```python
import torch

def _softmax(x, axis=-1):
    return torch.softmax(x, dim=axis)
def _gelu(x):
    return torch.nn.functional.gelu(x, approximate="tanh")
def _silu(x):
    return torch.nn.functional.silu(x)
def _sigmoid(x):
    return torch.sigmoid(x)
def _layernorm(x, axis=-1, eps=1e-5):
    m = x.mean(dim=axis, keepdim=True)
    v = x.var(dim=axis, keepdim=True, unbiased=False)
    return (x - m) / torch.sqrt(v + eps)
def _scatter_add(tgt, idx, src, axis=0):
    return tgt.clone().index_add_(axis, idx, src)
def _segment_sum(src, seg, n):
    out = torch.zeros((n,) + src.shape[1:], dtype=src.dtype)
    return out.index_add_(0, seg, src)
def _pad(x, pw):
    flat = tuple(v for pair in reversed(pw) for v in pair)
    return torch.nn.functional.pad(x, flat)

kernel_name = 'standalone__gqa_softmax__near_ridge'

def setup_inputs():

    _w = (lambda a: (lambda t: t.to(torch.bfloat16) if t.is_floating_point() else t)(torch.as_tensor(a)))
    B, Hq, Hkv, Sq, Sk, D = 16, 32, 32, 384, 1024, 128
    return {
        "q": _w((lambda *s: torch.randn(*s, dtype=torch.bfloat16) * 0.8)(B, Hq, Sq, D)),
        "k": _w((lambda *s: torch.randn(*s, dtype=torch.bfloat16) * 0.8)(B, Hkv, Sk, D)),
        "v": _w((lambda *s: torch.randn(*s, dtype=torch.bfloat16) * 0.05)(B, Hkv, Sk, D)),
    }

def reference(q, k, v):
    B, Hq, Sq, D = q.shape
    Hkv = k.shape[1]
    rep = Hq // Hkv
    k = (lambda x, n, axis: torch.repeat_interleave(x, n, dim=axis))(k, rep, axis=1)
    v = (lambda x, n, axis: torch.repeat_interleave(x, n, dim=axis))(v, rep, axis=1)
    scale = D ** -0.5
    scores = torch.einsum("bhqd,bhkd->bhqk", q, k) * scale
    p = _softmax(scores, axis=-1)
    return torch.einsum("bhqk,bhkd->bhqd", p, v)
```

```asm
; @launch grid=(256,1,1) block=(256,1,1) lds=155232
.amdgcn_target "amdgcn-amd-amdhsa--gfx950"
.text
.globl standalone__gqa_softmax__near_ridge_kernel
.p2align 8
.type standalone__gqa_softmax__near_ridge_kernel,@function
standalone__gqa_softmax__near_ridge_kernel:
    s_cmp_ge_u32 s2, 256
    s_cbranch_scc1 L_done
    s_load_dwordx8 s[44:51], s[0:1], 0
    v_lshrrev_b32 v244, 6, v0
    v_and_b32 v245, 63, v0
    v_readfirstlane_b32 s26, v244
    v_and_b32 v246, 15, v245
    v_lshrrev_b32 v247, 4, v245
    v_lshlrev_b32 v243, 4, v245
    v_lshl_add_u32 v243, v244, 11, v243
    v_mul_u32_u24 v248, 24576, v244
    v_and_b32 v249, 7, v246
    v_lshl_add_u32 v248, v249, 10, v248
    v_lshrrev_b32 v249, 3, v246
    v_lshl_add_u32 v248, v249, 8, v248
    v_lshl_add_u32 v254, v247, 4, v248
    s_mul_i32 s24, s26, 2112
    s_mov_b32 s20, 0
    s_waitcnt lgkmcnt(0)
    s_mul_i32 s3, s2, 524288
    s_add_u32 s4, s46, s3
    s_addc_u32 s5, s47, 0
    s_and_b32 s5, s5, 0xffff
    s_mov_b32 s6, 524288
    s_mov_b32 s7, 0x20000
    s_mul_i32 s3, s2, 196608
    s_add_u32 s12, s44, s3
    s_addc_u32 s13, s45, 0
    s_and_b32 s13, s13, 0xffff
    s_mov_b32 s14, 196608
    s_mov_b32 s15, 0x20000
    s_add_u32 m0, s24, 0
    s_nop 0
    buffer_load_dwordx4 v243, s[4:7], s20 offen nt lds
    s_add_u32 m0, s24, 32
    s_nop 0
    buffer_load_dwordx4 v243, s[4:7], s20 offen offset:1024 nt lds
    s_mov_b32 s40, 0
    buffer_load_dwordx4 v[96:99], v254, s[12:15], s40 offen offset:0 nt
    buffer_load_dwordx4 v[100:103], v254, s[12:15], s40 offen offset:64 nt
    buffer_load_dwordx4 v[104:107], v254, s[12:15], s40 offen offset:128 nt
    buffer_load_dwordx4 v[108:111], v254, s[12:15], s40 offen offset:192 nt
    s_mov_b32 s40, 512
    buffer_load_dwordx4 v[112:115], v254, s[12:15], s40 offen offset:0 nt
    buffer_load_dwordx4 v[116:119], v254, s[12:15], s40 offen offset:64 nt
    buffer_load_dwordx4 v[120:123], v254, s[12:15], s40 offen offset:128 nt
    buffer_load_dwordx4 v[124:127], v254, s[12:15], s40 offen offset:192 nt
    s_mov_b32 s40, 8192
    buffer_load_dwordx4 v[128:131], v254, s[12:15], s40 offen offset:0 nt
    buffer_load_dwordx4 v[132:135], v254, s[12:15], s40 offen offset:64 nt
    buffer_load_dwordx4 v[136:139], v254, s[12:15], s40 offen offset:128 nt
    buffer_load_dwordx4 v[140:143], v254, s[12:15], s40 offen offset:192 nt
    s_mul_i32 s3, s2, 524288
    s_add_u32 s8, s48, s3
    s_addc_u32 s9, s49, 0
    s_and_b32 s9, s9, 0xffff
    s_mov_b32 s10, 524288
    s_mov_b32 s11, 0x20000
    s_add_u32 m0, s24, 8448
    s_nop 0
    buffer_load_dwordx4 v243, s[8:11], s20 offen nt lds
    s_add_u32 m0, s24, 8456
    s_nop 0
    buffer_load_dwordx4 v243, s[8:11], s20 offen offset:1024 nt lds
    s_mul_i32 s3, s2, 196608
    s_add_u32 s16, s50, s3
    s_addc_u32 s17, s51, 0
    s_and_b32 s17, s17, 0xffff
    s_mov_b32 s18, 196608
    s_mov_b32 s19, 0x20000
    v_mul_u32_u24 v255, 24576, v244
    v_lshrrev_b32 v249, 3, v245
    v_lshl_add_u32 v255, v249, 10, v255
    v_and_b32 v249, 7, v245
    v_lshl_add_u32 v255, v249, 4, v255
    v_and_b32 v248, 7, v246
    v_mul_u32_u24 v241, 1056, v248
    v_lshrrev_b32 v248, 3, v246
    v_lshl_add_u32 v241, v248, 8, v241
    v_lshl_add_u32 v241, v247, 4, v241
    v_bfe_u32 v248, v245, 2, 3
    v_lshrrev_b32 v249, 1, v248
    v_mul_u32_u24 v242, 2112, v249
    v_and_b32 v249, 1, v248
    v_mul_u32_u24 v249, 1032, v249
    v_add_u32 v242, v249, v242
    v_lshrrev_b32 v248, 5, v245
    v_lshl_add_u32 v242, v248, 8, v242
    v_and_b32 v248, 3, v245
    v_lshl_add_u32 v242, v248, 4, v242
    v_add_u32 v242, 8448, v242
    s_mov_b32 s28, 0x3e0293ee
    s_mov_b32 s29, 0x3e0293ee
    s_mov_b32 s30, 0x53800000
    s_mov_b32 s31, 0xffff0000
    s_mov_b64 s[34:35], 0
    s_mov_b64 s[36:37], 0
    s_mul_i32 s42, s26, 25344
    s_add_u32 s42, s42, 53856
    s_sub_u32 s45, s42, 50688
    s_lshl_b32 s3, s26, 11
    s_sub_u32 s43, s42, s3
    s_sub_u32 s63, s43, 3168
    s_mov_b32 s44, -2
    s_sub_u32 s45, s45, 2112
    s_mul_i32 s47, s26, 22528
    s_add_u32 s47, s47, 96256
    s_mov_b32 s50, 0
    v_and_b32 v248, 1, v246
    v_mov_b32 v249, 0x4444
    v_mov_b32 v250, 0xeeee
    v_cmp_eq_u32 vcc, 0, v248
    s_nop 1
    v_cndmask_b32 v240, v250, v249, vcc
    v_bfe_u32 v248, v246, 1, 1
    v_lshrrev_b32 v249, 1, v247
    v_cmp_eq_u32 vcc, v248, v249
    v_mov_b32 v250, 0x3f803f80
    s_nop 0
    v_cndmask_b32 v248, 0, v250, vcc
    v_accvgpr_write_b32 a172, v248
    v_accvgpr_write_b32 a173, v248
    v_accvgpr_write_b32 a174, v248
    v_accvgpr_write_b32 a175, v248
    v_accvgpr_write_b32 a160, 0
    v_accvgpr_write_b32 a161, 0
    v_accvgpr_write_b32 a162, 0
    v_accvgpr_write_b32 a163, 0
    v_accvgpr_write_b32 a164, 0
    v_accvgpr_write_b32 a165, 0
    v_accvgpr_write_b32 a166, 0
    v_accvgpr_write_b32 a167, 0
    v_accvgpr_write_b32 a168, 0
    v_accvgpr_write_b32 a169, 0
    v_accvgpr_write_b32 a170, 0
    v_accvgpr_write_b32 a171, 0
    s_waitcnt vmcnt(10)
    s_mov_b32 s40, 8704
    buffer_load_dwordx4 v[144:147], v254, s[12:15], s40 offen offset:0 nt
    buffer_load_dwordx4 v[148:151], v254, s[12:15], s40 offen offset:64 nt
    buffer_load_dwordx4 v[152:155], v254, s[12:15], s40 offen offset:128 nt
    buffer_load_dwordx4 v[156:159], v254, s[12:15], s40 offen offset:192 nt
    v_lshlrev_b32 v0, 16, v96
    v_and_b32 v1, s31, v96
    v_lshlrev_b32 v2, 16, v97
    v_and_b32 v3, s31, v97
    v_lshlrev_b32 v4, 16, v98
    v_and_b32 v5, s31, v98
    v_lshlrev_b32 v6, 16, v99
    v_and_b32 v7, s31, v99
    v_pk_mul_f32 v[0:1], v[0:1], s[28:29]
    v_pk_mul_f32 v[2:3], v[2:3], s[28:29]
    v_pk_mul_f32 v[4:5], v[4:5], s[28:29]
    v_pk_mul_f32 v[6:7], v[6:7], s[28:29]
    v_cvt_pk_bf16_f32 v96, v0, v1
    v_cvt_pk_bf16_f32 v97, v2, v3
    v_cvt_pk_bf16_f32 v98, v4, v5
    v_cvt_pk_bf16_f32 v99, v6, v7
    v_accvgpr_write_b32 a0, v96
    v_accvgpr_write_b32 a1, v97
    v_accvgpr_write_b32 a2, v98
    v_accvgpr_write_b32 a3, v99
    v_lshlrev_b32 v8, 16, v100
    v_and_b32 v9, s31, v100
    v_lshlrev_b32 v10, 16, v101
    v_and_b32 v11, s31, v101
    v_lshlrev_b32 v12, 16, v102
    v_and_b32 v13, s31, v102
    v_lshlrev_b32 v14, 16, v103
    v_and_b32 v15, s31, v103
    v_pk_mul_f32 v[8:9], v[8:9], s[28:29]
    v_pk_mul_f32 v[10:11], v[10:11], s[28:29]
    v_pk_mul_f32 v[12:13], v[12:13], s[28:29]
    v_pk_mul_f32 v[14:15], v[14:15], s[28:29]
    v_cvt_pk_bf16_f32 v100, v8, v9
    v_cvt_pk_bf16_f32 v101, v10, v11
    v_cvt_pk_bf16_f32 v102, v12, v13
    v_cvt_pk_bf16_f32 v103, v14, v15
    v_accvgpr_write_b32 a4, v100
    v_accvgpr_write_b32 a5, v101
    v_accvgpr_write_b32 a6, v102
    v_accvgpr_write_b32 a7, v103
    v_lshlrev_b32 v0, 16, v104
    v_and_b32 v1, s31, v104
    v_lshlrev_b32 v2, 16, v105
    v_and_b32 v3, s31, v105
    v_lshlrev_b32 v4, 16, v106
    v_and_b32 v5, s31, v106
    v_lshlrev_b32 v6, 16, v107
    v_and_b32 v7, s31, v107
    v_pk_mul_f32 v[0:1], v[0:1], s[28:29]
    v_pk_mul_f32 v[2:3], v[2:3], s[28:29]
    v_pk_mul_f32 v[4:5], v[4:5], s[28:29]
    v_pk_mul_f32 v[6:7], v[6:7], s[28:29]
    v_cvt_pk_bf16_f32 v104, v0, v1
    v_cvt_pk_bf16_f32 v105, v2, v3
    v_cvt_pk_bf16_f32 v106, v4, v5
    v_cvt_pk_bf16_f32 v107, v6, v7
    v_accvgpr_write_b32 a8, v104
    v_accvgpr_write_b32 a9, v105
    v_accvgpr_write_b32 a10, v106
    v_accvgpr_write_b32 a11, v107
    v_lshlrev_b32 v8, 16, v108
    v_and_b32 v9, s31, v108
    v_lshlrev_b32 v10, 16, v109
    v_and_b32 v11, s31, v109
    v_lshlrev_b32 v12, 16, v110
    v_and_b32 v13, s31, v110
    v_lshlrev_b32 v14, 16, v111
    v_and_b32 v15, s31, v111
    v_pk_mul_f32 v[8:9], v[8:9], s[28:29]
    v_pk_mul_f32 v[10:11], v[10:11], s[28:29]
    v_pk_mul_f32 v[12:13], v[12:13], s[28:29]
    v_pk_mul_f32 v[14:15], v[14:15], s[28:29]
    v_cvt_pk_bf16_f32 v108, v8, v9
    v_cvt_pk_bf16_f32 v109, v10, v11
    v_cvt_pk_bf16_f32 v110, v12, v13
    v_cvt_pk_bf16_f32 v111, v14, v15
    v_accvgpr_write_b32 a12, v108
    v_accvgpr_write_b32 a13, v109
    v_accvgpr_write_b32 a14, v110
    v_accvgpr_write_b32 a15, v111
    s_barrier
    ds_read_b128 a[96:99], v241 offset:0
    ds_read_b128 a[100:103], v241 offset:64
    ds_read_b128 a[104:107], v241 offset:128
    ds_read_b128 a[108:111], v241 offset:192
    ds_read_b128 a[112:115], v241 offset:512
    ds_read_b128 a[116:119], v241 offset:576
    ds_read_b128 a[120:123], v241 offset:640
    ds_read_b128 a[124:127], v241 offset:704
    s_waitcnt lgkmcnt(7)
    v_mfma_f32_16x16x32_bf16 v[192:195], a[96:99], a[0:3], 0
    s_waitcnt vmcnt(13) lgkmcnt(6)
    v_lshlrev_b32 v249, 16, v112
    v_and_b32 v112, s31, v112
    v_mfma_f32_16x16x32_bf16 v[192:195], a[100:103], a[4:7], v[192:195]
    s_waitcnt lgkmcnt(5)
    s_mov_b32 s40, 16384
    v_mul_f32 v249, s28, v249
    v_mul_f32 v112, s28, v112
    v_mfma_f32_16x16x32_bf16 v[192:195], a[104:107], a[8:11], v[192:195]
    s_waitcnt lgkmcnt(4)
    buffer_load_dwordx4 v[160:163], v254, s[12:15], s40 offen offset:0 nt
    buffer_load_dwordx4 v[164:167], v254, s[12:15], s40 offen offset:64 nt
    buffer_load_dwordx4 v[168:171], v254, s[12:15], s40 offen offset:128 nt
    buffer_load_dwordx4 v[172:175], v254, s[12:15], s40 offen offset:192 nt
    v_mfma_f32_16x16x32_bf16 v[192:195], a[108:111], a[12:15], v[192:195]
    s_waitcnt lgkmcnt(3)
    v_cvt_pk_bf16_f32 v112, v249, v112
    v_accvgpr_write_b32 a16, v112
    v_mfma_f32_16x16x32_bf16 v[196:199], a[112:115], a[0:3], 0
    s_waitcnt lgkmcnt(2)
    v_lshlrev_b32 v250, 16, v113
    v_and_b32 v113, s31, v113
    v_mfma_f32_16x16x32_bf16 v[196:199], a[116:119], a[4:7], v[196:199]
    s_waitcnt lgkmcnt(1)
    v_mul_f32 v250, s28, v250
    v_mul_f32 v113, s28, v113
    v_mfma_f32_16x16x32_bf16 v[196:199], a[120:123], a[8:11], v[196:199]
    s_waitcnt lgkmcnt(0)
    v_cvt_pk_bf16_f32 v113, v250, v113
    v_accvgpr_write_b32 a17, v113
    v_lshlrev_b32 v249, 16, v114
    v_and_b32 v114, s31, v114
    v_mul_f32 v249, s28, v249
    v_mul_f32 v114, s28, v114
    v_cvt_pk_bf16_f32 v114, v249, v114
    v_accvgpr_write_b32 a18, v114
    v_lshlrev_b32 v250, 16, v115
    v_and_b32 v115, s31, v115
    v_mul_f32 v250, s28, v250
    v_mul_f32 v115, s28, v115
    v_cvt_pk_bf16_f32 v115, v250, v115
    v_accvgpr_write_b32 a19, v115
    v_mfma_f32_16x16x32_bf16 v[196:199], a[124:127], a[12:15], v[196:199]
    s_waitcnt vmcnt(16)
    v_lshlrev_b32 v249, 16, v116
    v_and_b32 v116, s31, v116
    v_mul_f32 v249, s28, v249
    v_mul_f32 v116, s28, v116
    v_cvt_pk_bf16_f32 v116, v249, v116
    v_accvgpr_write_b32 a20, v116
    v_lshlrev_b32 v250, 16, v117
    v_and_b32 v117, s31, v117
    v_mul_f32 v250, s28, v250
    v_mul_f32 v117, s28, v117
    v_cvt_pk_bf16_f32 v117, v250, v117
    v_accvgpr_write_b32 a21, v117
    v_lshlrev_b32 v249, 16, v118
    v_and_b32 v118, s31, v118
    v_mul_f32 v249, s28, v249
    v_mul_f32 v118, s28, v118
    v_cvt_pk_bf16_f32 v118, v249, v118
    v_accvgpr_write_b32 a22, v118
    v_lshlrev_b32 v250, 16, v119
    v_and_b32 v119, s31, v119
    v_mul_f32 v250, s28, v250
    v_mul_f32 v119, s28, v119
    v_cvt_pk_bf16_f32 v119, v250, v119
    v_accvgpr_write_b32 a23, v119
    v_mfma_f32_16x16x32_bf16 v[200:203], a[96:99], a[16:19], 0
    s_waitcnt vmcnt(15)
    v_lshlrev_b32 v249, 16, v120
    v_and_b32 v120, s31, v120
    v_mul_f32 v249, s28, v249
    v_mul_f32 v120, s28, v120
    v_cvt_pk_bf16_f32 v120, v249, v120
    v_accvgpr_write_b32 a24, v120
    v_lshlrev_b32 v250, 16, v121
    v_and_b32 v121, s31, v121
    v_mul_f32 v250, s28, v250
    v_mul_f32 v121, s28, v121
    v_cvt_pk_bf16_f32 v121, v250, v121
    v_accvgpr_write_b32 a25, v121
    v_lshlrev_b32 v249, 16, v122
    v_and_b32 v122, s31, v122
    v_mul_f32 v249, s28, v249
    v_mul_f32 v122, s28, v122
    v_cvt_pk_bf16_f32 v122, v249, v122
    v_accvgpr_write_b32 a26, v122
    v_lshlrev_b32 v250, 16, v123
    v_and_b32 v123, s31, v123
    v_mul_f32 v250, s28, v250
    v_mul_f32 v123, s28, v123
    v_cvt_pk_bf16_f32 v123, v250, v123
    v_accvgpr_write_b32 a27, v123
    v_mfma_f32_16x16x32_bf16 v[200:203], a[100:103], a[20:23], v[200:203]
    s_waitcnt vmcnt(8)
    v_lshlrev_b32 v249, 16, v124
    v_and_b32 v124, s31, v124
    v_mul_f32 v249, s28, v249
    v_mul_f32 v124, s28, v124
    v_cvt_pk_bf16_f32 v124, v249, v124
    v_accvgpr_write_b32 a28, v124
    v_lshlrev_b32 v250, 16, v125
    v_and_b32 v125, s31, v125
    v_mul_f32 v250, s28, v250
    v_mul_f32 v125, s28, v125
    v_cvt_pk_bf16_f32 v125, v250, v125
    v_accvgpr_write_b32 a29, v125
    v_lshlrev_b32 v249, 16, v126
    v_and_b32 v126, s31, v126
    v_mul_f32 v249, s28, v249
    v_mul_f32 v126, s28, v126
    v_cvt_pk_bf16_f32 v126, v249, v126
    v_accvgpr_write_b32 a30, v126
    v_lshlrev_b32 v250, 16, v127
    v_and_b32 v127, s31, v127
    v_mul_f32 v250, s28, v250
    v_mul_f32 v127, s28, v127
    v_cvt_pk_bf16_f32 v127, v250, v127
    v_accvgpr_write_b32 a31, v127
    v_mfma_f32_16x16x32_bf16 v[200:203], a[104:107], a[24:27], v[200:203]
    s_barrier
    v_max3_f32 v244, v192, v193, v194
    v_max_f32 v244, v244, v195
    v_mfma_f32_16x16x32_bf16 v[200:203], a[108:111], a[28:31], v[200:203]
    v_max3_f32 v244, v244, v196, v197
    v_max3_f32 v244, v244, v198, v199
    v_mfma_f32_16x16x32_bf16 v[204:207], a[112:115], a[16:19], 0
    ds_read_b64_tr_b16 a[128:129], v242 offset:0
    v_mov_b32 v245, v244
    v_mfma_f32_16x16x32_bf16 v[204:207], a[116:119], a[20:23], v[204:207]
    ds_read_b64_tr_b16 a[130:131], v242 offset:512
    v_permlane16_swap_b32 v244, v245
    v_max_f32 v244, v244, v245
    v_mov_b32 v245, v244
    v_mfma_f32_16x16x32_bf16 v[204:207], a[120:123], a[24:27], v[204:207]
    ds_read_b64_tr_b16 a[132:133], v242 offset:8
    ds_read_b64_tr_b16 a[134:135], v242 offset:520
    v_lshlrev_b32 v249, 16, v128
    v_and_b32 v128, s31, v128
    v_mul_f32 v249, s28, v249
    v_mul_f32 v128, s28, v128
    v_cvt_pk_bf16_f32 v128, v249, v128
    v_accvgpr_write_b32 a32, v128
    v_lshlrev_b32 v250, 16, v129
    v_and_b32 v129, s31, v129
    v_mul_f32 v250, s28, v250
    v_mul_f32 v129, s28, v129
    v_cvt_pk_bf16_f32 v129, v250, v129
    v_accvgpr_write_b32 a33, v129
    v_lshlrev_b32 v249, 16, v130
    v_and_b32 v130, s31, v130
    v_mul_f32 v249, s28, v249
    v_mul_f32 v130, s28, v130
    v_cvt_pk_bf16_f32 v130, v249, v130
    v_accvgpr_write_b32 a34, v130
    v_lshlrev_b32 v250, 16, v131
    v_and_b32 v131, s31, v131
    v_mul_f32 v250, s28, v250
    v_mul_f32 v131, s28, v131
    v_cvt_pk_bf16_f32 v131, v250, v131
    v_accvgpr_write_b32 a35, v131
    v_permlane32_swap_b32 v244, v245
    v_min_f32 v216, -v244, -v245
    v_add_f32 v192, v216, v192
    v_add_f32 v193, v216, v193
    v_add_f32 v194, v216, v194
    v_add_f32 v195, v216, v195
    v_exp_f32 v192, v192
    v_exp_f32 v193, v193
    v_exp_f32 v194, v194
    v_exp_f32 v195, v195
    v_mfma_f32_16x16x32_bf16 v[204:207], a[124:127], a[28:31], v[204:207]
    s_mov_b32 s40, 16896
    s_mov_b32 s20, 8192
    ds_read_b64_tr_b16 a[136:137], v242 offset:64
    ds_read_b64_tr_b16 a[138:139], v242 offset:576
    v_lshlrev_b32 v249, 16, v132
    v_and_b32 v132, s31, v132
    v_mul_f32 v249, s28, v249
    v_mul_f32 v132, s28, v132
    v_cvt_pk_bf16_f32 v132, v249, v132
    v_accvgpr_write_b32 a36, v132
    v_lshlrev_b32 v250, 16, v133
    v_and_b32 v133, s31, v133
    v_mul_f32 v250, s28, v250
    v_mul_f32 v133, s28, v133
    v_cvt_pk_bf16_f32 v133, v250, v133
    v_accvgpr_write_b32 a37, v133
    v_lshlrev_b32 v249, 16, v134
    v_and_b32 v134, s31, v134
    v_mul_f32 v249, s28, v249
    v_mul_f32 v134, s28, v134
    v_cvt_pk_bf16_f32 v134, v249, v134
    v_accvgpr_write_b32 a38, v134
    v_lshlrev_b32 v250, 16, v135
    v_and_b32 v135, s31, v135
    v_mul_f32 v250, s28, v250
    v_mul_f32 v135, s28, v135
    v_cvt_pk_bf16_f32 v135, v250, v135
    v_accvgpr_write_b32 a39, v135
    v_cvt_pk_bf16_f32 v208, v192, v193
    v_cvt_pk_bf16_f32 v209, v194, v195
    v_mfma_f32_16x16x32_bf16 v[192:195], a[96:99], a[32:35], 0
    s_add_u32 m0, s24, 16896
    buffer_load_dwordx4 v[176:179], v254, s[12:15], s40 offen offset:0 nt
    buffer_load_dwordx4 v[180:183], v254, s[12:15], s40 offen offset:64 nt
    buffer_load_dwordx4 v[184:187], v254, s[12:15], s40 offen offset:128 nt
    buffer_load_dwordx4 v[188:191], v254, s[12:15], s40 offen offset:192 nt
    ds_read_b64_tr_b16 a[140:141], v242 offset:72
    ds_read_b64_tr_b16 a[142:143], v242 offset:584
    v_lshlrev_b32 v249, 16, v136
    v_and_b32 v136, s31, v136
    v_mul_f32 v249, s28, v249
    v_mul_f32 v136, s28, v136
    v_cvt_pk_bf16_f32 v136, v249, v136
    v_accvgpr_write_b32 a40, v136
    v_lshlrev_b32 v250, 16, v137
    v_and_b32 v137, s31, v137
    v_mul_f32 v250, s28, v250
    v_mul_f32 v137, s28, v137
    v_cvt_pk_bf16_f32 v137, v250, v137
    v_accvgpr_write_b32 a41, v137
    v_lshlrev_b32 v249, 16, v138
    v_and_b32 v138, s31, v138
    v_mul_f32 v249, s28, v249
    v_mul_f32 v138, s28, v138
    v_cvt_pk_bf16_f32 v138, v249, v138
    v_accvgpr_write_b32 a42, v138
    v_lshlrev_b32 v250, 16, v139
    v_and_b32 v139, s31, v139
    v_mul_f32 v250, s28, v250
    v_mul_f32 v139, s28, v139
    v_cvt_pk_bf16_f32 v139, v250, v139
    v_accvgpr_write_b32 a43, v139
    v_mfma_f32_16x16x32_bf16 v[192:195], a[100:103], a[36:39], v[192:195]
    buffer_load_dwordx4 v243, s[4:7], s20 offen nt lds
    v_lshlrev_b32 v249, 16, v140
    v_and_b32 v140, s31, v140
    v_mul_f32 v249, s28, v249
    v_mul_f32 v140, s28, v140
    v_cvt_pk_bf16_f32 v140, v249, v140
    v_accvgpr_write_b32 a44, v140
    v_lshlrev_b32 v250, 16, v141
    v_and_b32 v141, s31, v141
    v_mul_f32 v250, s28, v250
    v_mul_f32 v141, s28, v141
    v_cvt_pk_bf16_f32 v141, v250, v141
    v_accvgpr_write_b32 a45, v141
    v_lshlrev_b32 v249, 16, v142
    v_and_b32 v142, s31, v142
    v_mul_f32 v249, s28, v249
    v_mul_f32 v142, s28, v142
    v_cvt_pk_bf16_f32 v142, v249, v142
    v_accvgpr_write_b32 a46, v142
    v_lshlrev_b32 v250, 16, v143
    v_and_b32 v143, s31, v143
    v_mul_f32 v250, s28, v250
    v_mul_f32 v143, s28, v143
    v_cvt_pk_bf16_f32 v143, v250, v143
    v_accvgpr_write_b32 a47, v143
    v_add_f32 v196, v216, v196
    v_add_f32 v197, v216, v197
    v_add_f32 v198, v216, v198
    v_add_f32 v199, v216, v199
    v_exp_f32 v196, v196
    v_exp_f32 v197, v197
    v_exp_f32 v198, v198
    v_exp_f32 v199, v199
    v_mfma_f32_16x16x32_bf16 v[192:195], a[104:107], a[40:43], v[192:195]
    s_add_u32 m0, s24, 16928
    v_cvt_pk_bf16_f32 v210, v196, v197
    v_cvt_pk_bf16_f32 v211, v198, v199
    v_mfma_f32_16x16x32_bf16 v[192:195], a[108:111], a[44:47], v[192:195]
    s_waitcnt lgkmcnt(6)
    buffer_load_dwordx4 v243, s[4:7], s20 offen offset:1024 nt lds
    v_mfma_f32_16x16x32_bf16 v[0:3], a[128:131], v[208:211], 0
    s_waitcnt lgkmcnt(4)
    s_add_u32 m0, s24, 25344
    ds_read_b64_tr_b16 a[144:145], v242 offset:128
    v_mfma_f32_16x16x32_bf16 v[4:7], a[132:135], v[208:211], 0
    s_waitcnt lgkmcnt(3)
    buffer_load_dwordx4 v243, s[8:11], s20 offen nt lds
    ds_read_b64_tr_b16 a[146:147], v242 offset:640
    v_mfma_f32_16x16x32_bf16 v[8:11], a[136:139], v[208:211], 0
    s_waitcnt lgkmcnt(2)
    s_add_u32 m0, s24, 25352
    ds_read_b64_tr_b16 a[148:149], v242 offset:136
    ds_read_b64_tr_b16 a[150:151], v242 offset:648
    v_mfma_f32_16x16x32_bf16 v[12:15], a[140:143], v[208:211], 0
    buffer_load_dwordx4 v243, s[8:11], s20 offen offset:1024 nt lds
    ds_read_b64_tr_b16 a[152:153], v242 offset:192
    ds_read_b64_tr_b16 a[154:155], v242 offset:704
    v_mfma_f32_16x16x32_bf16 v[196:199], a[112:115], a[32:35], 0
    ds_read_b64_tr_b16 a[156:157], v242 offset:200
    ds_read_b64_tr_b16 a[158:159], v242 offset:712
    v_mfma_f32_16x16x32_bf16 v[196:199], a[116:119], a[36:39], v[196:199]
    v_min_f32 v217, -v244, -v245
    v_min_f32 v218, -v244, -v245
    v_mfma_f32_16x16x32_bf16 v[196:199], a[120:123], a[40:43], v[196:199]
    v_min_f32 v219, -v244, -v245
    v_max3_f32 v244, v200, v201, v202
    v_mfma_f32_16x16x32_bf16 v[196:199], a[124:127], a[44:47], v[196:199]
    s_waitcnt lgkmcnt(6)
    v_max_f32 v244, v244, v203
    v_max3_f32 v244, v244, v204, v205
    v_mfma_f32_16x16x32_bf16 v[16:19], a[144:147], v[208:211], 0
    s_waitcnt lgkmcnt(4)
    v_max3_f32 v244, v244, v206, v207
    v_mov_b32 v245, v244
    v_mfma_f32_16x16x32_bf16 v[20:23], a[148:151], v[208:211], 0
    s_waitcnt lgkmcnt(2)
    v_permlane16_swap_b32 v244, v245
    v_max_f32 v244, v244, v245
    v_mov_b32 v245, v244
    v_mfma_f32_16x16x32_bf16 v[24:27], a[152:155], v[208:211], 0
    s_waitcnt vmcnt(15) lgkmcnt(0)
    v_lshlrev_b32 v249, 16, v144
    v_and_b32 v144, s31, v144
    v_mul_f32 v249, s28, v249
    v_mul_f32 v144, s28, v144
    v_cvt_pk_bf16_f32 v144, v249, v144
    v_accvgpr_write_b32 a48, v144
    v_lshlrev_b32 v250, 16, v145
    v_and_b32 v145, s31, v145
    v_mul_f32 v250, s28, v250
    v_mul_f32 v145, s28, v145
    v_cvt_pk_bf16_f32 v145, v250, v145
    v_accvgpr_write_b32 a49, v145
    v_lshlrev_b32 v249, 16, v146
    v_and_b32 v146, s31, v146
    v_mul_f32 v249, s28, v249
    v_mul_f32 v146, s28, v146
    v_cvt_pk_bf16_f32 v146, v249, v146
    v_accvgpr_write_b32 a50, v146
    v_lshlrev_b32 v250, 16, v147
    v_and_b32 v147, s31, v147
    v_mul_f32 v250, s28, v250
    v_mul_f32 v147, s28, v147
    v_cvt_pk_bf16_f32 v147, v250, v147
    v_accvgpr_write_b32 a51, v147
    v_permlane32_swap_b32 v244, v245
    v_min_f32 v220, -v244, -v245
    v_add_f32 v200, v220, v200
    v_add_f32 v201, v220, v201
    v_add_f32 v202, v220, v202
    v_add_f32 v203, v220, v203
    v_exp_f32 v200, v200
    v_exp_f32 v201, v201
    v_exp_f32 v202, v202
    v_exp_f32 v203, v203
    v_mfma_f32_16x16x32_bf16 v[28:31], a[156:159], v[208:211], 0
    s_waitcnt vmcnt(14)
    v_lshlrev_b32 v249, 16, v148
    v_and_b32 v148, s31, v148
    v_mul_f32 v249, s28, v249
    v_mul_f32 v148, s28, v148
    v_cvt_pk_bf16_f32 v148, v249, v148
    v_accvgpr_write_b32 a52, v148
    v_lshlrev_b32 v250, 16, v149
    v_and_b32 v149, s31, v149
    v_mul_f32 v250, s28, v250
    v_mul_f32 v149, s28, v149
    v_cvt_pk_bf16_f32 v149, v250, v149
    v_accvgpr_write_b32 a53, v149
    v_lshlrev_b32 v249, 16, v150
    v_and_b32 v150, s31, v150
    v_mul_f32 v249, s28, v249
    v_mul_f32 v150, s28, v150
    v_cvt_pk_bf16_f32 v150, v249, v150
    v_accvgpr_write_b32 a54, v150
    v_lshlrev_b32 v250, 16, v151
    v_and_b32 v151, s31, v151
    v_mul_f32 v250, s28, v250
    v_mul_f32 v151, s28, v151
    v_cvt_pk_bf16_f32 v151, v250, v151
    v_accvgpr_write_b32 a55, v151
    v_cvt_pk_bf16_f32 v212, v200, v201
    v_cvt_pk_bf16_f32 v213, v202, v203
    v_mfma_f32_16x16x32_bf16 v[200:203], a[96:99], a[48:51], 0
    s_waitcnt vmcnt(13)
    v_lshlrev_b32 v249, 16, v152
    v_and_b32 v152, s31, v152
    v_mul_f32 v249, s28, v249
    v_mul_f32 v152, s28, v152
    v_cvt_pk_bf16_f32 v152, v249, v152
    v_accvgpr_write_b32 a56, v152
    v_lshlrev_b32 v250, 16, v153
    v_and_b32 v153, s31, v153
    v_mul_f32 v250, s28, v250
    v_mul_f32 v153, s28, v153
    v_cvt_pk_bf16_f32 v153, v250, v153
    v_accvgpr_write_b32 a57, v153
    v_lshlrev_b32 v249, 16, v154
    v_and_b32 v154, s31, v154
    v_mul_f32 v249, s28, v249
    v_mul_f32 v154, s28, v154
    v_cvt_pk_bf16_f32 v154, v249, v154
    v_accvgpr_write_b32 a58, v154
    v_lshlrev_b32 v250, 16, v155
    v_and_b32 v155, s31, v155
    v_mul_f32 v250, s28, v250
    v_mul_f32 v155, s28, v155
    v_cvt_pk_bf16_f32 v155, v250, v155
    v_accvgpr_write_b32 a59, v155
    v_mfma_f32_16x16x32_bf16 v[200:203], a[100:103], a[52:55], v[200:203]
    s_waitcnt vmcnt(12)
    v_lshlrev_b32 v249, 16, v156
    v_and_b32 v156, s31, v156
    v_mul_f32 v249, s28, v249
    v_mul_f32 v156, s28, v156
    v_cvt_pk_bf16_f32 v156, v249, v156
    v_accvgpr_write_b32 a60, v156
    v_lshlrev_b32 v250, 16, v157
    v_and_b32 v157, s31, v157
    v_mul_f32 v250, s28, v250
    v_mul_f32 v157, s28, v157
    v_cvt_pk_bf16_f32 v157, v250, v157
    v_accvgpr_write_b32 a61, v157
    v_lshlrev_b32 v249, 16, v158
    v_and_b32 v158, s31, v158
    v_mul_f32 v249, s28, v249
    v_mul_f32 v158, s28, v158
    v_cvt_pk_bf16_f32 v158, v249, v158
    v_accvgpr_write_b32 a62, v158
    v_lshlrev_b32 v250, 16, v159
    v_and_b32 v159, s31, v159
    v_mul_f32 v250, s28, v250
    v_mul_f32 v159, s28, v159
    v_cvt_pk_bf16_f32 v159, v250, v159
    v_accvgpr_write_b32 a63, v159
    v_mfma_f32_16x16x32_bf16 v[200:203], a[104:107], a[56:59], v[200:203]
    v_add_f32 v204, v220, v204
    v_add_f32 v205, v220, v205
    v_add_f32 v206, v220, v206
    v_add_f32 v207, v220, v207
    v_exp_f32 v204, v204
    v_exp_f32 v205, v205
    v_exp_f32 v206, v206
    v_exp_f32 v207, v207
    v_mfma_f32_16x16x32_bf16 v[200:203], a[108:111], a[60:63], v[200:203]
    v_cvt_pk_bf16_f32 v214, v204, v205
    v_cvt_pk_bf16_f32 v215, v206, v207
    s_nop 1
    v_smfmac_f32_16x16x64_bf16 a[160:163], a[172:175], v[208:215], v240
    v_min_f32 v221, -v244, -v245
    v_min_f32 v222, -v244, -v245
    v_mfma_f32_16x16x32_bf16 v[32:35], a[128:131], v[212:215], 0
    v_min_f32 v223, -v244, -v245
    v_max3_f32 v244, v192, v193, v194
    v_mfma_f32_16x16x32_bf16 v[36:39], a[132:135], v[212:215], 0
    v_max_f32 v244, v244, v195
    v_max3_f32 v244, v244, v196, v197
    v_mfma_f32_16x16x32_bf16 v[40:43], a[136:139], v[212:215], 0
    v_max3_f32 v244, v244, v198, v199
    v_mov_b32 v245, v244
    v_mfma_f32_16x16x32_bf16 v[44:47], a[140:143], v[212:215], 0
    s_nop 0
    v_permlane16_swap_b32 v244, v245
    v_mfma_f32_16x16x32_bf16 v[204:207], a[112:115], a[48:51], 0
    v_max_f32 v244, v244, v245
    v_mov_b32 v245, v244
    v_mfma_f32_16x16x32_bf16 v[204:207], a[116:119], a[52:55], v[204:207]
    s_waitcnt vmcnt(11)
    v_lshlrev_b32 v249, 16, v160
    v_and_b32 v160, s31, v160
    v_mfma_f32_16x16x32_bf16 v[204:207], a[120:123], a[56:59], v[204:207]
    s_mov_b32 s20, 16384
    v_mul_f32 v249, s28, v249
    v_mul_f32 v160, s28, v160
    v_mfma_f32_16x16x32_bf16 v[204:207], a[124:127], a[60:63], v[204:207]
    s_add_u32 m0, s24, 33792
    v_cvt_pk_bf16_f32 v160, v249, v160
    v_accvgpr_write_b32 a64, v160
    v_mfma_f32_16x16x32_bf16 v[48:51], a[144:147], v[212:215], 0
    buffer_load_dwordx4 v243, s[4:7], s20 offen nt lds
    v_mfma_f32_16x16x32_bf16 v[52:55], a[148:151], v[212:215], 0
    s_add_u32 m0, s24, 33824
    v_lshlrev_b32 v250, 16, v161
    v_and_b32 v161, s31, v161
    v_mfma_f32_16x16x32_bf16 v[56:59], a[152:155], v[212:215], 0
    buffer_load_dwordx4 v243, s[4:7], s20 offen offset:1024 nt lds
    v_mul_f32 v250, s28, v250
    v_mul_f32 v161, s28, v161
    v_cvt_pk_bf16_f32 v161, v250, v161
    v_accvgpr_write_b32 a65, v161
    v_lshlrev_b32 v249, 16, v162
    v_and_b32 v162, s31, v162
    v_mul_f32 v249, s28, v249
    v_mul_f32 v162, s28, v162
    v_cvt_pk_bf16_f32 v162, v249, v162
    v_accvgpr_write_b32 a66, v162
    v_lshlrev_b32 v250, 16, v163
    v_and_b32 v163, s31, v163
    v_mul_f32 v250, s28, v250
    v_mul_f32 v163, s28, v163
    v_cvt_pk_bf16_f32 v163, v250, v163
    v_accvgpr_write_b32 a67, v163
    v_permlane32_swap_b32 v244, v245
    v_min_f32 v224, -v244, -v245
    v_add_f32 v192, v224, v192
    v_add_f32 v193, v224, v193
    v_add_f32 v194, v224, v194
    v_add_f32 v195, v224, v195
    v_exp_f32 v192, v192
    v_exp_f32 v193, v193
    v_exp_f32 v194, v194
    v_exp_f32 v195, v195
    v_mfma_f32_16x16x32_bf16 v[60:63], a[156:159], v[212:215], 0
    s_waitcnt vmcnt(12)
    s_add_u32 m0, s24, 42240
    v_lshlrev_b32 v249, 16, v164
    v_and_b32 v164, s31, v164
    v_mul_f32 v249, s28, v249
    v_mul_f32 v164, s28, v164
    v_cvt_pk_bf16_f32 v164, v249, v164
    v_accvgpr_write_b32 a68, v164
    v_lshlrev_b32 v250, 16, v165
    v_and_b32 v165, s31, v165
    v_mul_f32 v250, s28, v250
    v_mul_f32 v165, s28, v165
    v_cvt_pk_bf16_f32 v165, v250, v165
    v_accvgpr_write_b32 a69, v165
    v_lshlrev_b32 v249, 16, v166
    v_and_b32 v166, s31, v166
    v_mul_f32 v249, s28, v249
    v_mul_f32 v166, s28, v166
    v_cvt_pk_bf16_f32 v166, v249, v166
    v_accvgpr_write_b32 a70, v166
    v_lshlrev_b32 v250, 16, v167
    v_and_b32 v167, s31, v167
    v_mul_f32 v250, s28, v250
    v_mul_f32 v167, s28, v167
    v_cvt_pk_bf16_f32 v167, v250, v167
    v_accvgpr_write_b32 a71, v167
    v_cvt_pk_bf16_f32 v208, v192, v193
    v_cvt_pk_bf16_f32 v209, v194, v195
    v_mfma_f32_16x16x32_bf16 v[192:195], a[96:99], a[64:67], 0
    s_waitcnt vmcnt(11)
    buffer_load_dwordx4 v243, s[8:11], s20 offen nt lds
    v_lshlrev_b32 v249, 16, v168
    v_and_b32 v168, s31, v168
    v_mul_f32 v249, s28, v249
    v_mul_f32 v168, s28, v168
    v_cvt_pk_bf16_f32 v168, v249, v168
    v_accvgpr_write_b32 a72, v168
    v_lshlrev_b32 v250, 16, v169
    v_and_b32 v169, s31, v169
    v_mul_f32 v250, s28, v250
    v_mul_f32 v169, s28, v169
    v_cvt_pk_bf16_f32 v169, v250, v169
    v_accvgpr_write_b32 a73, v169
    v_lshlrev_b32 v249, 16, v170
    v_and_b32 v170, s31, v170
    v_mul_f32 v249, s28, v249
    v_mul_f32 v170, s28, v170
    v_cvt_pk_bf16_f32 v170, v249, v170
    v_accvgpr_write_b32 a74, v170
    v_lshlrev_b32 v250, 16, v171
    v_and_b32 v171, s31, v171
    v_mul_f32 v250, s28, v250
    v_mul_f32 v171, s28, v171
    v_cvt_pk_bf16_f32 v171, v250, v171
    v_accvgpr_write_b32 a75, v171
    v_mfma_f32_16x16x32_bf16 v[192:195], a[100:103], a[68:71], v[192:195]
    s_waitcnt vmcnt(11)
    s_add_u32 m0, s24, 42248
    v_lshlrev_b32 v249, 16, v172
    v_and_b32 v172, s31, v172
    v_mul_f32 v249, s28, v249
    v_mul_f32 v172, s28, v172
    v_cvt_pk_bf16_f32 v172, v249, v172
    v_accvgpr_write_b32 a76, v172
    v_lshlrev_b32 v250, 16, v173
    v_and_b32 v173, s31, v173
    v_mul_f32 v250, s28, v250
    v_mul_f32 v173, s28, v173
    v_cvt_pk_bf16_f32 v173, v250, v173
    v_accvgpr_write_b32 a77, v173
    v_lshlrev_b32 v249, 16, v174
    v_and_b32 v174, s31, v174
    v_mul_f32 v249, s28, v249
    v_mul_f32 v174, s28, v174
    v_cvt_pk_bf16_f32 v174, v249, v174
    v_accvgpr_write_b32 a78, v174
    v_lshlrev_b32 v250, 16, v175
    v_and_b32 v175, s31, v175
    v_mul_f32 v250, s28, v250
    v_mul_f32 v175, s28, v175
    v_cvt_pk_bf16_f32 v175, v250, v175
    v_accvgpr_write_b32 a79, v175
    v_add_f32 v196, v224, v196
    v_add_f32 v197, v224, v197
    v_add_f32 v198, v224, v198
    v_add_f32 v199, v224, v199
    v_exp_f32 v196, v196
    v_exp_f32 v197, v197
    v_exp_f32 v198, v198
    v_exp_f32 v199, v199
    v_mfma_f32_16x16x32_bf16 v[192:195], a[104:107], a[72:75], v[192:195]
    buffer_load_dwordx4 v243, s[8:11], s20 offen offset:1024 nt lds
    v_cvt_pk_bf16_f32 v210, v196, v197
    v_cvt_pk_bf16_f32 v211, v198, v199
    v_mfma_f32_16x16x32_bf16 v[192:195], a[108:111], a[76:79], v[192:195]
    s_mov_b32 s20, 24576
    v_min_f32 v225, -v244, -v245
    v_min_f32 v226, -v244, -v245
    v_mfma_f32_16x16x32_bf16 v[64:67], a[128:131], v[208:211], 0
    v_min_f32 v227, -v244, -v245
    v_max3_f32 v244, v200, v201, v202
    v_mfma_f32_16x16x32_bf16 v[68:71], a[132:135], v[208:211], 0
    v_max_f32 v244, v244, v203
    v_max3_f32 v244, v244, v204, v205
    v_mfma_f32_16x16x32_bf16 v[72:75], a[136:139], v[208:211], 0
    v_max3_f32 v244, v244, v206, v207
    v_mov_b32 v245, v244
    v_mfma_f32_16x16x32_bf16 v[76:79], a[140:143], v[208:211], 0
    s_nop 0
    v_permlane16_swap_b32 v244, v245
    v_mfma_f32_16x16x32_bf16 v[196:199], a[112:115], a[64:67], 0
    v_max_f32 v244, v244, v245
    v_mov_b32 v245, v244
    v_mfma_f32_16x16x32_bf16 v[196:199], a[116:119], a[68:71], v[196:199]
    s_waitcnt vmcnt(11)
    v_lshlrev_b32 v249, 16, v176
    v_and_b32 v176, s31, v176
    v_mfma_f32_16x16x32_bf16 v[196:199], a[120:123], a[72:75], v[196:199]
    v_mul_f32 v249, s28, v249
    v_mul_f32 v176, s28, v176
    v_mfma_f32_16x16x32_bf16 v[196:199], a[124:127], a[76:79], v[196:199]
    v_cvt_pk_bf16_f32 v176, v249, v176
    v_accvgpr_write_b32 a80, v176
    v_mfma_f32_16x16x32_bf16 v[80:83], a[144:147], v[208:211], 0
    v_lshlrev_b32 v250, 16, v177
    v_and_b32 v177, s31, v177
    v_mfma_f32_16x16x32_bf16 v[84:87], a[148:151], v[208:211], 0
    s_waitcnt vmcnt(4)
    v_mul_f32 v250, s28, v250
    v_mul_f32 v177, s28, v177
    v_mfma_f32_16x16x32_bf16 v[88:91], a[152:155], v[208:211], 0
    s_barrier
    v_cvt_pk_bf16_f32 v177, v250, v177
    v_accvgpr_write_b32 a81, v177
    v_lshlrev_b32 v249, 16, v178
    v_and_b32 v178, s31, v178
    v_mul_f32 v249, s28, v249
    v_mul_f32 v178, s28, v178
    v_cvt_pk_bf16_f32 v178, v249, v178
    v_accvgpr_write_b32 a82, v178
    v_lshlrev_b32 v250, 16, v179
    v_and_b32 v179, s31, v179
    v_mul_f32 v250, s28, v250
    v_mul_f32 v179, s28, v179
    v_cvt_pk_bf16_f32 v179, v250, v179
    v_accvgpr_write_b32 a83, v179
    v_permlane32_swap_b32 v244, v245
    v_min_f32 v228, -v244, -v245
    v_add_f32 v200, v228, v200
    v_add_f32 v201, v228, v201
    v_add_f32 v202, v228, v202
    v_add_f32 v203, v228, v203
    v_exp_f32 v200, v200
    v_exp_f32 v201, v201
    v_exp_f32 v202, v202
    v_exp_f32 v203, v203
    v_mfma_f32_16x16x32_bf16 v[92:95], a[156:159], v[208:211], 0
    v_lshlrev_b32 v249, 16, v180
    v_and_b32 v180, s31, v180
    v_mul_f32 v249, s28, v249
    v_mul_f32 v180, s28, v180
    v_cvt_pk_bf16_f32 v180, v249, v180
    v_accvgpr_write_b32 a84, v180
    v_lshlrev_b32 v250, 16, v181
    v_and_b32 v181, s31, v181
    v_mul_f32 v250, s28, v250
    v_mul_f32 v181, s28, v181
    v_cvt_pk_bf16_f32 v181, v250, v181
    v_accvgpr_write_b32 a85, v181
    v_lshlrev_b32 v249, 16, v182
    v_and_b32 v182, s31, v182
    v_mul_f32 v249, s28, v249
    v_mul_f32 v182, s28, v182
    v_cvt_pk_bf16_f32 v182, v249, v182
    v_accvgpr_write_b32 a86, v182
    v_lshlrev_b32 v250, 16, v183
    v_and_b32 v183, s31, v183
    v_mul_f32 v250, s28, v250
    v_mul_f32 v183, s28, v183
    v_cvt_pk_bf16_f32 v183, v250, v183
    v_accvgpr_write_b32 a87, v183
    v_cvt_pk_bf16_f32 v212, v200, v201
    v_cvt_pk_bf16_f32 v213, v202, v203
    v_mfma_f32_16x16x32_bf16 v[200:203], a[96:99], a[80:83], 0
    v_lshlrev_b32 v249, 16, v184
    v_and_b32 v184, s31, v184
    v_mul_f32 v249, s28, v249
    v_mul_f32 v184, s28, v184
    v_cvt_pk_bf16_f32 v184, v249, v184
    v_accvgpr_write_b32 a88, v184
    v_lshlrev_b32 v250, 16, v185
    v_and_b32 v185, s31, v185
    v_mul_f32 v250, s28, v250
    v_mul_f32 v185, s28, v185
    v_cvt_pk_bf16_f32 v185, v250, v185
    v_accvgpr_write_b32 a89, v185
    v_lshlrev_b32 v249, 16, v186
    v_and_b32 v186, s31, v186
    v_mul_f32 v249, s28, v249
    v_mul_f32 v186, s28, v186
    v_cvt_pk_bf16_f32 v186, v249, v186
    v_accvgpr_write_b32 a90, v186
    v_lshlrev_b32 v250, 16, v187
    v_and_b32 v187, s31, v187
    v_mul_f32 v250, s28, v250
    v_mul_f32 v187, s28, v187
    v_cvt_pk_bf16_f32 v187, v250, v187
    v_accvgpr_write_b32 a91, v187
    v_mfma_f32_16x16x32_bf16 v[200:203], a[100:103], a[84:87], v[200:203]
    v_lshlrev_b32 v249, 16, v188
    v_and_b32 v188, s31, v188
    v_mul_f32 v249, s28, v249
    v_mul_f32 v188, s28, v188
    v_cvt_pk_bf16_f32 v188, v249, v188
    v_accvgpr_write_b32 a92, v188
    v_lshlrev_b32 v250, 16, v189
    v_and_b32 v189, s31, v189
    v_mul_f32 v250, s28, v250
    v_mul_f32 v189, s28, v189
    v_cvt_pk_bf16_f32 v189, v250, v189
    v_accvgpr_write_b32 a93, v189
    v_lshlrev_b32 v249, 16, v190
    v_and_b32 v190, s31, v190
    v_mul_f32 v249, s28, v249
    v_mul_f32 v190, s28, v190
    v_cvt_pk_bf16_f32 v190, v249, v190
    v_accvgpr_write_b32 a94, v190
    v_lshlrev_b32 v250, 16, v191
    v_and_b32 v191, s31, v191
    v_mul_f32 v250, s28, v250
    v_mul_f32 v191, s28, v191
    v_cvt_pk_bf16_f32 v191, v250, v191
    v_accvgpr_write_b32 a95, v191
    v_mfma_f32_16x16x32_bf16 v[200:203], a[104:107], a[88:91], v[200:203]
    v_add_f32 v204, v228, v204
    v_add_f32 v205, v228, v205
    v_add_f32 v206, v228, v206
    v_add_f32 v207, v228, v207
    v_exp_f32 v204, v204
    v_exp_f32 v205, v205
    v_exp_f32 v206, v206
    v_exp_f32 v207, v207
    v_mfma_f32_16x16x32_bf16 v[200:203], a[108:111], a[92:95], v[200:203]
    v_cvt_pk_bf16_f32 v214, v204, v205
    v_cvt_pk_bf16_f32 v215, v206, v207
    s_nop 1
    v_smfmac_f32_16x16x64_bf16 a[164:167], a[172:175], v[208:215], v240
    ds_read_b128 a[96:99], v241 offset:16896
    ds_read_b128 a[100:103], v241 offset:16960
    v_mfma_f32_16x16x32_bf16 v[96:99], a[128:131], v[212:215], 0
    ds_read_b128 a[104:107], v241 offset:17024
    v_min_f32 v229, -v244, -v245
    v_mfma_f32_16x16x32_bf16 v[100:103], a[132:135], v[212:215], 0
    v_min_f32 v230, -v244, -v245
    v_min_f32 v231, -v244, -v245
    v_mfma_f32_16x16x32_bf16 v[104:107], a[136:139], v[212:215], 0
    v_max3_f32 v244, v192, v193, v194
    v_max_f32 v244, v244, v195
    v_mfma_f32_16x16x32_bf16 v[108:111], a[140:143], v[212:215], 0
    v_max3_f32 v244, v244, v196, v197
    v_max3_f32 v244, v244, v198, v199
    v_mfma_f32_16x16x32_bf16 v[204:207], a[112:115], a[80:83], 0
    ds_read_b128 a[108:111], v241 offset:17088
    v_mov_b32 v245, v244
    v_mfma_f32_16x16x32_bf16 v[204:207], a[116:119], a[84:87], v[204:207]
    s_nop 0
    v_permlane16_swap_b32 v244, v245
    v_mfma_f32_16x16x32_bf16 v[204:207], a[120:123], a[88:91], v[204:207]
    v_max_f32 v244, v244, v245
    v_mov_b32 v245, v244
    v_mfma_f32_16x16x32_bf16 v[204:207], a[124:127], a[92:95], v[204:207]
    s_nop 0
    v_permlane32_swap_b32 v244, v245
    v_mfma_f32_16x16x32_bf16 v[112:115], a[144:147], v[212:215], 0
    v_min_f32 v232, -v244, -v245
    v_add_f32 v192, v232, v192
    v_mfma_f32_16x16x32_bf16 v[116:119], a[148:151], v[212:215], 0
    v_add_f32 v193, v232, v193
    v_add_f32 v194, v232, v194
    v_mfma_f32_16x16x32_bf16 v[120:123], a[152:155], v[212:215], 0
    s_add_u32 m0, s24, 0
    v_add_f32 v195, v232, v195
    v_exp_f32 v192, v192
    v_exp_f32 v193, v193
    v_exp_f32 v194, v194
    v_exp_f32 v195, v195
    v_mfma_f32_16x16x32_bf16 v[124:127], a[156:159], v[212:215], 0
    s_waitcnt lgkmcnt(3)
    v_cvt_pk_bf16_f32 v208, v192, v193
    v_cvt_pk_bf16_f32 v209, v194, v195
    v_mfma_f32_16x16x32_bf16 v[192:195], a[96:99], a[0:3], v[216:219]
    s_waitcnt lgkmcnt(2)
    v_add_f32 v196, v232, v196
    v_add_f32 v197, v232, v197
    v_mfma_f32_16x16x32_bf16 v[192:195], a[100:103], a[4:7], v[192:195]
    s_waitcnt lgkmcnt(1)
    ds_read_b128 a[112:115], v241 offset:17408
    v_add_f32 v198, v232, v198
    v_add_f32 v199, v232, v199
    v_exp_f32 v196, v196
    v_exp_f32 v197, v197
    v_exp_f32 v198, v198
    v_exp_f32 v199, v199
    v_mfma_f32_16x16x32_bf16 v[192:195], a[104:107], a[8:11], v[192:195]
    s_waitcnt lgkmcnt(1)
    ds_read_b128 a[116:119], v241 offset:17472
    v_cvt_pk_bf16_f32 v210, v196, v197
    v_cvt_pk_bf16_f32 v211, v198, v199
    v_mfma_f32_16x16x32_bf16 v[192:195], a[108:111], a[12:15], v[192:195]
    ds_read_b128 a[120:123], v241 offset:17536
    ds_read_b128 a[124:127], v241 offset:17600
    v_mfma_f32_16x16x32_bf16 v[128:131], a[128:131], v[208:211], 0
    buffer_load_dwordx4 v243, s[4:7], s20 offen nt lds
    v_mfma_f32_16x16x32_bf16 v[132:135], a[132:135], v[208:211], 0
    s_add_u32 m0, s24, 32
    v_min_f32 v233, -v244, -v245
    v_min_f32 v234, -v244, -v245
    v_mfma_f32_16x16x32_bf16 v[136:139], a[136:139], v[208:211], 0
    buffer_load_dwordx4 v243, s[4:7], s20 offen offset:1024 nt lds
    v_mfma_f32_16x16x32_bf16 v[140:143], a[140:143], v[208:211], 0
    s_waitcnt lgkmcnt(3)
    v_min_f32 v235, -v244, -v245
    v_max3_f32 v244, v200, v201, v202
    v_mfma_f32_16x16x32_bf16 v[196:199], a[112:115], a[0:3], v[216:219]
    s_waitcnt lgkmcnt(2)
    v_max_f32 v244, v244, v203
    v_max3_f32 v244, v244, v204, v205
    v_mfma_f32_16x16x32_bf16 v[196:199], a[116:119], a[4:7], v[196:199]
    s_waitcnt lgkmcnt(1)
    v_max3_f32 v244, v244, v206, v207
    v_mov_b32 v245, v244
    v_mfma_f32_16x16x32_bf16 v[196:199], a[120:123], a[8:11], v[196:199]
    s_waitcnt lgkmcnt(0)
    v_permlane16_swap_b32 v244, v245
    v_mfma_f32_16x16x32_bf16 v[196:199], a[124:127], a[12:15], v[196:199]
    s_add_u32 m0, s24, 8448
    v_max_f32 v244, v244, v245
    v_mov_b32 v245, v244
    v_mfma_f32_16x16x32_bf16 v[144:147], a[144:147], v[208:211], 0
    buffer_load_dwordx4 v243, s[8:11], s20 offen nt lds
    v_mfma_f32_16x16x32_bf16 v[148:151], a[148:151], v[208:211], 0
    s_add_u32 m0, s24, 8456
    v_permlane32_swap_b32 v244, v245
    v_mfma_f32_16x16x32_bf16 v[152:155], a[152:155], v[208:211], 0
    buffer_load_dwordx4 v243, s[8:11], s20 offen offset:1024 nt lds
    v_min_f32 v236, -v244, -v245
    v_add_f32 v200, v236, v200
    v_add_f32 v201, v236, v201
    v_add_f32 v202, v236, v202
    v_add_f32 v203, v236, v203
    v_exp_f32 v200, v200
    v_exp_f32 v201, v201
    v_exp_f32 v202, v202
    v_exp_f32 v203, v203
    v_mfma_f32_16x16x32_bf16 v[156:159], a[156:159], v[208:211], 0
    v_cvt_pk_bf16_f32 v212, v200, v201
    v_cvt_pk_bf16_f32 v213, v202, v203
    v_mfma_f32_16x16x32_bf16 v[200:203], a[96:99], a[16:19], v[220:223]
    v_add_f32 v204, v236, v204
    v_add_f32 v205, v236, v205
    v_mfma_f32_16x16x32_bf16 v[200:203], a[100:103], a[20:23], v[200:203]
    v_exp_f32 v192, v192
    v_mfma_f32_16x16x32_bf16 v[200:203], a[104:107], a[24:27], v[200:203]
    v_add_f32 v206, v236, v206
    v_add_f32 v207, v236, v207
    v_exp_f32 v204, v204
    v_exp_f32 v205, v205
    v_exp_f32 v206, v206
    v_exp_f32 v207, v207
    v_mfma_f32_16x16x32_bf16 v[200:203], a[108:111], a[28:31], v[200:203]
    v_exp_f32 v193, v193
    v_cvt_pk_bf16_f32 v214, v204, v205
    v_cvt_pk_bf16_f32 v215, v206, v207
    s_nop 1
    v_smfmac_f32_16x16x64_bf16 a[168:171], a[172:175], v[208:215], v240
    v_min_f32 v237, -v244, -v245
    v_min_f32 v238, -v244, -v245
    v_mfma_f32_16x16x32_bf16 v[160:163], a[128:131], v[212:215], 0
    ds_read_b64_tr_b16 a[128:129], v242 offset:16896
    ds_read_b64_tr_b16 a[130:131], v242 offset:17408
    v_mfma_f32_16x16x32_bf16 v[164:167], a[132:135], v[212:215], 0
    v_exp_f32 v194, v194
    v_mfma_f32_16x16x32_bf16 v[168:171], a[136:139], v[212:215], 0
    ds_read_b64_tr_b16 a[132:133], v242 offset:16904
    ds_read_b64_tr_b16 a[134:135], v242 offset:17416
    v_mfma_f32_16x16x32_bf16 v[172:175], a[140:143], v[212:215], 0
    v_exp_f32 v195, v195
    v_mfma_f32_16x16x32_bf16 v[204:207], a[112:115], a[16:19], v[220:223]
    v_cvt_pk_bf16_f32 v208, v192, v193
    v_cvt_pk_bf16_f32 v209, v194, v195
    v_mfma_f32_16x16x32_bf16 v[204:207], a[116:119], a[20:23], v[204:207]
    v_exp_f32 v196, v196
    v_mfma_f32_16x16x32_bf16 v[204:207], a[120:123], a[24:27], v[204:207]
    ds_read_b64_tr_b16 a[136:137], v242 offset:16960
    ds_read_b64_tr_b16 a[138:139], v242 offset:17472
    v_mfma_f32_16x16x32_bf16 v[204:207], a[124:127], a[28:31], v[204:207]
    v_exp_f32 v197, v197
    v_mfma_f32_16x16x32_bf16 v[176:179], a[144:147], v[212:215], 0
    ds_read_b64_tr_b16 a[140:141], v242 offset:16968
    ds_read_b64_tr_b16 a[142:143], v242 offset:17480
    v_mfma_f32_16x16x32_bf16 v[180:183], a[148:151], v[212:215], 0
    v_exp_f32 v198, v198
    v_mfma_f32_16x16x32_bf16 v[184:187], a[152:155], v[212:215], 0
    ds_read_b64_tr_b16 a[144:145], v242 offset:17024
    ds_read_b64_tr_b16 a[146:147], v242 offset:17536
    v_mfma_f32_16x16x32_bf16 v[188:191], a[156:159], v[212:215], 0
    v_exp_f32 v199, v199
    v_mfma_f32_16x16x32_bf16 v[192:195], a[96:99], a[32:35], v[224:227]
    v_cvt_pk_bf16_f32 v210, v196, v197
    v_cvt_pk_bf16_f32 v211, v198, v199
    v_mfma_f32_16x16x32_bf16 v[192:195], a[100:103], a[36:39], v[192:195]
    v_exp_f32 v200, v200
    v_mfma_f32_16x16x32_bf16 v[192:195], a[104:107], a[40:43], v[192:195]
    s_add_u32 s44, s44, 1
    ds_read_b64_tr_b16 a[148:149], v242 offset:17032
    ds_read_b64_tr_b16 a[150:151], v242 offset:17544
    v_mfma_f32_16x16x32_bf16 v[192:195], a[108:111], a[44:47], v[192:195]
    s_waitcnt lgkmcnt(10)
    v_exp_f32 v201, v201
    v_mfma_f32_16x16x32_bf16 v[0:3], a[128:131], v[208:211], v[0:3]
    s_waitcnt lgkmcnt(8)
    ds_read_b64_tr_b16 a[152:153], v242 offset:17088
    ds_read_b64_tr_b16 a[154:155], v242 offset:17600
    v_mfma_f32_16x16x32_bf16 v[4:7], a[132:135], v[208:211], v[4:7]
    s_waitcnt lgkmcnt(8)
    v_exp_f32 v202, v202
    v_mfma_f32_16x16x32_bf16 v[8:11], a[136:139], v[208:211], v[8:11]
    s_waitcnt lgkmcnt(6)
    ds_read_b64_tr_b16 a[156:157], v242 offset:17096
    ds_read_b64_tr_b16 a[158:159], v242 offset:17608
    v_mfma_f32_16x16x32_bf16 v[12:15], a[140:143], v[208:211], v[12:15]
    s_add_u32 s45, s45, 1056
    v_exp_f32 v203, v203
    v_mfma_f32_16x16x32_bf16 v[196:199], a[112:115], a[32:35], v[224:227]
    s_add_u32 s47, s47, 1024
    v_cvt_pk_bf16_f32 v212, v200, v201
    v_cvt_pk_bf16_f32 v213, v202, v203
    v_mfma_f32_16x16x32_bf16 v[196:199], a[116:119], a[36:39], v[196:199]
    s_sub_u32 s46, s44, 24
    v_exp_f32 v204, v204
    v_mfma_f32_16x16x32_bf16 v[196:199], a[120:123], a[40:43], v[196:199]
    s_ashr_i32 s46, s46, 31
    v_min_f32 v239, -v244, -v245
    v_add_u32 v249, s63, v243
    v_mfma_f32_16x16x32_bf16 v[196:199], a[124:127], a[44:47], v[196:199]
    s_waitcnt lgkmcnt(6)
    v_exp_f32 v205, v205
    v_mfma_f32_16x16x32_bf16 v[16:19], a[144:147], v[208:211], v[16:19]
    s_waitcnt lgkmcnt(4)
    v_mfma_f32_16x16x32_bf16 v[20:23], a[148:151], v[208:211], v[20:23]
    s_waitcnt lgkmcnt(2)
    v_exp_f32 v206, v206
    v_mfma_f32_16x16x32_bf16 v[24:27], a[152:155], v[208:211], v[24:27]
    s_waitcnt lgkmcnt(0)
    v_mfma_f32_16x16x32_bf16 v[28:31], a[156:159], v[208:211], v[28:31]
    s_and_b32 s48, s45, s46
    v_exp_f32 v207, v207
    v_mfma_f32_16x16x32_bf16 v[200:203], a[96:99], a[48:51], v[228:231]
    s_andn2_b32 s49, 0x40000000, s46
    v_cvt_pk_bf16_f32 v214, v204, v205
    v_cvt_pk_bf16_f32 v215, v206, v207
    v_mfma_f32_16x16x32_bf16 v[200:203], a[100:103], a[52:55], v[200:203]
    s_or_b32 s49, s49, s47
    v_exp_f32 v192, v192
    v_mfma_f32_16x16x32_bf16 v[200:203], a[104:107], a[56:59], v[200:203]
    s_add_u32 s20, s20, 8192
    v_mfma_f32_16x16x32_bf16 v[200:203], a[108:111], a[60:63], v[200:203]
    v_exp_f32 v193, v193
    v_smfmac_f32_16x16x64_bf16 a[160:163], a[172:175], v[208:215], v240
    v_mfma_f32_16x16x32_bf16 v[32:35], a[128:131], v[212:215], v[32:35]
    v_mfma_f32_16x16x32_bf16 v[36:39], a[132:135], v[212:215], v[36:39]
    v_exp_f32 v194, v194
    v_mfma_f32_16x16x32_bf16 v[40:43], a[136:139], v[212:215], v[40:43]
    v_mfma_f32_16x16x32_bf16 v[44:47], a[140:143], v[212:215], v[44:47]
    v_exp_f32 v195, v195
    v_mfma_f32_16x16x32_bf16 v[204:207], a[112:115], a[48:51], v[228:231]
    v_cvt_pk_bf16_f32 v208, v192, v193
    v_cvt_pk_bf16_f32 v209, v194, v195
    v_mfma_f32_16x16x32_bf16 v[204:207], a[116:119], a[52:55], v[204:207]
    v_exp_f32 v196, v196
    v_mfma_f32_16x16x32_bf16 v[204:207], a[120:123], a[56:59], v[204:207]
    v_mfma_f32_16x16x32_bf16 v[204:207], a[124:127], a[60:63], v[204:207]
    v_exp_f32 v197, v197
    v_mfma_f32_16x16x32_bf16 v[48:51], a[144:147], v[212:215], v[48:51]
    v_mfma_f32_16x16x32_bf16 v[52:55], a[148:151], v[212:215], v[52:55]
    v_exp_f32 v198, v198
    v_mfma_f32_16x16x32_bf16 v[56:59], a[152:155], v[212:215], v[56:59]
    v_mfma_f32_16x16x32_bf16 v[60:63], a[156:159], v[212:215], v[60:63]
    v_exp_f32 v199, v199
    v_mfma_f32_16x16x32_bf16 v[192:195], a[96:99], a[64:67], v[232:235]
    v_cvt_pk_bf16_f32 v210, v196, v197
    v_cvt_pk_bf16_f32 v211, v198, v199
    v_mfma_f32_16x16x32_bf16 v[192:195], a[100:103], a[68:71], v[192:195]
    v_exp_f32 v200, v200
    v_mfma_f32_16x16x32_bf16 v[192:195], a[104:107], a[72:75], v[192:195]
    v_mfma_f32_16x16x32_bf16 v[192:195], a[108:111], a[76:79], v[192:195]
    v_exp_f32 v201, v201
    v_mfma_f32_16x16x32_bf16 v[64:67], a[128:131], v[208:211], v[64:67]
    v_mfma_f32_16x16x32_bf16 v[68:71], a[132:135], v[208:211], v[68:71]
    v_exp_f32 v202, v202
    v_mfma_f32_16x16x32_bf16 v[72:75], a[136:139], v[208:211], v[72:75]
    v_mfma_f32_16x16x32_bf16 v[76:79], a[140:143], v[208:211], v[76:79]
    v_exp_f32 v203, v203
    v_mfma_f32_16x16x32_bf16 v[196:199], a[112:115], a[64:67], v[232:235]
    v_cvt_pk_bf16_f32 v212, v200, v201
    v_cvt_pk_bf16_f32 v213, v202, v203
    v_mfma_f32_16x16x32_bf16 v[196:199], a[116:119], a[68:71], v[196:199]
    v_exp_f32 v204, v204
    v_mfma_f32_16x16x32_bf16 v[196:199], a[120:123], a[72:75], v[196:199]
    v_mfma_f32_16x16x32_bf16 v[196:199], a[124:127], a[76:79], v[196:199]
    v_exp_f32 v205, v205
    v_mfma_f32_16x16x32_bf16 v[80:83], a[144:147], v[208:211], v[80:83]
    v_mfma_f32_16x16x32_bf16 v[84:87], a[148:151], v[208:211], v[84:87]
    s_waitcnt vmcnt(4)
    v_exp_f32 v206, v206
    v_mfma_f32_16x16x32_bf16 v[88:91], a[152:155], v[208:211], v[88:91]
    s_barrier
    v_mfma_f32_16x16x32_bf16 v[92:95], a[156:159], v[208:211], v[92:95]
    v_exp_f32 v207, v207
    v_mfma_f32_16x16x32_bf16 v[200:203], a[96:99], a[80:83], v[236:239]
    v_cvt_pk_bf16_f32 v214, v204, v205
    v_cvt_pk_bf16_f32 v215, v206, v207
    v_mfma_f32_16x16x32_bf16 v[200:203], a[100:103], a[84:87], v[200:203]
    v_exp_f32 v192, v192
    v_mfma_f32_16x16x32_bf16 v[200:203], a[104:107], a[88:91], v[200:203]
    ds_read_b128 a[96:99], v241 offset:33792
    ds_read_b128 a[100:103], v241 offset:33856
    v_mfma_f32_16x16x32_bf16 v[200:203], a[108:111], a[92:95], v[200:203]
    v_exp_f32 v193, v193
    v_smfmac_f32_16x16x64_bf16 a[164:167], a[172:175], v[208:215], v240
    ds_read_b128 a[104:107], v241 offset:33920
    ds_read_b128 a[108:111], v241 offset:33984
    v_mfma_f32_16x16x32_bf16 v[96:99], a[128:131], v[212:215], v[96:99]
    v_mfma_f32_16x16x32_bf16 v[100:103], a[132:135], v[212:215], v[100:103]
    v_exp_f32 v194, v194
    v_mfma_f32_16x16x32_bf16 v[104:107], a[136:139], v[212:215], v[104:107]
    v_mfma_f32_16x16x32_bf16 v[108:111], a[140:143], v[212:215], v[108:111]
    v_exp_f32 v195, v195
    v_mfma_f32_16x16x32_bf16 v[204:207], a[112:115], a[80:83], v[236:239]
    v_cvt_pk_bf16_f32 v208, v192, v193
    v_cvt_pk_bf16_f32 v209, v194, v195
    v_mfma_f32_16x16x32_bf16 v[204:207], a[116:119], a[84:87], v[204:207]
    v_exp_f32 v196, v196
    v_mfma_f32_16x16x32_bf16 v[204:207], a[120:123], a[88:91], v[204:207]
    ds_read_b128 a[112:115], v241 offset:34304
    ds_read_b128 a[116:119], v241 offset:34368
    v_mfma_f32_16x16x32_bf16 v[204:207], a[124:127], a[92:95], v[204:207]
    v_exp_f32 v197, v197
    v_mfma_f32_16x16x32_bf16 v[112:115], a[144:147], v[212:215], v[112:115]
    ds_read_b128 a[120:123], v241 offset:34432
    ds_read_b128 a[124:127], v241 offset:34496
    v_mfma_f32_16x16x32_bf16 v[116:119], a[148:151], v[212:215], v[116:119]
    s_add_u32 m0, s48, 50688
    v_exp_f32 v198, v198
    v_mfma_f32_16x16x32_bf16 v[120:123], a[152:155], v[212:215], v[120:123]
    buffer_load_dwordx4 v243, s[12:15], s49 offen nt lds
    v_mfma_f32_16x16x32_bf16 v[124:127], a[156:159], v[212:215], v[124:127]
    s_waitcnt lgkmcnt(7)
    v_exp_f32 v199, v199
    v_mfma_f32_16x16x32_bf16 v[192:195], a[96:99], a[0:3], v[216:219]
    s_waitcnt lgkmcnt(6)
    v_cvt_pk_bf16_f32 v210, v196, v197
    v_cvt_pk_bf16_f32 v211, v198, v199
    v_mfma_f32_16x16x32_bf16 v[192:195], a[100:103], a[4:7], v[192:195]
    s_waitcnt lgkmcnt(5)
    v_exp_f32 v200, v200
    v_mfma_f32_16x16x32_bf16 v[192:195], a[104:107], a[8:11], v[192:195]
    s_waitcnt lgkmcnt(4)
    v_mfma_f32_16x16x32_bf16 v[192:195], a[108:111], a[12:15], v[192:195]
    s_add_u32 m0, s24, 16896
    v_exp_f32 v201, v201
    v_mfma_f32_16x16x32_bf16 v[128:131], a[128:131], v[208:211], v[128:131]
    buffer_load_dwordx4 v243, s[4:7], s20 offen nt lds
    v_mfma_f32_16x16x32_bf16 v[132:135], a[132:135], v[208:211], v[132:135]
    s_add_u32 m0, s24, 16928
    v_exp_f32 v202, v202
    v_mfma_f32_16x16x32_bf16 v[136:139], a[136:139], v[208:211], v[136:139]
    buffer_load_dwordx4 v243, s[4:7], s20 offen offset:1024 nt lds
    v_mfma_f32_16x16x32_bf16 v[140:143], a[140:143], v[208:211], v[140:143]
    s_waitcnt lgkmcnt(3)
    v_exp_f32 v203, v203
    v_mfma_f32_16x16x32_bf16 v[196:199], a[112:115], a[0:3], v[216:219]
    s_waitcnt lgkmcnt(2)
    v_cvt_pk_bf16_f32 v212, v200, v201
    v_cvt_pk_bf16_f32 v213, v202, v203
    v_mfma_f32_16x16x32_bf16 v[196:199], a[116:119], a[4:7], v[196:199]
    s_waitcnt lgkmcnt(1)
    v_exp_f32 v204, v204
    v_mfma_f32_16x16x32_bf16 v[196:199], a[120:123], a[8:11], v[196:199]
    s_waitcnt lgkmcnt(0)
    v_mfma_f32_16x16x32_bf16 v[196:199], a[124:127], a[12:15], v[196:199]
    s_add_u32 m0, s24, 25344
    v_exp_f32 v205, v205
    v_mfma_f32_16x16x32_bf16 v[144:147], a[144:147], v[208:211], v[144:147]
    buffer_load_dwordx4 v243, s[8:11], s20 offen nt lds
    v_mfma_f32_16x16x32_bf16 v[148:151], a[148:151], v[208:211], v[148:151]
    s_add_u32 m0, s24, 25352
    v_exp_f32 v206, v206
    v_mfma_f32_16x16x32_bf16 v[152:155], a[152:155], v[208:211], v[152:155]
    buffer_load_dwordx4 v243, s[8:11], s20 offen offset:1024 nt lds
    v_mfma_f32_16x16x32_bf16 v[156:159], a[156:159], v[208:211], v[156:159]
    v_exp_f32 v207, v207
    v_mfma_f32_16x16x32_bf16 v[200:203], a[96:99], a[16:19], v[220:223]
    s_mov_b32 s38, 8
L_loop0:
    v_cvt_pk_bf16_f32 v214, v204, v205
    v_cvt_pk_bf16_f32 v215, v206, v207
    v_mfma_f32_16x16x32_bf16 v[200:203], a[100:103], a[20:23], v[200:203]
    v_exp_f32 v192, v192
    v_mfma_f32_16x16x32_bf16 v[200:203], a[104:107], a[24:27], v[200:203]
    v_mfma_f32_16x16x32_bf16 v[200:203], a[108:111], a[28:31], v[200:203]
    v_exp_f32 v193, v193
    v_smfmac_f32_16x16x64_bf16 a[168:171], a[172:175], v[208:215], v240
    v_mfma_f32_16x16x32_bf16 v[160:163], a[128:131], v[212:215], v[160:163]
    ds_read_b64_tr_b16 a[128:129], v242 offset:33792
    ds_read_b64_tr_b16 a[130:131], v242 offset:34304
    v_mfma_f32_16x16x32_bf16 v[164:167], a[132:135], v[212:215], v[164:167]
    v_exp_f32 v194, v194
    v_mfma_f32_16x16x32_bf16 v[168:171], a[136:139], v[212:215], v[168:171]
    ds_read_b64_tr_b16 a[132:133], v242 offset:33800
    ds_read_b64_tr_b16 a[134:135], v242 offset:34312
    v_mfma_f32_16x16x32_bf16 v[172:175], a[140:143], v[212:215], v[172:175]
    v_exp_f32 v195, v195
    v_mfma_f32_16x16x32_bf16 v[204:207], a[112:115], a[16:19], v[220:223]
    v_cvt_pk_bf16_f32 v208, v192, v193
    v_cvt_pk_bf16_f32 v209, v194, v195
    v_mfma_f32_16x16x32_bf16 v[204:207], a[116:119], a[20:23], v[204:207]
    v_exp_f32 v196, v196
    v_mfma_f32_16x16x32_bf16 v[204:207], a[120:123], a[24:27], v[204:207]
    ds_read_b64_tr_b16 a[136:137], v242 offset:33856
    ds_read_b64_tr_b16 a[138:139], v242 offset:34368
    v_mfma_f32_16x16x32_bf16 v[204:207], a[124:127], a[28:31], v[204:207]
    v_exp_f32 v197, v197
    v_mfma_f32_16x16x32_bf16 v[176:179], a[144:147], v[212:215], v[176:179]
    ds_read_b64_tr_b16 a[140:141], v242 offset:33864
    ds_read_b64_tr_b16 a[142:143], v242 offset:34376
    v_mfma_f32_16x16x32_bf16 v[180:183], a[148:151], v[212:215], v[180:183]
    v_exp_f32 v198, v198
    v_mfma_f32_16x16x32_bf16 v[184:187], a[152:155], v[212:215], v[184:187]
    ds_read_b64_tr_b16 a[144:145], v242 offset:33920
    ds_read_b64_tr_b16 a[146:147], v242 offset:34432
    v_mfma_f32_16x16x32_bf16 v[188:191], a[156:159], v[212:215], v[188:191]
    v_exp_f32 v199, v199
    v_mfma_f32_16x16x32_bf16 v[192:195], a[96:99], a[32:35], v[224:227]
    v_cvt_pk_bf16_f32 v210, v196, v197
    v_cvt_pk_bf16_f32 v211, v198, v199
    v_mfma_f32_16x16x32_bf16 v[192:195], a[100:103], a[36:39], v[192:195]
    v_exp_f32 v200, v200
    v_mfma_f32_16x16x32_bf16 v[192:195], a[104:107], a[40:43], v[192:195]
    s_add_u32 s44, s44, 1
    ds_read_b64_tr_b16 a[148:149], v242 offset:33928
    ds_read_b64_tr_b16 a[150:151], v242 offset:34440
    v_mfma_f32_16x16x32_bf16 v[192:195], a[108:111], a[44:47], v[192:195]
    s_waitcnt lgkmcnt(10)
    v_exp_f32 v201, v201
    v_mfma_f32_16x16x32_bf16 v[0:3], a[128:131], v[208:211], v[0:3]
    s_waitcnt lgkmcnt(8)
    ds_read_b64_tr_b16 a[152:153], v242 offset:33984
    ds_read_b64_tr_b16 a[154:155], v242 offset:34496
    v_mfma_f32_16x16x32_bf16 v[4:7], a[132:135], v[208:211], v[4:7]
    s_waitcnt lgkmcnt(8)
    v_exp_f32 v202, v202
    v_mfma_f32_16x16x32_bf16 v[8:11], a[136:139], v[208:211], v[8:11]
    s_waitcnt lgkmcnt(6)
    ds_read_b64_tr_b16 a[156:157], v242 offset:33992
    ds_read_b64_tr_b16 a[158:159], v242 offset:34504
    v_mfma_f32_16x16x32_bf16 v[12:15], a[140:143], v[208:211], v[12:15]
    s_add_u32 s45, s45, 1056
    v_exp_f32 v203, v203
    v_mfma_f32_16x16x32_bf16 v[196:199], a[112:115], a[32:35], v[224:227]
    s_add_u32 s47, s47, 1024
    v_cvt_pk_bf16_f32 v212, v200, v201
    v_cvt_pk_bf16_f32 v213, v202, v203
    v_mfma_f32_16x16x32_bf16 v[196:199], a[116:119], a[36:39], v[196:199]
    s_sub_u32 s46, s44, 24
    v_exp_f32 v204, v204
    v_mfma_f32_16x16x32_bf16 v[196:199], a[120:123], a[40:43], v[196:199]
    s_ashr_i32 s46, s46, 31
    ds_read_b128 v[244:247], v249
    v_mfma_f32_16x16x32_bf16 v[196:199], a[124:127], a[44:47], v[196:199]
    s_waitcnt lgkmcnt(7)
    v_exp_f32 v205, v205
    v_mfma_f32_16x16x32_bf16 v[16:19], a[144:147], v[208:211], v[16:19]
    s_waitcnt lgkmcnt(5)
    v_mfma_f32_16x16x32_bf16 v[20:23], a[148:151], v[208:211], v[20:23]
    s_waitcnt lgkmcnt(3)
    v_exp_f32 v206, v206
    v_mfma_f32_16x16x32_bf16 v[24:27], a[152:155], v[208:211], v[24:27]
    s_waitcnt lgkmcnt(1)
    v_mfma_f32_16x16x32_bf16 v[28:31], a[156:159], v[208:211], v[28:31]
    s_and_b32 s48, s45, s46
    v_exp_f32 v207, v207
    v_mfma_f32_16x16x32_bf16 v[200:203], a[96:99], a[48:51], v[228:231]
    s_andn2_b32 s49, 0x40000000, s46
    v_cvt_pk_bf16_f32 v214, v204, v205
    v_cvt_pk_bf16_f32 v215, v206, v207
    v_mfma_f32_16x16x32_bf16 v[200:203], a[100:103], a[52:55], v[200:203]
    s_or_b32 s49, s49, s47
    v_exp_f32 v192, v192
    v_mfma_f32_16x16x32_bf16 v[200:203], a[104:107], a[56:59], v[200:203]
    s_add_u32 s20, s20, 8192
    v_mfma_f32_16x16x32_bf16 v[200:203], a[108:111], a[60:63], v[200:203]
    v_exp_f32 v193, v193
    v_smfmac_f32_16x16x64_bf16 a[160:163], a[172:175], v[208:215], v240
    v_mfma_f32_16x16x32_bf16 v[32:35], a[128:131], v[212:215], v[32:35]
    s_waitcnt lgkmcnt(0)
    v_lshlrev_b32 v248, 16, v244
    v_and_b32 v244, s31, v244
    v_mfma_f32_16x16x32_bf16 v[36:39], a[132:135], v[212:215], v[36:39]
    v_exp_f32 v194, v194
    v_mfma_f32_16x16x32_bf16 v[40:43], a[136:139], v[212:215], v[40:43]
    v_mul_f32 v248, s28, v248
    v_mul_f32 v244, s28, v244
    v_mfma_f32_16x16x32_bf16 v[44:47], a[140:143], v[212:215], v[44:47]
    v_exp_f32 v195, v195
    v_mfma_f32_16x16x32_bf16 v[204:207], a[112:115], a[48:51], v[228:231]
    v_cvt_pk_bf16_f32 v208, v192, v193
    v_cvt_pk_bf16_f32 v209, v194, v195
    v_mfma_f32_16x16x32_bf16 v[204:207], a[116:119], a[52:55], v[204:207]
    v_exp_f32 v196, v196
    v_mfma_f32_16x16x32_bf16 v[204:207], a[120:123], a[56:59], v[204:207]
    v_cvt_pk_bf16_f32 v244, v248, v244
    v_lshlrev_b32 v248, 16, v245
    v_mfma_f32_16x16x32_bf16 v[204:207], a[124:127], a[60:63], v[204:207]
    v_exp_f32 v197, v197
    v_mfma_f32_16x16x32_bf16 v[48:51], a[144:147], v[212:215], v[48:51]
    v_and_b32 v245, s31, v245
    v_mul_f32 v248, s28, v248
    v_mfma_f32_16x16x32_bf16 v[52:55], a[148:151], v[212:215], v[52:55]
    v_exp_f32 v198, v198
    v_mfma_f32_16x16x32_bf16 v[56:59], a[152:155], v[212:215], v[56:59]
    v_mul_f32 v245, s28, v245
    v_cvt_pk_bf16_f32 v245, v248, v245
    v_mfma_f32_16x16x32_bf16 v[60:63], a[156:159], v[212:215], v[60:63]
    v_exp_f32 v199, v199
    v_mfma_f32_16x16x32_bf16 v[192:195], a[96:99], a[64:67], v[232:235]
    v_cvt_pk_bf16_f32 v210, v196, v197
    v_cvt_pk_bf16_f32 v211, v198, v199
    v_mfma_f32_16x16x32_bf16 v[192:195], a[100:103], a[68:71], v[192:195]
    v_exp_f32 v200, v200
    v_mfma_f32_16x16x32_bf16 v[192:195], a[104:107], a[72:75], v[192:195]
    v_lshlrev_b32 v248, 16, v246
    v_and_b32 v246, s31, v246
    v_mfma_f32_16x16x32_bf16 v[192:195], a[108:111], a[76:79], v[192:195]
    v_exp_f32 v201, v201
    v_mfma_f32_16x16x32_bf16 v[64:67], a[128:131], v[208:211], v[64:67]
    v_mul_f32 v248, s28, v248
    v_mul_f32 v246, s28, v246
    v_mfma_f32_16x16x32_bf16 v[68:71], a[132:135], v[208:211], v[68:71]
    v_exp_f32 v202, v202
    v_mfma_f32_16x16x32_bf16 v[72:75], a[136:139], v[208:211], v[72:75]
    v_cvt_pk_bf16_f32 v246, v248, v246
    v_lshlrev_b32 v248, 16, v247
    v_mfma_f32_16x16x32_bf16 v[76:79], a[140:143], v[208:211], v[76:79]
    v_exp_f32 v203, v203
    v_mfma_f32_16x16x32_bf16 v[196:199], a[112:115], a[64:67], v[232:235]
    v_cvt_pk_bf16_f32 v212, v200, v201
    v_cvt_pk_bf16_f32 v213, v202, v203
    v_mfma_f32_16x16x32_bf16 v[196:199], a[116:119], a[68:71], v[196:199]
    v_exp_f32 v204, v204
    v_mfma_f32_16x16x32_bf16 v[196:199], a[120:123], a[72:75], v[196:199]
    v_and_b32 v247, s31, v247
    v_mul_f32 v248, s28, v248
    v_mfma_f32_16x16x32_bf16 v[196:199], a[124:127], a[76:79], v[196:199]
    v_exp_f32 v205, v205
    v_mfma_f32_16x16x32_bf16 v[80:83], a[144:147], v[208:211], v[80:83]
    v_mul_f32 v247, s28, v247
    v_cvt_pk_bf16_f32 v247, v248, v247
    v_mfma_f32_16x16x32_bf16 v[84:87], a[148:151], v[208:211], v[84:87]
    s_waitcnt vmcnt(5)
    v_exp_f32 v206, v206
    v_mfma_f32_16x16x32_bf16 v[88:91], a[152:155], v[208:211], v[88:91]
    s_barrier
    ds_write_b128 v249, v[244:247]
    v_mfma_f32_16x16x32_bf16 v[92:95], a[156:159], v[208:211], v[92:95]
    v_exp_f32 v207, v207
    v_mfma_f32_16x16x32_bf16 v[200:203], a[96:99], a[80:83], v[236:239]
    v_cvt_pk_bf16_f32 v214, v204, v205
    v_cvt_pk_bf16_f32 v215, v206, v207
    v_mfma_f32_16x16x32_bf16 v[200:203], a[100:103], a[84:87], v[200:203]
    v_exp_f32 v192, v192
    v_mfma_f32_16x16x32_bf16 v[200:203], a[104:107], a[88:91], v[200:203]
    ds_read_b128 a[96:99], v241 offset:0
    ds_read_b128 a[100:103], v241 offset:64
    v_mfma_f32_16x16x32_bf16 v[200:203], a[108:111], a[92:95], v[200:203]
    v_exp_f32 v193, v193
    v_smfmac_f32_16x16x64_bf16 a[164:167], a[172:175], v[208:215], v240
    ds_read_b128 a[104:107], v241 offset:128
    ds_read_b128 a[108:111], v241 offset:192
    v_mfma_f32_16x16x32_bf16 v[96:99], a[128:131], v[212:215], v[96:99]
    v_add_u32 v249, 1056, v249
    v_mfma_f32_16x16x32_bf16 v[100:103], a[132:135], v[212:215], v[100:103]
    v_exp_f32 v194, v194
    v_mfma_f32_16x16x32_bf16 v[104:107], a[136:139], v[212:215], v[104:107]
    v_mfma_f32_16x16x32_bf16 v[108:111], a[140:143], v[212:215], v[108:111]
    v_exp_f32 v195, v195
    v_mfma_f32_16x16x32_bf16 v[204:207], a[112:115], a[80:83], v[236:239]
    v_cvt_pk_bf16_f32 v208, v192, v193
    v_cvt_pk_bf16_f32 v209, v194, v195
    v_mfma_f32_16x16x32_bf16 v[204:207], a[116:119], a[84:87], v[204:207]
    v_exp_f32 v196, v196
    v_mfma_f32_16x16x32_bf16 v[204:207], a[120:123], a[88:91], v[204:207]
    ds_read_b128 a[112:115], v241 offset:512
    ds_read_b128 a[116:119], v241 offset:576
    v_mfma_f32_16x16x32_bf16 v[204:207], a[124:127], a[92:95], v[204:207]
    v_exp_f32 v197, v197
    v_mfma_f32_16x16x32_bf16 v[112:115], a[144:147], v[212:215], v[112:115]
    ds_read_b128 a[120:123], v241 offset:640
    ds_read_b128 a[124:127], v241 offset:704
    v_mfma_f32_16x16x32_bf16 v[116:119], a[148:151], v[212:215], v[116:119]
    s_add_u32 m0, s48, 50688
    v_exp_f32 v198, v198
    v_mfma_f32_16x16x32_bf16 v[120:123], a[152:155], v[212:215], v[120:123]
    buffer_load_dwordx4 v243, s[12:15], s49 offen nt lds
    v_mfma_f32_16x16x32_bf16 v[124:127], a[156:159], v[212:215], v[124:127]
    s_waitcnt lgkmcnt(7)
    v_exp_f32 v199, v199
    v_mfma_f32_16x16x32_bf16 v[192:195], a[96:99], a[0:3], v[216:219]
    s_waitcnt lgkmcnt(6)
    v_cvt_pk_bf16_f32 v210, v196, v197
    v_cvt_pk_bf16_f32 v211, v198, v199
    v_mfma_f32_16x16x32_bf16 v[192:195], a[100:103], a[4:7], v[192:195]
    s_waitcnt lgkmcnt(5)
    v_exp_f32 v200, v200
    v_mfma_f32_16x16x32_bf16 v[192:195], a[104:107], a[8:11], v[192:195]
    s_waitcnt lgkmcnt(4)
    v_mfma_f32_16x16x32_bf16 v[192:195], a[108:111], a[12:15], v[192:195]
    s_add_u32 m0, s24, 33792
    v_exp_f32 v201, v201
    v_mfma_f32_16x16x32_bf16 v[128:131], a[128:131], v[208:211], v[128:131]
    buffer_load_dwordx4 v243, s[4:7], s20 offen nt lds
    v_mfma_f32_16x16x32_bf16 v[132:135], a[132:135], v[208:211], v[132:135]
    s_add_u32 m0, s24, 33824
    v_exp_f32 v202, v202
    v_mfma_f32_16x16x32_bf16 v[136:139], a[136:139], v[208:211], v[136:139]
    buffer_load_dwordx4 v243, s[4:7], s20 offen offset:1024 nt lds
    v_mfma_f32_16x16x32_bf16 v[140:143], a[140:143], v[208:211], v[140:143]
    s_waitcnt lgkmcnt(3)
    v_exp_f32 v203, v203
    v_mfma_f32_16x16x32_bf16 v[196:199], a[112:115], a[0:3], v[216:219]
    s_waitcnt lgkmcnt(2)
    v_cvt_pk_bf16_f32 v212, v200, v201
    v_cvt_pk_bf16_f32 v213, v202, v203
    v_mfma_f32_16x16x32_bf16 v[196:199], a[116:119], a[4:7], v[196:199]
    s_waitcnt lgkmcnt(1)
    v_exp_f32 v204, v204
    v_mfma_f32_16x16x32_bf16 v[196:199], a[120:123], a[8:11], v[196:199]
    s_waitcnt lgkmcnt(0)
    v_mfma_f32_16x16x32_bf16 v[196:199], a[124:127], a[12:15], v[196:199]
    s_add_u32 m0, s24, 42240
    v_exp_f32 v205, v205
    v_mfma_f32_16x16x32_bf16 v[144:147], a[144:147], v[208:211], v[144:147]
    buffer_load_dwordx4 v243, s[8:11], s20 offen nt lds
    v_mfma_f32_16x16x32_bf16 v[148:151], a[148:151], v[208:211], v[148:151]
    s_add_u32 m0, s24, 42248
    v_exp_f32 v206, v206
    v_mfma_f32_16x16x32_bf16 v[152:155], a[152:155], v[208:211], v[152:155]
    buffer_load_dwordx4 v243, s[8:11], s20 offen offset:1024 nt lds
    v_mfma_f32_16x16x32_bf16 v[156:159], a[156:159], v[208:211], v[156:159]
    v_exp_f32 v207, v207
    v_mfma_f32_16x16x32_bf16 v[200:203], a[96:99], a[16:19], v[220:223]
    v_cvt_pk_bf16_f32 v214, v204, v205
    v_cvt_pk_bf16_f32 v215, v206, v207
    v_mfma_f32_16x16x32_bf16 v[200:203], a[100:103], a[20:23], v[200:203]
    v_exp_f32 v192, v192
    v_mfma_f32_16x16x32_bf16 v[200:203], a[104:107], a[24:27], v[200:203]
    v_mfma_f32_16x16x32_bf16 v[200:203], a[108:111], a[28:31], v[200:203]
    v_exp_f32 v193, v193
    v_smfmac_f32_16x16x64_bf16 a[168:171], a[172:175], v[208:215], v240
    v_mfma_f32_16x16x32_bf16 v[160:163], a[128:131], v[212:215], v[160:163]
    ds_read_b64_tr_b16 a[128:129], v242 offset:0
    ds_read_b64_tr_b16 a[130:131], v242 offset:512
    v_mfma_f32_16x16x32_bf16 v[164:167], a[132:135], v[212:215], v[164:167]
    v_exp_f32 v194, v194
    v_mfma_f32_16x16x32_bf16 v[168:171], a[136:139], v[212:215], v[168:171]
    ds_read_b64_tr_b16 a[132:133], v242 offset:8
    ds_read_b64_tr_b16 a[134:135], v242 offset:520
    v_mfma_f32_16x16x32_bf16 v[172:175], a[140:143], v[212:215], v[172:175]
    v_exp_f32 v195, v195
    v_mfma_f32_16x16x32_bf16 v[204:207], a[112:115], a[16:19], v[220:223]
    v_cvt_pk_bf16_f32 v208, v192, v193
    v_cvt_pk_bf16_f32 v209, v194, v195
    v_mfma_f32_16x16x32_bf16 v[204:207], a[116:119], a[20:23], v[204:207]
    v_exp_f32 v196, v196
    v_mfma_f32_16x16x32_bf16 v[204:207], a[120:123], a[24:27], v[204:207]
    ds_read_b64_tr_b16 a[136:137], v242 offset:64
    ds_read_b64_tr_b16 a[138:139], v242 offset:576
    v_mfma_f32_16x16x32_bf16 v[204:207], a[124:127], a[28:31], v[204:207]
    v_exp_f32 v197, v197
    v_mfma_f32_16x16x32_bf16 v[176:179], a[144:147], v[212:215], v[176:179]
    ds_read_b64_tr_b16 a[140:141], v242 offset:72
    ds_read_b64_tr_b16 a[142:143], v242 offset:584
    v_mfma_f32_16x16x32_bf16 v[180:183], a[148:151], v[212:215], v[180:183]
    v_exp_f32 v198, v198
    v_mfma_f32_16x16x32_bf16 v[184:187], a[152:155], v[212:215], v[184:187]
    ds_read_b64_tr_b16 a[144:145], v242 offset:128
    ds_read_b64_tr_b16 a[146:147], v242 offset:640
    v_mfma_f32_16x16x32_bf16 v[188:191], a[156:159], v[212:215], v[188:191]
    v_exp_f32 v199, v199
    v_mfma_f32_16x16x32_bf16 v[192:195], a[96:99], a[32:35], v[224:227]
    v_cvt_pk_bf16_f32 v210, v196, v197
    v_cvt_pk_bf16_f32 v211, v198, v199
    v_mfma_f32_16x16x32_bf16 v[192:195], a[100:103], a[36:39], v[192:195]
    v_exp_f32 v200, v200
    v_mfma_f32_16x16x32_bf16 v[192:195], a[104:107], a[40:43], v[192:195]
    s_add_u32 s44, s44, 1
    ds_read_b64_tr_b16 a[148:149], v242 offset:136
    ds_read_b64_tr_b16 a[150:151], v242 offset:648
    v_mfma_f32_16x16x32_bf16 v[192:195], a[108:111], a[44:47], v[192:195]
    s_waitcnt lgkmcnt(10)
    v_exp_f32 v201, v201
    v_mfma_f32_16x16x32_bf16 v[0:3], a[128:131], v[208:211], v[0:3]
    s_waitcnt lgkmcnt(8)
    ds_read_b64_tr_b16 a[152:153], v242 offset:192
    ds_read_b64_tr_b16 a[154:155], v242 offset:704
    v_mfma_f32_16x16x32_bf16 v[4:7], a[132:135], v[208:211], v[4:7]
    s_waitcnt lgkmcnt(8)
    v_exp_f32 v202, v202
    v_mfma_f32_16x16x32_bf16 v[8:11], a[136:139], v[208:211], v[8:11]
    s_waitcnt lgkmcnt(6)
    ds_read_b64_tr_b16 a[156:157], v242 offset:200
    ds_read_b64_tr_b16 a[158:159], v242 offset:712
    v_mfma_f32_16x16x32_bf16 v[12:15], a[140:143], v[208:211], v[12:15]
    s_add_u32 s45, s45, 1056
    v_exp_f32 v203, v203
    v_mfma_f32_16x16x32_bf16 v[196:199], a[112:115], a[32:35], v[224:227]
    s_add_u32 s47, s47, 1024
    v_cvt_pk_bf16_f32 v212, v200, v201
    v_cvt_pk_bf16_f32 v213, v202, v203
    v_mfma_f32_16x16x32_bf16 v[196:199], a[116:119], a[36:39], v[196:199]
    s_sub_u32 s46, s44, 24
    v_exp_f32 v204, v204
    v_mfma_f32_16x16x32_bf16 v[196:199], a[120:123], a[40:43], v[196:199]
    s_ashr_i32 s46, s46, 31
    ds_read_b128 v[244:247], v249
    v_mfma_f32_16x16x32_bf16 v[196:199], a[124:127], a[44:47], v[196:199]
    s_waitcnt lgkmcnt(7)
    v_exp_f32 v205, v205
    v_mfma_f32_16x16x32_bf16 v[16:19], a[144:147], v[208:211], v[16:19]
    s_waitcnt lgkmcnt(5)
    v_mfma_f32_16x16x32_bf16 v[20:23], a[148:151], v[208:211], v[20:23]
    s_waitcnt lgkmcnt(3)
    v_exp_f32 v206, v206
    v_mfma_f32_16x16x32_bf16 v[24:27], a[152:155], v[208:211], v[24:27]
    s_waitcnt lgkmcnt(1)
    v_mfma_f32_16x16x32_bf16 v[28:31], a[156:159], v[208:211], v[28:31]
    s_and_b32 s48, s45, s46
    v_exp_f32 v207, v207
    v_mfma_f32_16x16x32_bf16 v[200:203], a[96:99], a[48:51], v[228:231]
    s_andn2_b32 s49, 0x40000000, s46
    v_cvt_pk_bf16_f32 v214, v204, v205
    v_cvt_pk_bf16_f32 v215, v206, v207
    v_mfma_f32_16x16x32_bf16 v[200:203], a[100:103], a[52:55], v[200:203]
    s_or_b32 s49, s49, s47
    v_exp_f32 v192, v192
    v_mfma_f32_16x16x32_bf16 v[200:203], a[104:107], a[56:59], v[200:203]
    s_add_u32 s20, s20, 8192
    v_mfma_f32_16x16x32_bf16 v[200:203], a[108:111], a[60:63], v[200:203]
    v_exp_f32 v193, v193
    v_smfmac_f32_16x16x64_bf16 a[160:163], a[172:175], v[208:215], v240
    v_mfma_f32_16x16x32_bf16 v[32:35], a[128:131], v[212:215], v[32:35]
    s_waitcnt lgkmcnt(0)
    v_lshlrev_b32 v248, 16, v244
    v_and_b32 v244, s31, v244
    v_mfma_f32_16x16x32_bf16 v[36:39], a[132:135], v[212:215], v[36:39]
    v_exp_f32 v194, v194
    v_mfma_f32_16x16x32_bf16 v[40:43], a[136:139], v[212:215], v[40:43]
    v_mul_f32 v248, s28, v248
    v_mul_f32 v244, s28, v244
    v_mfma_f32_16x16x32_bf16 v[44:47], a[140:143], v[212:215], v[44:47]
    v_exp_f32 v195, v195
    v_mfma_f32_16x16x32_bf16 v[204:207], a[112:115], a[48:51], v[228:231]
    v_cvt_pk_bf16_f32 v208, v192, v193
    v_cvt_pk_bf16_f32 v209, v194, v195
    v_mfma_f32_16x16x32_bf16 v[204:207], a[116:119], a[52:55], v[204:207]
    v_exp_f32 v196, v196
    v_mfma_f32_16x16x32_bf16 v[204:207], a[120:123], a[56:59], v[204:207]
    v_cvt_pk_bf16_f32 v244, v248, v244
    v_lshlrev_b32 v248, 16, v245
    v_mfma_f32_16x16x32_bf16 v[204:207], a[124:127], a[60:63], v[204:207]
    v_exp_f32 v197, v197
    v_mfma_f32_16x16x32_bf16 v[48:51], a[144:147], v[212:215], v[48:51]
    v_and_b32 v245, s31, v245
    v_mul_f32 v248, s28, v248
    v_mfma_f32_16x16x32_bf16 v[52:55], a[148:151], v[212:215], v[52:55]
    v_exp_f32 v198, v198
    v_mfma_f32_16x16x32_bf16 v[56:59], a[152:155], v[212:215], v[56:59]
    v_mul_f32 v245, s28, v245
    v_cvt_pk_bf16_f32 v245, v248, v245
    v_mfma_f32_16x16x32_bf16 v[60:63], a[156:159], v[212:215], v[60:63]
    v_exp_f32 v199, v199
    v_mfma_f32_16x16x32_bf16 v[192:195], a[96:99], a[64:67], v[232:235]
    v_cvt_pk_bf16_f32 v210, v196, v197
    v_cvt_pk_bf16_f32 v211, v198, v199
    v_mfma_f32_16x16x32_bf16 v[192:195], a[100:103], a[68:71], v[192:195]
    v_exp_f32 v200, v200
    v_mfma_f32_16x16x32_bf16 v[192:195], a[104:107], a[72:75], v[192:195]
    v_lshlrev_b32 v248, 16, v246
    v_and_b32 v246, s31, v246
    v_mfma_f32_16x16x32_bf16 v[192:195], a[108:111], a[76:79], v[192:195]
    v_exp_f32 v201, v201
    v_mfma_f32_16x16x32_bf16 v[64:67], a[128:131], v[208:211], v[64:67]
    v_mul_f32 v248, s28, v248
    v_mul_f32 v246, s28, v246
    v_mfma_f32_16x16x32_bf16 v[68:71], a[132:135], v[208:211], v[68:71]
    v_exp_f32 v202, v202
    v_mfma_f32_16x16x32_bf16 v[72:75], a[136:139], v[208:211], v[72:75]
    v_cvt_pk_bf16_f32 v246, v248, v246
    v_lshlrev_b32 v248, 16, v247
    v_mfma_f32_16x16x32_bf16 v[76:79], a[140:143], v[208:211], v[76:79]
    v_exp_f32 v203, v203
    v_mfma_f32_16x16x32_bf16 v[196:199], a[112:115], a[64:67], v[232:235]
    v_cvt_pk_bf16_f32 v212, v200, v201
    v_cvt_pk_bf16_f32 v213, v202, v203
    v_mfma_f32_16x16x32_bf16 v[196:199], a[116:119], a[68:71], v[196:199]
    v_exp_f32 v204, v204
    v_mfma_f32_16x16x32_bf16 v[196:199], a[120:123], a[72:75], v[196:199]
    v_and_b32 v247, s31, v247
    v_mul_f32 v248, s28, v248
    v_mfma_f32_16x16x32_bf16 v[196:199], a[124:127], a[76:79], v[196:199]
    v_exp_f32 v205, v205
    v_mfma_f32_16x16x32_bf16 v[80:83], a[144:147], v[208:211], v[80:83]
    v_mul_f32 v247, s28, v247
    v_cvt_pk_bf16_f32 v247, v248, v247
    v_mfma_f32_16x16x32_bf16 v[84:87], a[148:151], v[208:211], v[84:87]
    s_waitcnt vmcnt(5)
    v_exp_f32 v206, v206
    v_mfma_f32_16x16x32_bf16 v[88:91], a[152:155], v[208:211], v[88:91]
    s_barrier
    ds_write_b128 v249, v[244:247]
    v_mfma_f32_16x16x32_bf16 v[92:95], a[156:159], v[208:211], v[92:95]
    v_exp_f32 v207, v207
    v_mfma_f32_16x16x32_bf16 v[200:203], a[96:99], a[80:83], v[236:239]
    v_cvt_pk_bf16_f32 v214, v204, v205
    v_cvt_pk_bf16_f32 v215, v206, v207
    v_mfma_f32_16x16x32_bf16 v[200:203], a[100:103], a[84:87], v[200:203]
    v_exp_f32 v192, v192
    v_mfma_f32_16x16x32_bf16 v[200:203], a[104:107], a[88:91], v[200:203]
    ds_read_b128 a[96:99], v241 offset:16896
    ds_read_b128 a[100:103], v241 offset:16960
    v_mfma_f32_16x16x32_bf16 v[200:203], a[108:111], a[92:95], v[200:203]
    v_exp_f32 v193, v193
    v_smfmac_f32_16x16x64_bf16 a[164:167], a[172:175], v[208:215], v240
    ds_read_b128 a[104:107], v241 offset:17024
    ds_read_b128 a[108:111], v241 offset:17088
    v_mfma_f32_16x16x32_bf16 v[96:99], a[128:131], v[212:215], v[96:99]
    v_add_u32 v249, 1056, v249
    v_mfma_f32_16x16x32_bf16 v[100:103], a[132:135], v[212:215], v[100:103]
    v_exp_f32 v194, v194
    v_mfma_f32_16x16x32_bf16 v[104:107], a[136:139], v[212:215], v[104:107]
    v_mfma_f32_16x16x32_bf16 v[108:111], a[140:143], v[212:215], v[108:111]
    v_exp_f32 v195, v195
    v_mfma_f32_16x16x32_bf16 v[204:207], a[112:115], a[80:83], v[236:239]
    v_cvt_pk_bf16_f32 v208, v192, v193
    v_cvt_pk_bf16_f32 v209, v194, v195
    v_mfma_f32_16x16x32_bf16 v[204:207], a[116:119], a[84:87], v[204:207]
    v_exp_f32 v196, v196
    v_mfma_f32_16x16x32_bf16 v[204:207], a[120:123], a[88:91], v[204:207]
    ds_read_b128 a[112:115], v241 offset:17408
    ds_read_b128 a[116:119], v241 offset:17472
    v_mfma_f32_16x16x32_bf16 v[204:207], a[124:127], a[92:95], v[204:207]
    v_exp_f32 v197, v197
    v_mfma_f32_16x16x32_bf16 v[112:115], a[144:147], v[212:215], v[112:115]
    ds_read_b128 a[120:123], v241 offset:17536
    ds_read_b128 a[124:127], v241 offset:17600
    v_mfma_f32_16x16x32_bf16 v[116:119], a[148:151], v[212:215], v[116:119]
    s_add_u32 m0, s48, 50688
    v_exp_f32 v198, v198
    v_mfma_f32_16x16x32_bf16 v[120:123], a[152:155], v[212:215], v[120:123]
    buffer_load_dwordx4 v243, s[12:15], s49 offen nt lds
    v_mfma_f32_16x16x32_bf16 v[124:127], a[156:159], v[212:215], v[124:127]
    s_waitcnt lgkmcnt(7)
    v_exp_f32 v199, v199
    v_mfma_f32_16x16x32_bf16 v[192:195], a[96:99], a[0:3], v[216:219]
    s_waitcnt lgkmcnt(6)
    v_cvt_pk_bf16_f32 v210, v196, v197
    v_cvt_pk_bf16_f32 v211, v198, v199
    v_mfma_f32_16x16x32_bf16 v[192:195], a[100:103], a[4:7], v[192:195]
    s_waitcnt lgkmcnt(5)
    v_exp_f32 v200, v200
    v_mfma_f32_16x16x32_bf16 v[192:195], a[104:107], a[8:11], v[192:195]
    s_waitcnt lgkmcnt(4)
    v_mfma_f32_16x16x32_bf16 v[192:195], a[108:111], a[12:15], v[192:195]
    s_add_u32 m0, s24, 0
    v_exp_f32 v201, v201
    v_mfma_f32_16x16x32_bf16 v[128:131], a[128:131], v[208:211], v[128:131]
    buffer_load_dwordx4 v243, s[4:7], s20 offen nt lds
    v_mfma_f32_16x16x32_bf16 v[132:135], a[132:135], v[208:211], v[132:135]
    s_add_u32 m0, s24, 32
    v_exp_f32 v202, v202
    v_mfma_f32_16x16x32_bf16 v[136:139], a[136:139], v[208:211], v[136:139]
    buffer_load_dwordx4 v243, s[4:7], s20 offen offset:1024 nt lds
    v_mfma_f32_16x16x32_bf16 v[140:143], a[140:143], v[208:211], v[140:143]
    s_waitcnt lgkmcnt(3)
    v_exp_f32 v203, v203
    v_mfma_f32_16x16x32_bf16 v[196:199], a[112:115], a[0:3], v[216:219]
    s_waitcnt lgkmcnt(2)
    v_cvt_pk_bf16_f32 v212, v200, v201
    v_cvt_pk_bf16_f32 v213, v202, v203
    v_mfma_f32_16x16x32_bf16 v[196:199], a[116:119], a[4:7], v[196:199]
    s_waitcnt lgkmcnt(1)
    v_exp_f32 v204, v204
    v_mfma_f32_16x16x32_bf16 v[196:199], a[120:123], a[8:11], v[196:199]
    s_waitcnt lgkmcnt(0)
    v_mfma_f32_16x16x32_bf16 v[196:199], a[124:127], a[12:15], v[196:199]
    s_add_u32 m0, s24, 8448
    v_exp_f32 v205, v205
    v_mfma_f32_16x16x32_bf16 v[144:147], a[144:147], v[208:211], v[144:147]
    buffer_load_dwordx4 v243, s[8:11], s20 offen nt lds
    v_mfma_f32_16x16x32_bf16 v[148:151], a[148:151], v[208:211], v[148:151]
    s_add_u32 m0, s24, 8456
    v_exp_f32 v206, v206
    v_mfma_f32_16x16x32_bf16 v[152:155], a[152:155], v[208:211], v[152:155]
    buffer_load_dwordx4 v243, s[8:11], s20 offen offset:1024 nt lds
    v_mfma_f32_16x16x32_bf16 v[156:159], a[156:159], v[208:211], v[156:159]
    v_exp_f32 v207, v207
    v_mfma_f32_16x16x32_bf16 v[200:203], a[96:99], a[16:19], v[220:223]
    v_cvt_pk_bf16_f32 v214, v204, v205
    v_cvt_pk_bf16_f32 v215, v206, v207
    v_mfma_f32_16x16x32_bf16 v[200:203], a[100:103], a[20:23], v[200:203]
    v_exp_f32 v192, v192
    v_mfma_f32_16x16x32_bf16 v[200:203], a[104:107], a[24:27], v[200:203]
    v_mfma_f32_16x16x32_bf16 v[200:203], a[108:111], a[28:31], v[200:203]
    v_exp_f32 v193, v193
    v_smfmac_f32_16x16x64_bf16 a[168:171], a[172:175], v[208:215], v240
    v_mfma_f32_16x16x32_bf16 v[160:163], a[128:131], v[212:215], v[160:163]
    ds_read_b64_tr_b16 a[128:129], v242 offset:16896
    ds_read_b64_tr_b16 a[130:131], v242 offset:17408
    v_mfma_f32_16x16x32_bf16 v[164:167], a[132:135], v[212:215], v[164:167]
    v_exp_f32 v194, v194
    v_mfma_f32_16x16x32_bf16 v[168:171], a[136:139], v[212:215], v[168:171]
    ds_read_b64_tr_b16 a[132:133], v242 offset:16904
    ds_read_b64_tr_b16 a[134:135], v242 offset:17416
    v_mfma_f32_16x16x32_bf16 v[172:175], a[140:143], v[212:215], v[172:175]
    v_exp_f32 v195, v195
    v_mfma_f32_16x16x32_bf16 v[204:207], a[112:115], a[16:19], v[220:223]
    v_cvt_pk_bf16_f32 v208, v192, v193
    v_cvt_pk_bf16_f32 v209, v194, v195
    v_mfma_f32_16x16x32_bf16 v[204:207], a[116:119], a[20:23], v[204:207]
    v_exp_f32 v196, v196
    v_mfma_f32_16x16x32_bf16 v[204:207], a[120:123], a[24:27], v[204:207]
    ds_read_b64_tr_b16 a[136:137], v242 offset:16960
    ds_read_b64_tr_b16 a[138:139], v242 offset:17472
    v_mfma_f32_16x16x32_bf16 v[204:207], a[124:127], a[28:31], v[204:207]
    v_exp_f32 v197, v197
    v_mfma_f32_16x16x32_bf16 v[176:179], a[144:147], v[212:215], v[176:179]
    ds_read_b64_tr_b16 a[140:141], v242 offset:16968
    ds_read_b64_tr_b16 a[142:143], v242 offset:17480
    v_mfma_f32_16x16x32_bf16 v[180:183], a[148:151], v[212:215], v[180:183]
    v_exp_f32 v198, v198
    v_mfma_f32_16x16x32_bf16 v[184:187], a[152:155], v[212:215], v[184:187]
    ds_read_b64_tr_b16 a[144:145], v242 offset:17024
    ds_read_b64_tr_b16 a[146:147], v242 offset:17536
    v_mfma_f32_16x16x32_bf16 v[188:191], a[156:159], v[212:215], v[188:191]
    v_exp_f32 v199, v199
    v_mfma_f32_16x16x32_bf16 v[192:195], a[96:99], a[32:35], v[224:227]
    v_cvt_pk_bf16_f32 v210, v196, v197
    v_cvt_pk_bf16_f32 v211, v198, v199
    v_mfma_f32_16x16x32_bf16 v[192:195], a[100:103], a[36:39], v[192:195]
    v_exp_f32 v200, v200
    v_mfma_f32_16x16x32_bf16 v[192:195], a[104:107], a[40:43], v[192:195]
    s_add_u32 s44, s44, 1
    ds_read_b64_tr_b16 a[148:149], v242 offset:17032
    ds_read_b64_tr_b16 a[150:151], v242 offset:17544
    v_mfma_f32_16x16x32_bf16 v[192:195], a[108:111], a[44:47], v[192:195]
    s_waitcnt lgkmcnt(10)
    v_exp_f32 v201, v201
    v_mfma_f32_16x16x32_bf16 v[0:3], a[128:131], v[208:211], v[0:3]
    s_waitcnt lgkmcnt(8)
    ds_read_b64_tr_b16 a[152:153], v242 offset:17088
    ds_read_b64_tr_b16 a[154:155], v242 offset:17600
    v_mfma_f32_16x16x32_bf16 v[4:7], a[132:135], v[208:211], v[4:7]
    s_waitcnt lgkmcnt(8)
    v_exp_f32 v202, v202
    v_mfma_f32_16x16x32_bf16 v[8:11], a[136:139], v[208:211], v[8:11]
    s_waitcnt lgkmcnt(6)
    ds_read_b64_tr_b16 a[156:157], v242 offset:17096
    ds_read_b64_tr_b16 a[158:159], v242 offset:17608
    v_mfma_f32_16x16x32_bf16 v[12:15], a[140:143], v[208:211], v[12:15]
    s_add_u32 s45, s45, 1056
    v_exp_f32 v203, v203
    v_mfma_f32_16x16x32_bf16 v[196:199], a[112:115], a[32:35], v[224:227]
    s_add_u32 s47, s47, 1024
    v_cvt_pk_bf16_f32 v212, v200, v201
    v_cvt_pk_bf16_f32 v213, v202, v203
    v_mfma_f32_16x16x32_bf16 v[196:199], a[116:119], a[36:39], v[196:199]
    s_sub_u32 s46, s44, 24
    v_exp_f32 v204, v204
    v_mfma_f32_16x16x32_bf16 v[196:199], a[120:123], a[40:43], v[196:199]
    s_ashr_i32 s46, s46, 31
    ds_read_b128 v[244:247], v249
    v_mfma_f32_16x16x32_bf16 v[196:199], a[124:127], a[44:47], v[196:199]
    s_waitcnt lgkmcnt(7)
    v_exp_f32 v205, v205
    v_mfma_f32_16x16x32_bf16 v[16:19], a[144:147], v[208:211], v[16:19]
    s_waitcnt lgkmcnt(5)
    v_mfma_f32_16x16x32_bf16 v[20:23], a[148:151], v[208:211], v[20:23]
    s_waitcnt lgkmcnt(3)
    v_exp_f32 v206, v206
    v_mfma_f32_16x16x32_bf16 v[24:27], a[152:155], v[208:211], v[24:27]
    s_waitcnt lgkmcnt(1)
    v_mfma_f32_16x16x32_bf16 v[28:31], a[156:159], v[208:211], v[28:31]
    s_and_b32 s48, s45, s46
    v_exp_f32 v207, v207
    v_mfma_f32_16x16x32_bf16 v[200:203], a[96:99], a[48:51], v[228:231]
    s_andn2_b32 s49, 0x40000000, s46
    v_cvt_pk_bf16_f32 v214, v204, v205
    v_cvt_pk_bf16_f32 v215, v206, v207
    v_mfma_f32_16x16x32_bf16 v[200:203], a[100:103], a[52:55], v[200:203]
    s_or_b32 s49, s49, s47
    v_exp_f32 v192, v192
    v_mfma_f32_16x16x32_bf16 v[200:203], a[104:107], a[56:59], v[200:203]
    s_add_u32 s20, s20, 8192
    v_mfma_f32_16x16x32_bf16 v[200:203], a[108:111], a[60:63], v[200:203]
    v_exp_f32 v193, v193
    v_smfmac_f32_16x16x64_bf16 a[160:163], a[172:175], v[208:215], v240
    v_mfma_f32_16x16x32_bf16 v[32:35], a[128:131], v[212:215], v[32:35]
    s_waitcnt lgkmcnt(0)
    v_lshlrev_b32 v248, 16, v244
    v_and_b32 v244, s31, v244
    v_mfma_f32_16x16x32_bf16 v[36:39], a[132:135], v[212:215], v[36:39]
    v_exp_f32 v194, v194
    v_mfma_f32_16x16x32_bf16 v[40:43], a[136:139], v[212:215], v[40:43]
    v_mul_f32 v248, s28, v248
    v_mul_f32 v244, s28, v244
    v_mfma_f32_16x16x32_bf16 v[44:47], a[140:143], v[212:215], v[44:47]
    v_exp_f32 v195, v195
    v_mfma_f32_16x16x32_bf16 v[204:207], a[112:115], a[48:51], v[228:231]
    v_cvt_pk_bf16_f32 v208, v192, v193
    v_cvt_pk_bf16_f32 v209, v194, v195
    v_mfma_f32_16x16x32_bf16 v[204:207], a[116:119], a[52:55], v[204:207]
    v_exp_f32 v196, v196
    v_mfma_f32_16x16x32_bf16 v[204:207], a[120:123], a[56:59], v[204:207]
    v_cvt_pk_bf16_f32 v244, v248, v244
    v_lshlrev_b32 v248, 16, v245
    v_mfma_f32_16x16x32_bf16 v[204:207], a[124:127], a[60:63], v[204:207]
    v_exp_f32 v197, v197
    v_mfma_f32_16x16x32_bf16 v[48:51], a[144:147], v[212:215], v[48:51]
    v_and_b32 v245, s31, v245
    v_mul_f32 v248, s28, v248
    v_mfma_f32_16x16x32_bf16 v[52:55], a[148:151], v[212:215], v[52:55]
    v_exp_f32 v198, v198
    v_mfma_f32_16x16x32_bf16 v[56:59], a[152:155], v[212:215], v[56:59]
    v_mul_f32 v245, s28, v245
    v_cvt_pk_bf16_f32 v245, v248, v245
    v_mfma_f32_16x16x32_bf16 v[60:63], a[156:159], v[212:215], v[60:63]
    v_exp_f32 v199, v199
    v_mfma_f32_16x16x32_bf16 v[192:195], a[96:99], a[64:67], v[232:235]
    v_cvt_pk_bf16_f32 v210, v196, v197
    v_cvt_pk_bf16_f32 v211, v198, v199
    v_mfma_f32_16x16x32_bf16 v[192:195], a[100:103], a[68:71], v[192:195]
    v_exp_f32 v200, v200
    v_mfma_f32_16x16x32_bf16 v[192:195], a[104:107], a[72:75], v[192:195]
    v_lshlrev_b32 v248, 16, v246
    v_and_b32 v246, s31, v246
    v_mfma_f32_16x16x32_bf16 v[192:195], a[108:111], a[76:79], v[192:195]
    v_exp_f32 v201, v201
    v_mfma_f32_16x16x32_bf16 v[64:67], a[128:131], v[208:211], v[64:67]
    v_mul_f32 v248, s28, v248
    v_mul_f32 v246, s28, v246
    v_mfma_f32_16x16x32_bf16 v[68:71], a[132:135], v[208:211], v[68:71]
    v_exp_f32 v202, v202
    v_mfma_f32_16x16x32_bf16 v[72:75], a[136:139], v[208:211], v[72:75]
    v_cvt_pk_bf16_f32 v246, v248, v246
    v_lshlrev_b32 v248, 16, v247
    v_mfma_f32_16x16x32_bf16 v[76:79], a[140:143], v[208:211], v[76:79]
    v_exp_f32 v203, v203
    v_mfma_f32_16x16x32_bf16 v[196:199], a[112:115], a[64:67], v[232:235]
    v_cvt_pk_bf16_f32 v212, v200, v201
    v_cvt_pk_bf16_f32 v213, v202, v203
    v_mfma_f32_16x16x32_bf16 v[196:199], a[116:119], a[68:71], v[196:199]
    v_exp_f32 v204, v204
    v_mfma_f32_16x16x32_bf16 v[196:199], a[120:123], a[72:75], v[196:199]
    v_and_b32 v247, s31, v247
    v_mul_f32 v248, s28, v248
    v_mfma_f32_16x16x32_bf16 v[196:199], a[124:127], a[76:79], v[196:199]
    v_exp_f32 v205, v205
    v_mfma_f32_16x16x32_bf16 v[80:83], a[144:147], v[208:211], v[80:83]
    v_mul_f32 v247, s28, v247
    v_cvt_pk_bf16_f32 v247, v248, v247
    v_mfma_f32_16x16x32_bf16 v[84:87], a[148:151], v[208:211], v[84:87]
    s_waitcnt vmcnt(5)
    v_exp_f32 v206, v206
    v_mfma_f32_16x16x32_bf16 v[88:91], a[152:155], v[208:211], v[88:91]
    s_barrier
    ds_write_b128 v249, v[244:247]
    v_mfma_f32_16x16x32_bf16 v[92:95], a[156:159], v[208:211], v[92:95]
    v_exp_f32 v207, v207
    v_mfma_f32_16x16x32_bf16 v[200:203], a[96:99], a[80:83], v[236:239]
    v_cvt_pk_bf16_f32 v214, v204, v205
    v_cvt_pk_bf16_f32 v215, v206, v207
    v_mfma_f32_16x16x32_bf16 v[200:203], a[100:103], a[84:87], v[200:203]
    v_exp_f32 v192, v192
    v_mfma_f32_16x16x32_bf16 v[200:203], a[104:107], a[88:91], v[200:203]
    ds_read_b128 a[96:99], v241 offset:33792
    ds_read_b128 a[100:103], v241 offset:33856
    v_mfma_f32_16x16x32_bf16 v[200:203], a[108:111], a[92:95], v[200:203]
    v_exp_f32 v193, v193
    v_smfmac_f32_16x16x64_bf16 a[164:167], a[172:175], v[208:215], v240
    ds_read_b128 a[104:107], v241 offset:33920
    ds_read_b128 a[108:111], v241 offset:33984
    v_mfma_f32_16x16x32_bf16 v[96:99], a[128:131], v[212:215], v[96:99]
    v_add_u32 v249, 1056, v249
    v_mfma_f32_16x16x32_bf16 v[100:103], a[132:135], v[212:215], v[100:103]
    v_exp_f32 v194, v194
    v_mfma_f32_16x16x32_bf16 v[104:107], a[136:139], v[212:215], v[104:107]
    v_mfma_f32_16x16x32_bf16 v[108:111], a[140:143], v[212:215], v[108:111]
    v_exp_f32 v195, v195
    v_mfma_f32_16x16x32_bf16 v[204:207], a[112:115], a[80:83], v[236:239]
    v_cvt_pk_bf16_f32 v208, v192, v193
    v_cvt_pk_bf16_f32 v209, v194, v195
    v_mfma_f32_16x16x32_bf16 v[204:207], a[116:119], a[84:87], v[204:207]
    v_exp_f32 v196, v196
    v_mfma_f32_16x16x32_bf16 v[204:207], a[120:123], a[88:91], v[204:207]
    ds_read_b128 a[112:115], v241 offset:34304
    ds_read_b128 a[116:119], v241 offset:34368
    v_mfma_f32_16x16x32_bf16 v[204:207], a[124:127], a[92:95], v[204:207]
    v_exp_f32 v197, v197
    v_mfma_f32_16x16x32_bf16 v[112:115], a[144:147], v[212:215], v[112:115]
    ds_read_b128 a[120:123], v241 offset:34432
    ds_read_b128 a[124:127], v241 offset:34496
    v_mfma_f32_16x16x32_bf16 v[116:119], a[148:151], v[212:215], v[116:119]
    s_add_u32 m0, s48, 50688
    v_exp_f32 v198, v198
    v_mfma_f32_16x16x32_bf16 v[120:123], a[152:155], v[212:215], v[120:123]
    buffer_load_dwordx4 v243, s[12:15], s49 offen nt lds
    v_mfma_f32_16x16x32_bf16 v[124:127], a[156:159], v[212:215], v[124:127]
    s_waitcnt lgkmcnt(7)
    v_exp_f32 v199, v199
    v_mfma_f32_16x16x32_bf16 v[192:195], a[96:99], a[0:3], v[216:219]
    s_waitcnt lgkmcnt(6)
    v_cvt_pk_bf16_f32 v210, v196, v197
    v_cvt_pk_bf16_f32 v211, v198, v199
    v_mfma_f32_16x16x32_bf16 v[192:195], a[100:103], a[4:7], v[192:195]
    s_waitcnt lgkmcnt(5)
    v_exp_f32 v200, v200
    v_mfma_f32_16x16x32_bf16 v[192:195], a[104:107], a[8:11], v[192:195]
    s_waitcnt lgkmcnt(4)
    v_mfma_f32_16x16x32_bf16 v[192:195], a[108:111], a[12:15], v[192:195]
    s_add_u32 m0, s24, 16896
    v_exp_f32 v201, v201
    v_mfma_f32_16x16x32_bf16 v[128:131], a[128:131], v[208:211], v[128:131]
    buffer_load_dwordx4 v243, s[4:7], s20 offen nt lds
    v_mfma_f32_16x16x32_bf16 v[132:135], a[132:135], v[208:211], v[132:135]
    s_add_u32 m0, s24, 16928
    v_exp_f32 v202, v202
    v_mfma_f32_16x16x32_bf16 v[136:139], a[136:139], v[208:211], v[136:139]
    buffer_load_dwordx4 v243, s[4:7], s20 offen offset:1024 nt lds
    v_mfma_f32_16x16x32_bf16 v[140:143], a[140:143], v[208:211], v[140:143]
    s_waitcnt lgkmcnt(3)
    v_exp_f32 v203, v203
    v_mfma_f32_16x16x32_bf16 v[196:199], a[112:115], a[0:3], v[216:219]
    s_waitcnt lgkmcnt(2)
    v_cvt_pk_bf16_f32 v212, v200, v201
    v_cvt_pk_bf16_f32 v213, v202, v203
    v_mfma_f32_16x16x32_bf16 v[196:199], a[116:119], a[4:7], v[196:199]
    s_waitcnt lgkmcnt(1)
    v_exp_f32 v204, v204
    v_mfma_f32_16x16x32_bf16 v[196:199], a[120:123], a[8:11], v[196:199]
    s_waitcnt lgkmcnt(0)
    v_mfma_f32_16x16x32_bf16 v[196:199], a[124:127], a[12:15], v[196:199]
    s_add_u32 m0, s24, 25344
    v_exp_f32 v205, v205
    v_mfma_f32_16x16x32_bf16 v[144:147], a[144:147], v[208:211], v[144:147]
    buffer_load_dwordx4 v243, s[8:11], s20 offen nt lds
    v_mfma_f32_16x16x32_bf16 v[148:151], a[148:151], v[208:211], v[148:151]
    s_add_u32 m0, s24, 25352
    v_exp_f32 v206, v206
    v_mfma_f32_16x16x32_bf16 v[152:155], a[152:155], v[208:211], v[152:155]
    buffer_load_dwordx4 v243, s[8:11], s20 offen offset:1024 nt lds
    v_mfma_f32_16x16x32_bf16 v[156:159], a[156:159], v[208:211], v[156:159]
    s_sub_u32 s38, s38, 1
    v_exp_f32 v207, v207
    v_mfma_f32_16x16x32_bf16 v[200:203], a[96:99], a[16:19], v[220:223]
    s_cbranch_scc0 L_loop0
    v_cvt_pk_bf16_f32 v214, v204, v205
    v_cvt_pk_bf16_f32 v215, v206, v207
    v_mfma_f32_16x16x32_bf16 v[200:203], a[100:103], a[20:23], v[200:203]
    v_exp_f32 v192, v192
    v_mfma_f32_16x16x32_bf16 v[200:203], a[104:107], a[24:27], v[200:203]
    v_add_u32 v249, s42, v241
    v_bfe_u32 v252, v243, 4, 4
    v_mfma_f32_16x16x32_bf16 v[200:203], a[108:111], a[28:31], v[200:203]
    v_exp_f32 v193, v193
    v_smfmac_f32_16x16x64_bf16 a[168:171], a[172:175], v[208:215], v240
    v_bfe_u32 v251, v243, 8, 2
    v_xor_b32 v251, v252, v251
    v_mfma_f32_16x16x32_bf16 v[160:163], a[128:131], v[212:215], v[160:163]
    ds_read_b64_tr_b16 a[128:129], v242 offset:33792
    ds_read_b64_tr_b16 a[130:131], v242 offset:34304
    v_mfma_f32_16x16x32_bf16 v[164:167], a[132:135], v[212:215], v[164:167]
    v_exp_f32 v194, v194
    v_mfma_f32_16x16x32_bf16 v[168:171], a[136:139], v[212:215], v[168:171]
    ds_read_b64_tr_b16 a[132:133], v242 offset:33800
    ds_read_b64_tr_b16 a[134:135], v242 offset:34312
    v_mfma_f32_16x16x32_bf16 v[172:175], a[140:143], v[212:215], v[172:175]
    v_exp_f32 v195, v195
    v_mfma_f32_16x16x32_bf16 v[204:207], a[112:115], a[16:19], v[220:223]
    v_cvt_pk_bf16_f32 v208, v192, v193
    v_cvt_pk_bf16_f32 v209, v194, v195
    v_mfma_f32_16x16x32_bf16 v[204:207], a[116:119], a[20:23], v[204:207]
    v_exp_f32 v196, v196
    v_mfma_f32_16x16x32_bf16 v[204:207], a[120:123], a[24:27], v[204:207]
    ds_read_b64_tr_b16 a[136:137], v242 offset:33856
    ds_read_b64_tr_b16 a[138:139], v242 offset:34368
    v_mfma_f32_16x16x32_bf16 v[204:207], a[124:127], a[28:31], v[204:207]
    v_exp_f32 v197, v197
    v_mfma_f32_16x16x32_bf16 v[176:179], a[144:147], v[212:215], v[176:179]
    ds_read_b64_tr_b16 a[140:141], v242 offset:33864
    ds_read_b64_tr_b16 a[142:143], v242 offset:34376
    v_mfma_f32_16x16x32_bf16 v[180:183], a[148:151], v[212:215], v[180:183]
    v_exp_f32 v198, v198
    v_mfma_f32_16x16x32_bf16 v[184:187], a[152:155], v[212:215], v[184:187]
    ds_read_b64_tr_b16 a[144:145], v242 offset:33920
    ds_read_b64_tr_b16 a[146:147], v242 offset:34432
    v_mfma_f32_16x16x32_bf16 v[188:191], a[156:159], v[212:215], v[188:191]
    v_exp_f32 v199, v199
    v_mfma_f32_16x16x32_bf16 v[192:195], a[96:99], a[32:35], v[224:227]
    v_cvt_pk_bf16_f32 v210, v196, v197
    v_cvt_pk_bf16_f32 v211, v198, v199
    v_mfma_f32_16x16x32_bf16 v[192:195], a[100:103], a[36:39], v[192:195]
    v_exp_f32 v200, v200
    v_mfma_f32_16x16x32_bf16 v[192:195], a[104:107], a[40:43], v[192:195]
    ds_read_b64_tr_b16 a[148:149], v242 offset:33928
    ds_read_b64_tr_b16 a[150:151], v242 offset:34440
    v_mfma_f32_16x16x32_bf16 v[192:195], a[108:111], a[44:47], v[192:195]
    s_waitcnt lgkmcnt(10)
    v_exp_f32 v201, v201
    v_mfma_f32_16x16x32_bf16 v[0:3], a[128:131], v[208:211], v[0:3]
    s_waitcnt lgkmcnt(8)
    ds_read_b64_tr_b16 a[152:153], v242 offset:33984
    ds_read_b64_tr_b16 a[154:155], v242 offset:34496
    v_mfma_f32_16x16x32_bf16 v[4:7], a[132:135], v[208:211], v[4:7]
    s_waitcnt lgkmcnt(8)
    v_exp_f32 v202, v202
    v_mfma_f32_16x16x32_bf16 v[8:11], a[136:139], v[208:211], v[8:11]
    s_waitcnt lgkmcnt(6)
    ds_read_b64_tr_b16 a[156:157], v242 offset:33992
    ds_read_b64_tr_b16 a[158:159], v242 offset:34504
    v_mfma_f32_16x16x32_bf16 v[12:15], a[140:143], v[208:211], v[12:15]
    v_exp_f32 v203, v203
    v_mfma_f32_16x16x32_bf16 v[196:199], a[112:115], a[32:35], v[224:227]
    v_cvt_pk_bf16_f32 v212, v200, v201
    v_cvt_pk_bf16_f32 v213, v202, v203
    v_mfma_f32_16x16x32_bf16 v[196:199], a[116:119], a[36:39], v[196:199]
    v_exp_f32 v204, v204
    v_mfma_f32_16x16x32_bf16 v[196:199], a[120:123], a[40:43], v[196:199]
    v_and_b32 v251, 7, v251
    v_lshl_add_u32 v252, v252, 3, v251
    v_mfma_f32_16x16x32_bf16 v[196:199], a[124:127], a[44:47], v[196:199]
    s_waitcnt lgkmcnt(6)
    v_exp_f32 v205, v205
    v_mfma_f32_16x16x32_bf16 v[16:19], a[144:147], v[208:211], v[16:19]
    s_waitcnt lgkmcnt(4)
    v_lshlrev_b32 v252, 4, v252
    v_xor_b32 v253, 64, v252
    v_mfma_f32_16x16x32_bf16 v[20:23], a[148:151], v[208:211], v[20:23]
    s_waitcnt lgkmcnt(2)
    v_exp_f32 v206, v206
    v_mfma_f32_16x16x32_bf16 v[24:27], a[152:155], v[208:211], v[24:27]
    s_waitcnt lgkmcnt(0)
    v_add_u32 v253, s42, v253
    v_add_u32 v252, s42, v252
    v_mfma_f32_16x16x32_bf16 v[28:31], a[156:159], v[208:211], v[28:31]
    v_exp_f32 v207, v207
    v_mfma_f32_16x16x32_bf16 v[200:203], a[96:99], a[48:51], v[228:231]
    v_cvt_pk_bf16_f32 v214, v204, v205
    v_cvt_pk_bf16_f32 v215, v206, v207
    v_mfma_f32_16x16x32_bf16 v[200:203], a[100:103], a[52:55], v[200:203]
    s_add_u32 s20, s20, 8192
    v_exp_f32 v192, v192
    v_mfma_f32_16x16x32_bf16 v[200:203], a[104:107], a[56:59], v[200:203]
    v_mfma_f32_16x16x32_bf16 v[200:203], a[108:111], a[60:63], v[200:203]
    v_exp_f32 v193, v193
    v_smfmac_f32_16x16x64_bf16 a[160:163], a[172:175], v[208:215], v240
    v_mfma_f32_16x16x32_bf16 v[32:35], a[128:131], v[212:215], v[32:35]
    v_mfma_f32_16x16x32_bf16 v[36:39], a[132:135], v[212:215], v[36:39]
    v_exp_f32 v194, v194
    v_mfma_f32_16x16x32_bf16 v[40:43], a[136:139], v[212:215], v[40:43]
    v_mfma_f32_16x16x32_bf16 v[44:47], a[140:143], v[212:215], v[44:47]
    v_exp_f32 v195, v195
    v_mfma_f32_16x16x32_bf16 v[204:207], a[112:115], a[48:51], v[228:231]
    v_cvt_pk_bf16_f32 v208, v192, v193
    v_cvt_pk_bf16_f32 v209, v194, v195
    v_mfma_f32_16x16x32_bf16 v[204:207], a[116:119], a[52:55], v[204:207]
    v_exp_f32 v196, v196
    v_mfma_f32_16x16x32_bf16 v[204:207], a[120:123], a[56:59], v[204:207]
    v_mfma_f32_16x16x32_bf16 v[204:207], a[124:127], a[60:63], v[204:207]
    v_exp_f32 v197, v197
    v_mfma_f32_16x16x32_bf16 v[48:51], a[144:147], v[212:215], v[48:51]
    v_mfma_f32_16x16x32_bf16 v[52:55], a[148:151], v[212:215], v[52:55]
    v_exp_f32 v198, v198
    v_mfma_f32_16x16x32_bf16 v[56:59], a[152:155], v[212:215], v[56:59]
    v_mfma_f32_16x16x32_bf16 v[60:63], a[156:159], v[212:215], v[60:63]
    v_exp_f32 v199, v199
    v_mfma_f32_16x16x32_bf16 v[192:195], a[96:99], a[64:67], v[232:235]
    v_cvt_pk_bf16_f32 v210, v196, v197
    v_cvt_pk_bf16_f32 v211, v198, v199
    v_mfma_f32_16x16x32_bf16 v[192:195], a[100:103], a[68:71], v[192:195]
    v_exp_f32 v200, v200
    v_mfma_f32_16x16x32_bf16 v[192:195], a[104:107], a[72:75], v[192:195]
    v_mfma_f32_16x16x32_bf16 v[192:195], a[108:111], a[76:79], v[192:195]
    v_exp_f32 v201, v201
    v_mfma_f32_16x16x32_bf16 v[64:67], a[128:131], v[208:211], v[64:67]
    v_mfma_f32_16x16x32_bf16 v[68:71], a[132:135], v[208:211], v[68:71]
    v_exp_f32 v202, v202
    v_mfma_f32_16x16x32_bf16 v[72:75], a[136:139], v[208:211], v[72:75]
    v_mfma_f32_16x16x32_bf16 v[76:79], a[140:143], v[208:211], v[76:79]
    v_exp_f32 v203, v203
    v_mfma_f32_16x16x32_bf16 v[196:199], a[112:115], a[64:67], v[232:235]
    v_cvt_pk_bf16_f32 v212, v200, v201
    v_cvt_pk_bf16_f32 v213, v202, v203
    v_mfma_f32_16x16x32_bf16 v[196:199], a[116:119], a[68:71], v[196:199]
    v_exp_f32 v204, v204
    v_mfma_f32_16x16x32_bf16 v[196:199], a[120:123], a[72:75], v[196:199]
    v_mfma_f32_16x16x32_bf16 v[196:199], a[124:127], a[76:79], v[196:199]
    v_exp_f32 v205, v205
    v_mfma_f32_16x16x32_bf16 v[80:83], a[144:147], v[208:211], v[80:83]
    v_mfma_f32_16x16x32_bf16 v[84:87], a[148:151], v[208:211], v[84:87]
    s_waitcnt vmcnt(5)
    v_exp_f32 v206, v206
    v_mfma_f32_16x16x32_bf16 v[88:91], a[152:155], v[208:211], v[88:91]
    s_barrier
    v_mfma_f32_16x16x32_bf16 v[92:95], a[156:159], v[208:211], v[92:95]
    v_exp_f32 v207, v207
    v_mfma_f32_16x16x32_bf16 v[200:203], a[96:99], a[80:83], v[236:239]
    v_cvt_pk_bf16_f32 v214, v204, v205
    v_cvt_pk_bf16_f32 v215, v206, v207
    v_mfma_f32_16x16x32_bf16 v[200:203], a[100:103], a[84:87], v[200:203]
    v_exp_f32 v192, v192
    v_mfma_f32_16x16x32_bf16 v[200:203], a[104:107], a[88:91], v[200:203]
    ds_read_b128 a[96:99], v241 offset:0
    ds_read_b128 a[100:103], v241 offset:64
    v_mfma_f32_16x16x32_bf16 v[200:203], a[108:111], a[92:95], v[200:203]
    v_exp_f32 v193, v193
    v_smfmac_f32_16x16x64_bf16 a[164:167], a[172:175], v[208:215], v240
    ds_read_b128 a[104:107], v241 offset:128
    ds_read_b128 a[108:111], v241 offset:192
    v_mfma_f32_16x16x32_bf16 v[96:99], a[128:131], v[212:215], v[96:99]
    v_mfma_f32_16x16x32_bf16 v[100:103], a[132:135], v[212:215], v[100:103]
    v_exp_f32 v194, v194
    v_mfma_f32_16x16x32_bf16 v[104:107], a[136:139], v[212:215], v[104:107]
    v_mfma_f32_16x16x32_bf16 v[108:111], a[140:143], v[212:215], v[108:111]
    v_exp_f32 v195, v195
    v_mfma_f32_16x16x32_bf16 v[204:207], a[112:115], a[80:83], v[236:239]
    v_cvt_pk_bf16_f32 v208, v192, v193
    v_cvt_pk_bf16_f32 v209, v194, v195
    v_mfma_f32_16x16x32_bf16 v[204:207], a[116:119], a[84:87], v[204:207]
    v_exp_f32 v196, v196
    v_mfma_f32_16x16x32_bf16 v[204:207], a[120:123], a[88:91], v[204:207]
    ds_read_b128 a[112:115], v241 offset:512
    ds_read_b128 a[116:119], v241 offset:576
    v_mfma_f32_16x16x32_bf16 v[204:207], a[124:127], a[92:95], v[204:207]
    v_exp_f32 v197, v197
    v_mfma_f32_16x16x32_bf16 v[112:115], a[144:147], v[212:215], v[112:115]
    ds_read_b128 a[120:123], v241 offset:640
    ds_read_b128 a[124:127], v241 offset:704
    v_mfma_f32_16x16x32_bf16 v[116:119], a[148:151], v[212:215], v[116:119]
    v_exp_f32 v198, v198
    v_mfma_f32_16x16x32_bf16 v[120:123], a[152:155], v[212:215], v[120:123]
    s_add_u32 m0, s24, 33792
    v_mfma_f32_16x16x32_bf16 v[124:127], a[156:159], v[212:215], v[124:127]
    s_waitcnt lgkmcnt(7)
    v_exp_f32 v199, v199
    v_mfma_f32_16x16x32_bf16 v[192:195], a[96:99], a[0:3], v[216:219]
    s_waitcnt lgkmcnt(6)
    v_cvt_pk_bf16_f32 v210, v196, v197
    v_cvt_pk_bf16_f32 v211, v198, v199
    v_mfma_f32_16x16x32_bf16 v[192:195], a[100:103], a[4:7], v[192:195]
    s_waitcnt lgkmcnt(5)
    v_exp_f32 v200, v200
    v_mfma_f32_16x16x32_bf16 v[192:195], a[104:107], a[8:11], v[192:195]
    s_waitcnt lgkmcnt(4)
    buffer_load_dwordx4 v243, s[4:7], s20 offen nt lds
    v_mfma_f32_16x16x32_bf16 v[192:195], a[108:111], a[12:15], v[192:195]
    s_add_u32 m0, s24, 33824
    v_exp_f32 v201, v201
    v_mfma_f32_16x16x32_bf16 v[128:131], a[128:131], v[208:211], v[128:131]
    buffer_load_dwordx4 v243, s[4:7], s20 offen offset:1024 nt lds
    v_mfma_f32_16x16x32_bf16 v[132:135], a[132:135], v[208:211], v[132:135]
    s_add_u32 m0, s24, 42240
    v_exp_f32 v202, v202
    v_mfma_f32_16x16x32_bf16 v[136:139], a[136:139], v[208:211], v[136:139]
    buffer_load_dwordx4 v243, s[8:11], s20 offen nt lds
    v_mfma_f32_16x16x32_bf16 v[140:143], a[140:143], v[208:211], v[140:143]
    s_waitcnt lgkmcnt(3)
    v_exp_f32 v203, v203
    v_mfma_f32_16x16x32_bf16 v[196:199], a[112:115], a[0:3], v[216:219]
    s_waitcnt lgkmcnt(2)
    v_cvt_pk_bf16_f32 v212, v200, v201
    v_cvt_pk_bf16_f32 v213, v202, v203
    v_mfma_f32_16x16x32_bf16 v[196:199], a[116:119], a[4:7], v[196:199]
    s_waitcnt lgkmcnt(1)
    v_exp_f32 v204, v204
    v_mfma_f32_16x16x32_bf16 v[196:199], a[120:123], a[8:11], v[196:199]
    s_waitcnt lgkmcnt(0)
    v_mfma_f32_16x16x32_bf16 v[196:199], a[124:127], a[12:15], v[196:199]
    s_add_u32 m0, s24, 42248
    v_exp_f32 v205, v205
    v_mfma_f32_16x16x32_bf16 v[144:147], a[144:147], v[208:211], v[144:147]
    buffer_load_dwordx4 v243, s[8:11], s20 offen offset:1024 nt lds
    v_mfma_f32_16x16x32_bf16 v[148:151], a[148:151], v[208:211], v[148:151]
    v_exp_f32 v206, v206
    v_mfma_f32_16x16x32_bf16 v[152:155], a[152:155], v[208:211], v[152:155]
    v_mfma_f32_16x16x32_bf16 v[156:159], a[156:159], v[208:211], v[156:159]
    v_exp_f32 v207, v207
    v_mfma_f32_16x16x32_bf16 v[200:203], a[96:99], a[16:19], v[220:223]
    v_cvt_pk_bf16_f32 v214, v204, v205
    v_cvt_pk_bf16_f32 v215, v206, v207
    v_mfma_f32_16x16x32_bf16 v[200:203], a[100:103], a[20:23], v[200:203]
    v_exp_f32 v192, v192
    v_mfma_f32_16x16x32_bf16 v[200:203], a[104:107], a[24:27], v[200:203]
    v_mfma_f32_16x16x32_bf16 v[200:203], a[108:111], a[28:31], v[200:203]
    v_exp_f32 v193, v193
    v_smfmac_f32_16x16x64_bf16 a[168:171], a[172:175], v[208:215], v240
    v_mfma_f32_16x16x32_bf16 v[160:163], a[128:131], v[212:215], v[160:163]
    ds_read_b64_tr_b16 a[128:129], v242 offset:0
    ds_read_b64_tr_b16 a[130:131], v242 offset:512
    v_mfma_f32_16x16x32_bf16 v[164:167], a[132:135], v[212:215], v[164:167]
    v_exp_f32 v194, v194
    v_mfma_f32_16x16x32_bf16 v[168:171], a[136:139], v[212:215], v[168:171]
    ds_read_b64_tr_b16 a[132:133], v242 offset:8
    ds_read_b64_tr_b16 a[134:135], v242 offset:520
    v_mfma_f32_16x16x32_bf16 v[172:175], a[140:143], v[212:215], v[172:175]
    v_exp_f32 v195, v195
    v_mfma_f32_16x16x32_bf16 v[204:207], a[112:115], a[16:19], v[220:223]
    v_cvt_pk_bf16_f32 v208, v192, v193
    v_cvt_pk_bf16_f32 v209, v194, v195
    v_mfma_f32_16x16x32_bf16 v[204:207], a[116:119], a[20:23], v[204:207]
    v_exp_f32 v196, v196
    v_mfma_f32_16x16x32_bf16 v[204:207], a[120:123], a[24:27], v[204:207]
    ds_read_b64_tr_b16 a[136:137], v242 offset:64
    ds_read_b64_tr_b16 a[138:139], v242 offset:576
    v_mfma_f32_16x16x32_bf16 v[204:207], a[124:127], a[28:31], v[204:207]
    v_exp_f32 v197, v197
    v_mfma_f32_16x16x32_bf16 v[176:179], a[144:147], v[212:215], v[176:179]
    ds_read_b64_tr_b16 a[140:141], v242 offset:72
    ds_read_b64_tr_b16 a[142:143], v242 offset:584
    v_mfma_f32_16x16x32_bf16 v[180:183], a[148:151], v[212:215], v[180:183]
    v_exp_f32 v198, v198
    v_mfma_f32_16x16x32_bf16 v[184:187], a[152:155], v[212:215], v[184:187]
    ds_read_b64_tr_b16 a[144:145], v242 offset:128
    ds_read_b64_tr_b16 a[146:147], v242 offset:640
    v_mfma_f32_16x16x32_bf16 v[188:191], a[156:159], v[212:215], v[188:191]
    v_exp_f32 v199, v199
    v_mfma_f32_16x16x32_bf16 v[192:195], a[96:99], a[32:35], v[224:227]
    v_cvt_pk_bf16_f32 v210, v196, v197
    v_cvt_pk_bf16_f32 v211, v198, v199
    v_mfma_f32_16x16x32_bf16 v[192:195], a[100:103], a[36:39], v[192:195]
    v_exp_f32 v200, v200
    v_mfma_f32_16x16x32_bf16 v[192:195], a[104:107], a[40:43], v[192:195]
    ds_read_b64_tr_b16 a[148:149], v242 offset:136
    ds_read_b64_tr_b16 a[150:151], v242 offset:648
    v_mfma_f32_16x16x32_bf16 v[192:195], a[108:111], a[44:47], v[192:195]
    s_waitcnt lgkmcnt(10)
    v_exp_f32 v201, v201
    v_mfma_f32_16x16x32_bf16 v[0:3], a[128:131], v[208:211], v[0:3]
    s_waitcnt lgkmcnt(8)
    ds_read_b64_tr_b16 a[152:153], v242 offset:192
    ds_read_b64_tr_b16 a[154:155], v242 offset:704
    v_mfma_f32_16x16x32_bf16 v[4:7], a[132:135], v[208:211], v[4:7]
    s_waitcnt lgkmcnt(8)
    v_exp_f32 v202, v202
    v_mfma_f32_16x16x32_bf16 v[8:11], a[136:139], v[208:211], v[8:11]
    s_waitcnt lgkmcnt(6)
    ds_read_b64_tr_b16 a[156:157], v242 offset:200
    ds_read_b64_tr_b16 a[158:159], v242 offset:712
    v_mfma_f32_16x16x32_bf16 v[12:15], a[140:143], v[208:211], v[12:15]
    v_exp_f32 v203, v203
    v_mfma_f32_16x16x32_bf16 v[196:199], a[112:115], a[32:35], v[224:227]
    v_cvt_pk_bf16_f32 v212, v200, v201
    v_cvt_pk_bf16_f32 v213, v202, v203
    v_mfma_f32_16x16x32_bf16 v[196:199], a[116:119], a[36:39], v[196:199]
    v_exp_f32 v204, v204
    v_mfma_f32_16x16x32_bf16 v[196:199], a[120:123], a[40:43], v[196:199]
    v_mfma_f32_16x16x32_bf16 v[196:199], a[124:127], a[44:47], v[196:199]
    s_waitcnt lgkmcnt(6)
    v_exp_f32 v205, v205
    v_mfma_f32_16x16x32_bf16 v[16:19], a[144:147], v[208:211], v[16:19]
    s_waitcnt lgkmcnt(4)
    v_mfma_f32_16x16x32_bf16 v[20:23], a[148:151], v[208:211], v[20:23]
    s_waitcnt lgkmcnt(2)
    v_exp_f32 v206, v206
    v_mfma_f32_16x16x32_bf16 v[24:27], a[152:155], v[208:211], v[24:27]
    s_waitcnt lgkmcnt(0)
    v_mfma_f32_16x16x32_bf16 v[28:31], a[156:159], v[208:211], v[28:31]
    v_exp_f32 v207, v207
    v_mfma_f32_16x16x32_bf16 v[200:203], a[96:99], a[48:51], v[228:231]
    v_cvt_pk_bf16_f32 v214, v204, v205
    v_cvt_pk_bf16_f32 v215, v206, v207
    v_mfma_f32_16x16x32_bf16 v[200:203], a[100:103], a[52:55], v[200:203]
    s_add_u32 s20, s20, 8192
    v_exp_f32 v192, v192
    v_mfma_f32_16x16x32_bf16 v[200:203], a[104:107], a[56:59], v[200:203]
    v_mfma_f32_16x16x32_bf16 v[200:203], a[108:111], a[60:63], v[200:203]
    v_exp_f32 v193, v193
    v_smfmac_f32_16x16x64_bf16 a[160:163], a[172:175], v[208:215], v240
    v_mfma_f32_16x16x32_bf16 v[32:35], a[128:131], v[212:215], v[32:35]
    v_mfma_f32_16x16x32_bf16 v[36:39], a[132:135], v[212:215], v[36:39]
    v_exp_f32 v194, v194
    v_mfma_f32_16x16x32_bf16 v[40:43], a[136:139], v[212:215], v[40:43]
    v_mfma_f32_16x16x32_bf16 v[44:47], a[140:143], v[212:215], v[44:47]
    v_exp_f32 v195, v195
    v_mfma_f32_16x16x32_bf16 v[204:207], a[112:115], a[48:51], v[228:231]
    v_cvt_pk_bf16_f32 v208, v192, v193
    v_cvt_pk_bf16_f32 v209, v194, v195
    v_mfma_f32_16x16x32_bf16 v[204:207], a[116:119], a[52:55], v[204:207]
    v_exp_f32 v196, v196
    v_mfma_f32_16x16x32_bf16 v[204:207], a[120:123], a[56:59], v[204:207]
    v_mfma_f32_16x16x32_bf16 v[204:207], a[124:127], a[60:63], v[204:207]
    v_exp_f32 v197, v197
    v_mfma_f32_16x16x32_bf16 v[48:51], a[144:147], v[212:215], v[48:51]
    v_mfma_f32_16x16x32_bf16 v[52:55], a[148:151], v[212:215], v[52:55]
    v_exp_f32 v198, v198
    v_mfma_f32_16x16x32_bf16 v[56:59], a[152:155], v[212:215], v[56:59]
    v_mfma_f32_16x16x32_bf16 v[60:63], a[156:159], v[212:215], v[60:63]
    v_exp_f32 v199, v199
    v_mfma_f32_16x16x32_bf16 v[192:195], a[96:99], a[64:67], v[232:235]
    v_cvt_pk_bf16_f32 v210, v196, v197
    v_cvt_pk_bf16_f32 v211, v198, v199
    v_mfma_f32_16x16x32_bf16 v[192:195], a[100:103], a[68:71], v[192:195]
    v_exp_f32 v200, v200
    v_mfma_f32_16x16x32_bf16 v[192:195], a[104:107], a[72:75], v[192:195]
    v_mfma_f32_16x16x32_bf16 v[192:195], a[108:111], a[76:79], v[192:195]
    v_exp_f32 v201, v201
    v_mfma_f32_16x16x32_bf16 v[64:67], a[128:131], v[208:211], v[64:67]
    v_mfma_f32_16x16x32_bf16 v[68:71], a[132:135], v[208:211], v[68:71]
    v_exp_f32 v202, v202
    v_mfma_f32_16x16x32_bf16 v[72:75], a[136:139], v[208:211], v[72:75]
    v_mfma_f32_16x16x32_bf16 v[76:79], a[140:143], v[208:211], v[76:79]
    v_exp_f32 v203, v203
    v_mfma_f32_16x16x32_bf16 v[196:199], a[112:115], a[64:67], v[232:235]
    v_cvt_pk_bf16_f32 v212, v200, v201
    v_cvt_pk_bf16_f32 v213, v202, v203
    v_mfma_f32_16x16x32_bf16 v[196:199], a[116:119], a[68:71], v[196:199]
    v_exp_f32 v204, v204
    v_mfma_f32_16x16x32_bf16 v[196:199], a[120:123], a[72:75], v[196:199]
    v_mfma_f32_16x16x32_bf16 v[196:199], a[124:127], a[76:79], v[196:199]
    v_exp_f32 v205, v205
    v_mfma_f32_16x16x32_bf16 v[80:83], a[144:147], v[208:211], v[80:83]
    v_mfma_f32_16x16x32_bf16 v[84:87], a[148:151], v[208:211], v[84:87]
    s_waitcnt vmcnt(4)
    v_exp_f32 v206, v206
    v_mfma_f32_16x16x32_bf16 v[88:91], a[152:155], v[208:211], v[88:91]
    s_barrier
    v_mfma_f32_16x16x32_bf16 v[92:95], a[156:159], v[208:211], v[92:95]
    v_exp_f32 v207, v207
    v_mfma_f32_16x16x32_bf16 v[200:203], a[96:99], a[80:83], v[236:239]
    v_cvt_pk_bf16_f32 v214, v204, v205
    v_cvt_pk_bf16_f32 v215, v206, v207
    v_mfma_f32_16x16x32_bf16 v[200:203], a[100:103], a[84:87], v[200:203]
    v_exp_f32 v192, v192
    v_mfma_f32_16x16x32_bf16 v[200:203], a[104:107], a[88:91], v[200:203]
    ds_read_b128 a[96:99], v241 offset:16896
    ds_read_b128 a[100:103], v241 offset:16960
    v_mfma_f32_16x16x32_bf16 v[200:203], a[108:111], a[92:95], v[200:203]
    v_exp_f32 v193, v193
    v_smfmac_f32_16x16x64_bf16 a[164:167], a[172:175], v[208:215], v240
    ds_read_b128 a[104:107], v241 offset:17024
    ds_read_b128 a[108:111], v241 offset:17088
    v_mfma_f32_16x16x32_bf16 v[96:99], a[128:131], v[212:215], v[96:99]
    v_mfma_f32_16x16x32_bf16 v[100:103], a[132:135], v[212:215], v[100:103]
    v_exp_f32 v194, v194
    v_mfma_f32_16x16x32_bf16 v[104:107], a[136:139], v[212:215], v[104:107]
    v_mfma_f32_16x16x32_bf16 v[108:111], a[140:143], v[212:215], v[108:111]
    v_exp_f32 v195, v195
    v_mfma_f32_16x16x32_bf16 v[204:207], a[112:115], a[80:83], v[236:239]
    v_cvt_pk_bf16_f32 v208, v192, v193
    v_cvt_pk_bf16_f32 v209, v194, v195
    v_mfma_f32_16x16x32_bf16 v[204:207], a[116:119], a[84:87], v[204:207]
    v_exp_f32 v196, v196
    v_mfma_f32_16x16x32_bf16 v[204:207], a[120:123], a[88:91], v[204:207]
    ds_read_b128 a[112:115], v241 offset:17408
    ds_read_b128 a[116:119], v241 offset:17472
    v_mfma_f32_16x16x32_bf16 v[204:207], a[124:127], a[92:95], v[204:207]
    v_exp_f32 v197, v197
    v_mfma_f32_16x16x32_bf16 v[112:115], a[144:147], v[212:215], v[112:115]
    ds_read_b128 a[120:123], v241 offset:17536
    ds_read_b128 a[124:127], v241 offset:17600
    v_mfma_f32_16x16x32_bf16 v[116:119], a[148:151], v[212:215], v[116:119]
    v_exp_f32 v198, v198
    v_mfma_f32_16x16x32_bf16 v[120:123], a[152:155], v[212:215], v[120:123]
    s_add_u32 m0, s24, 0
    v_mfma_f32_16x16x32_bf16 v[124:127], a[156:159], v[212:215], v[124:127]
    s_waitcnt lgkmcnt(7)
    v_exp_f32 v199, v199
    v_mfma_f32_16x16x32_bf16 v[192:195], a[96:99], a[0:3], v[216:219]
    s_waitcnt lgkmcnt(6)
    v_cvt_pk_bf16_f32 v210, v196, v197
    v_cvt_pk_bf16_f32 v211, v198, v199
    v_mfma_f32_16x16x32_bf16 v[192:195], a[100:103], a[4:7], v[192:195]
    s_waitcnt lgkmcnt(5)
    v_exp_f32 v200, v200
    v_mfma_f32_16x16x32_bf16 v[192:195], a[104:107], a[8:11], v[192:195]
    s_waitcnt lgkmcnt(4)
    buffer_load_dwordx4 v243, s[4:7], s20 offen nt lds
    v_mfma_f32_16x16x32_bf16 v[192:195], a[108:111], a[12:15], v[192:195]
    s_add_u32 m0, s24, 32
    v_exp_f32 v201, v201
    v_mfma_f32_16x16x32_bf16 v[128:131], a[128:131], v[208:211], v[128:131]
    buffer_load_dwordx4 v243, s[4:7], s20 offen offset:1024 nt lds
    v_mfma_f32_16x16x32_bf16 v[132:135], a[132:135], v[208:211], v[132:135]
    s_add_u32 m0, s24, 8448
    v_exp_f32 v202, v202
    v_mfma_f32_16x16x32_bf16 v[136:139], a[136:139], v[208:211], v[136:139]
    buffer_load_dwordx4 v243, s[8:11], s20 offen nt lds
    v_mfma_f32_16x16x32_bf16 v[140:143], a[140:143], v[208:211], v[140:143]
    s_waitcnt lgkmcnt(3)
    v_exp_f32 v203, v203
    v_mfma_f32_16x16x32_bf16 v[196:199], a[112:115], a[0:3], v[216:219]
    s_waitcnt lgkmcnt(2)
    v_cvt_pk_bf16_f32 v212, v200, v201
    v_cvt_pk_bf16_f32 v213, v202, v203
    v_mfma_f32_16x16x32_bf16 v[196:199], a[116:119], a[4:7], v[196:199]
    s_waitcnt lgkmcnt(1)
    v_exp_f32 v204, v204
    v_mfma_f32_16x16x32_bf16 v[196:199], a[120:123], a[8:11], v[196:199]
    s_waitcnt lgkmcnt(0)
    ds_read_b128 a[0:3], v249 offset:0
    ds_read_b128 a[4:7], v249 offset:64
    v_mfma_f32_16x16x32_bf16 v[196:199], a[124:127], a[12:15], v[196:199]
    s_add_u32 m0, s24, 8456
    v_exp_f32 v205, v205
    v_mfma_f32_16x16x32_bf16 v[144:147], a[144:147], v[208:211], v[144:147]
    buffer_load_dwordx4 v243, s[8:11], s20 offen offset:1024 nt lds
    v_mfma_f32_16x16x32_bf16 v[148:151], a[148:151], v[208:211], v[148:151]
    v_exp_f32 v206, v206
    v_mfma_f32_16x16x32_bf16 v[152:155], a[152:155], v[208:211], v[152:155]
    ds_read_b128 a[8:11], v249 offset:128
    ds_read_b128 a[12:15], v249 offset:192
    v_mfma_f32_16x16x32_bf16 v[156:159], a[156:159], v[208:211], v[156:159]
    v_exp_f32 v207, v207
    v_mfma_f32_16x16x32_bf16 v[200:203], a[96:99], a[16:19], v[220:223]
    v_cvt_pk_bf16_f32 v214, v204, v205
    v_cvt_pk_bf16_f32 v215, v206, v207
    v_mfma_f32_16x16x32_bf16 v[200:203], a[100:103], a[20:23], v[200:203]
    v_exp_f32 v192, v192
    v_mfma_f32_16x16x32_bf16 v[200:203], a[104:107], a[24:27], v[200:203]
    v_mfma_f32_16x16x32_bf16 v[200:203], a[108:111], a[28:31], v[200:203]
    v_exp_f32 v193, v193
    v_smfmac_f32_16x16x64_bf16 a[168:171], a[172:175], v[208:215], v240
    v_mfma_f32_16x16x32_bf16 v[160:163], a[128:131], v[212:215], v[160:163]
    ds_read_b64_tr_b16 a[128:129], v242 offset:16896
    ds_read_b64_tr_b16 a[130:131], v242 offset:17408
    v_mfma_f32_16x16x32_bf16 v[164:167], a[132:135], v[212:215], v[164:167]
    v_exp_f32 v194, v194
    v_mfma_f32_16x16x32_bf16 v[168:171], a[136:139], v[212:215], v[168:171]
    ds_read_b64_tr_b16 a[132:133], v242 offset:16904
    ds_read_b64_tr_b16 a[134:135], v242 offset:17416
    v_mfma_f32_16x16x32_bf16 v[172:175], a[140:143], v[212:215], v[172:175]
    v_exp_f32 v195, v195
    v_mfma_f32_16x16x32_bf16 v[204:207], a[112:115], a[16:19], v[220:223]
    v_cvt_pk_bf16_f32 v208, v192, v193
    v_cvt_pk_bf16_f32 v209, v194, v195
    v_mfma_f32_16x16x32_bf16 v[204:207], a[116:119], a[20:23], v[204:207]
    v_exp_f32 v196, v196
    v_mfma_f32_16x16x32_bf16 v[204:207], a[120:123], a[24:27], v[204:207]
    ds_read_b64_tr_b16 a[136:137], v242 offset:16960
    ds_read_b64_tr_b16 a[138:139], v242 offset:17472
    v_mfma_f32_16x16x32_bf16 v[204:207], a[124:127], a[28:31], v[204:207]
    v_exp_f32 v197, v197
    v_mfma_f32_16x16x32_bf16 v[176:179], a[144:147], v[212:215], v[176:179]
    ds_read_b64_tr_b16 a[140:141], v242 offset:16968
    ds_read_b64_tr_b16 a[142:143], v242 offset:17480
    v_mfma_f32_16x16x32_bf16 v[180:183], a[148:151], v[212:215], v[180:183]
    v_exp_f32 v198, v198
    v_mfma_f32_16x16x32_bf16 v[184:187], a[152:155], v[212:215], v[184:187]
    ds_read_b64_tr_b16 a[144:145], v242 offset:17024
    ds_read_b64_tr_b16 a[146:147], v242 offset:17536
    v_mfma_f32_16x16x32_bf16 v[188:191], a[156:159], v[212:215], v[188:191]
    v_exp_f32 v199, v199
    v_mfma_f32_16x16x32_bf16 v[192:195], a[96:99], a[32:35], v[224:227]
    v_cvt_pk_bf16_f32 v210, v196, v197
    v_cvt_pk_bf16_f32 v211, v198, v199
    v_mfma_f32_16x16x32_bf16 v[192:195], a[100:103], a[36:39], v[192:195]
    v_exp_f32 v200, v200
    v_mfma_f32_16x16x32_bf16 v[192:195], a[104:107], a[40:43], v[192:195]
    ds_read_b64_tr_b16 a[148:149], v242 offset:17032
    ds_read_b64_tr_b16 a[150:151], v242 offset:17544
    v_mfma_f32_16x16x32_bf16 v[192:195], a[108:111], a[44:47], v[192:195]
    s_waitcnt lgkmcnt(10)
    v_exp_f32 v201, v201
    v_mfma_f32_16x16x32_bf16 v[0:3], a[128:131], v[208:211], v[0:3]
    s_waitcnt lgkmcnt(8)
    ds_read_b64_tr_b16 a[152:153], v242 offset:17088
    ds_read_b64_tr_b16 a[154:155], v242 offset:17600
    v_mfma_f32_16x16x32_bf16 v[4:7], a[132:135], v[208:211], v[4:7]
    s_waitcnt lgkmcnt(8)
    v_exp_f32 v202, v202
    v_mfma_f32_16x16x32_bf16 v[8:11], a[136:139], v[208:211], v[8:11]
    s_waitcnt lgkmcnt(6)
    ds_read_b64_tr_b16 a[156:157], v242 offset:17096
    ds_read_b64_tr_b16 a[158:159], v242 offset:17608
    v_mfma_f32_16x16x32_bf16 v[12:15], a[140:143], v[208:211], v[12:15]
    v_exp_f32 v203, v203
    v_mfma_f32_16x16x32_bf16 v[196:199], a[112:115], a[32:35], v[224:227]
    v_cvt_pk_bf16_f32 v212, v200, v201
    v_cvt_pk_bf16_f32 v213, v202, v203
    v_mfma_f32_16x16x32_bf16 v[196:199], a[116:119], a[36:39], v[196:199]
    v_exp_f32 v204, v204
    v_mfma_f32_16x16x32_bf16 v[196:199], a[120:123], a[40:43], v[196:199]
    ds_read_b128 a[16:19], v249 offset:512
    ds_read_b128 a[20:23], v249 offset:576
    v_mfma_f32_16x16x32_bf16 v[196:199], a[124:127], a[44:47], v[196:199]
    s_waitcnt lgkmcnt(8)
    v_exp_f32 v205, v205
    v_mfma_f32_16x16x32_bf16 v[16:19], a[144:147], v[208:211], v[16:19]
    s_waitcnt lgkmcnt(6)
    ds_read_b128 a[24:27], v249 offset:640
    ds_read_b128 a[28:31], v249 offset:704
    v_mfma_f32_16x16x32_bf16 v[20:23], a[148:151], v[208:211], v[20:23]
    s_waitcnt lgkmcnt(6)
    v_exp_f32 v206, v206
    v_mfma_f32_16x16x32_bf16 v[24:27], a[152:155], v[208:211], v[24:27]
    s_waitcnt lgkmcnt(4)
    ds_read_b128 a[32:35], v249 offset:8448
    ds_read_b128 a[36:39], v249 offset:8512
    v_mfma_f32_16x16x32_bf16 v[28:31], a[156:159], v[208:211], v[28:31]
    v_exp_f32 v207, v207
    v_mfma_f32_16x16x32_bf16 v[200:203], a[96:99], a[48:51], v[228:231]
    v_cvt_pk_bf16_f32 v214, v204, v205
    v_cvt_pk_bf16_f32 v215, v206, v207
    v_mfma_f32_16x16x32_bf16 v[200:203], a[100:103], a[52:55], v[200:203]
    s_add_u32 s20, s20, 8192
    v_exp_f32 v192, v192
    v_mfma_f32_16x16x32_bf16 v[200:203], a[104:107], a[56:59], v[200:203]
    ds_read_b128 a[40:43], v249 offset:8576
    ds_read_b128 a[44:47], v249 offset:8640
    v_mfma_f32_16x16x32_bf16 v[200:203], a[108:111], a[60:63], v[200:203]
    v_exp_f32 v193, v193
    v_smfmac_f32_16x16x64_bf16 a[160:163], a[172:175], v[208:215], v240
    v_mfma_f32_16x16x32_bf16 v[32:35], a[128:131], v[212:215], v[32:35]
    v_mfma_f32_16x16x32_bf16 v[36:39], a[132:135], v[212:215], v[36:39]
    v_exp_f32 v194, v194
    v_mfma_f32_16x16x32_bf16 v[40:43], a[136:139], v[212:215], v[40:43]
    v_mfma_f32_16x16x32_bf16 v[44:47], a[140:143], v[212:215], v[44:47]
    v_exp_f32 v195, v195
    v_mfma_f32_16x16x32_bf16 v[204:207], a[112:115], a[48:51], v[228:231]
    v_cvt_pk_bf16_f32 v208, v192, v193
    v_cvt_pk_bf16_f32 v209, v194, v195
    v_mfma_f32_16x16x32_bf16 v[204:207], a[116:119], a[52:55], v[204:207]
    v_exp_f32 v196, v196
    v_mfma_f32_16x16x32_bf16 v[204:207], a[120:123], a[56:59], v[204:207]
    v_accvgpr_read_b32 v246, a160
    v_accvgpr_read_b32 v248, a161
    v_mfma_f32_16x16x32_bf16 v[204:207], a[124:127], a[60:63], v[204:207]
    v_exp_f32 v197, v197
    v_mfma_f32_16x16x32_bf16 v[48:51], a[144:147], v[212:215], v[48:51]
    v_add_f32 v246, v246, v248
    v_cmp_nge_f32 vcc, s30, v246
    v_mfma_f32_16x16x32_bf16 v[52:55], a[148:151], v[212:215], v[52:55]
    s_nop 0
    s_or_b64 s[34:35], s[34:35], vcc
    v_exp_f32 v198, v198
    v_mfma_f32_16x16x32_bf16 v[56:59], a[152:155], v[212:215], v[56:59]
    v_rcp_f32 v246, v246
    v_mfma_f32_16x16x32_bf16 v[60:63], a[156:159], v[212:215], v[60:63]
    v_exp_f32 v199, v199
    v_mfma_f32_16x16x32_bf16 v[192:195], a[96:99], a[64:67], v[232:235]
    v_cvt_pk_bf16_f32 v210, v196, v197
    v_cvt_pk_bf16_f32 v211, v198, v199
    v_mfma_f32_16x16x32_bf16 v[192:195], a[100:103], a[68:71], v[192:195]
    v_exp_f32 v200, v200
    v_mfma_f32_16x16x32_bf16 v[192:195], a[104:107], a[72:75], v[192:195]
    v_mul_f32 v0, v246, v0
    v_mul_f32 v1, v246, v1
    v_mfma_f32_16x16x32_bf16 v[192:195], a[108:111], a[76:79], v[192:195]
    v_exp_f32 v201, v201
    v_mfma_f32_16x16x32_bf16 v[64:67], a[128:131], v[208:211], v[64:67]
    v_mul_f32 v2, v246, v2
    v_mul_f32 v3, v246, v3
    v_mfma_f32_16x16x32_bf16 v[68:71], a[132:135], v[208:211], v[68:71]
    v_exp_f32 v202, v202
    v_mfma_f32_16x16x32_bf16 v[72:75], a[136:139], v[208:211], v[72:75]
    v_mul_f32 v4, v246, v4
    v_mul_f32 v5, v246, v5
    v_mfma_f32_16x16x32_bf16 v[76:79], a[140:143], v[208:211], v[76:79]
    v_exp_f32 v203, v203
    v_mfma_f32_16x16x32_bf16 v[196:199], a[112:115], a[64:67], v[232:235]
    v_cvt_pk_bf16_f32 v212, v200, v201
    v_cvt_pk_bf16_f32 v213, v202, v203
    v_mfma_f32_16x16x32_bf16 v[196:199], a[116:119], a[68:71], v[196:199]
    v_exp_f32 v204, v204
    v_mfma_f32_16x16x32_bf16 v[196:199], a[120:123], a[72:75], v[196:199]
    v_mul_f32 v6, v246, v6
    v_mul_f32 v7, v246, v7
    v_mfma_f32_16x16x32_bf16 v[196:199], a[124:127], a[76:79], v[196:199]
    v_exp_f32 v205, v205
    v_mfma_f32_16x16x32_bf16 v[80:83], a[144:147], v[208:211], v[80:83]
    v_cvt_pk_bf16_f32 v0, v0, v1
    v_cvt_pk_bf16_f32 v1, v2, v3
    v_mfma_f32_16x16x32_bf16 v[84:87], a[148:151], v[208:211], v[84:87]
    s_waitcnt vmcnt(4)
    v_exp_f32 v206, v206
    v_mfma_f32_16x16x32_bf16 v[88:91], a[152:155], v[208:211], v[88:91]
    s_barrier
    v_cvt_pk_bf16_f32 v2, v4, v5
    v_cvt_pk_bf16_f32 v3, v6, v7
    v_mfma_f32_16x16x32_bf16 v[92:95], a[156:159], v[208:211], v[92:95]
    v_exp_f32 v207, v207
    v_mfma_f32_16x16x32_bf16 v[200:203], a[96:99], a[80:83], v[236:239]
    v_cvt_pk_bf16_f32 v214, v204, v205
    v_cvt_pk_bf16_f32 v215, v206, v207
    v_mfma_f32_16x16x32_bf16 v[200:203], a[100:103], a[84:87], v[200:203]
    v_exp_f32 v192, v192
    v_mfma_f32_16x16x32_bf16 v[200:203], a[104:107], a[88:91], v[200:203]
    ds_read_b128 a[96:99], v241 offset:33792
    ds_read_b128 a[100:103], v241 offset:33856
    v_mfma_f32_16x16x32_bf16 v[200:203], a[108:111], a[92:95], v[200:203]
    v_exp_f32 v193, v193
    v_smfmac_f32_16x16x64_bf16 a[164:167], a[172:175], v[208:215], v240
    ds_read_b128 a[104:107], v241 offset:33920
    ds_read_b128 a[108:111], v241 offset:33984
    v_mfma_f32_16x16x32_bf16 v[96:99], a[128:131], v[212:215], v[96:99]
    ds_write_b128 v252, v[0:3] offset:0
    v_mfma_f32_16x16x32_bf16 v[100:103], a[132:135], v[212:215], v[100:103]
    v_exp_f32 v194, v194
    v_mfma_f32_16x16x32_bf16 v[104:107], a[136:139], v[212:215], v[104:107]
    v_mul_f32 v8, v246, v8
    v_mul_f32 v9, v246, v9
    v_mfma_f32_16x16x32_bf16 v[108:111], a[140:143], v[212:215], v[108:111]
    v_exp_f32 v195, v195
    v_mfma_f32_16x16x32_bf16 v[204:207], a[112:115], a[80:83], v[236:239]
    v_cvt_pk_bf16_f32 v208, v192, v193
    v_cvt_pk_bf16_f32 v209, v194, v195
    v_mfma_f32_16x16x32_bf16 v[204:207], a[116:119], a[84:87], v[204:207]
    v_exp_f32 v196, v196
    v_mfma_f32_16x16x32_bf16 v[204:207], a[120:123], a[88:91], v[204:207]
    ds_read_b128 a[112:115], v241 offset:34304
    ds_read_b128 a[116:119], v241 offset:34368
    v_mfma_f32_16x16x32_bf16 v[204:207], a[124:127], a[92:95], v[204:207]
    v_exp_f32 v197, v197
    v_mfma_f32_16x16x32_bf16 v[112:115], a[144:147], v[212:215], v[112:115]
    ds_read_b128 a[120:123], v241 offset:34432
    ds_read_b128 a[124:127], v241 offset:34496
    v_mfma_f32_16x16x32_bf16 v[116:119], a[148:151], v[212:215], v[116:119]
    v_exp_f32 v198, v198
    v_mfma_f32_16x16x32_bf16 v[120:123], a[152:155], v[212:215], v[120:123]
    s_add_u32 m0, s24, 16896
    v_mul_f32 v10, v246, v10
    v_mul_f32 v11, v246, v11
    v_mfma_f32_16x16x32_bf16 v[124:127], a[156:159], v[212:215], v[124:127]
    s_waitcnt lgkmcnt(8)
    v_exp_f32 v199, v199
    v_mfma_f32_16x16x32_bf16 v[192:195], a[96:99], a[0:3], 0
    s_waitcnt lgkmcnt(7)
    v_cvt_pk_bf16_f32 v210, v196, v197
    v_cvt_pk_bf16_f32 v211, v198, v199
    v_mfma_f32_16x16x32_bf16 v[192:195], a[100:103], a[4:7], v[192:195]
    s_waitcnt lgkmcnt(6)
    v_exp_f32 v200, v200
    v_mfma_f32_16x16x32_bf16 v[192:195], a[104:107], a[8:11], v[192:195]
    s_waitcnt lgkmcnt(5)
    buffer_load_dwordx4 v243, s[4:7], s20 offen nt lds
    v_mfma_f32_16x16x32_bf16 v[192:195], a[108:111], a[12:15], v[192:195]
    s_add_u32 m0, s24, 16928
    v_exp_f32 v201, v201
    v_mfma_f32_16x16x32_bf16 v[128:131], a[128:131], v[208:211], v[128:131]
    buffer_load_dwordx4 v243, s[4:7], s20 offen offset:1024 nt lds
    v_mfma_f32_16x16x32_bf16 v[132:135], a[132:135], v[208:211], v[132:135]
    s_add_u32 m0, s24, 25344
    v_exp_f32 v202, v202
    v_mfma_f32_16x16x32_bf16 v[136:139], a[136:139], v[208:211], v[136:139]
    buffer_load_dwordx4 v243, s[8:11], s20 offen nt lds
    v_mfma_f32_16x16x32_bf16 v[140:143], a[140:143], v[208:211], v[140:143]
    s_waitcnt lgkmcnt(3)
    v_exp_f32 v203, v203
    v_mfma_f32_16x16x32_bf16 v[196:199], a[112:115], a[0:3], 0
    s_waitcnt lgkmcnt(2)
    v_cvt_pk_bf16_f32 v212, v200, v201
    v_cvt_pk_bf16_f32 v213, v202, v203
    v_mfma_f32_16x16x32_bf16 v[196:199], a[116:119], a[4:7], v[196:199]
    s_waitcnt lgkmcnt(1)
    v_exp_f32 v204, v204
    v_mfma_f32_16x16x32_bf16 v[196:199], a[120:123], a[8:11], v[196:199]
    s_waitcnt lgkmcnt(0)
    v_max3_f32 v244, v192, v193, v194
    v_max_f32 v244, v244, v195
    v_mfma_f32_16x16x32_bf16 v[196:199], a[124:127], a[12:15], v[196:199]
    s_add_u32 m0, s24, 25352
    v_exp_f32 v205, v205
    v_mfma_f32_16x16x32_bf16 v[144:147], a[144:147], v[208:211], v[144:147]
    buffer_load_dwordx4 v243, s[8:11], s20 offen offset:1024 nt lds
    v_mfma_f32_16x16x32_bf16 v[148:151], a[148:151], v[208:211], v[148:151]
    v_exp_f32 v206, v206
    v_mfma_f32_16x16x32_bf16 v[152:155], a[152:155], v[208:211], v[152:155]
    v_mul_f32 v12, v246, v12
    v_mul_f32 v13, v246, v13
    v_mfma_f32_16x16x32_bf16 v[156:159], a[156:159], v[208:211], v[156:159]
    v_exp_f32 v207, v207
    v_mfma_f32_16x16x32_bf16 v[200:203], a[96:99], a[16:19], 0
    v_cvt_pk_bf16_f32 v214, v204, v205
    v_cvt_pk_bf16_f32 v215, v206, v207
    v_mfma_f32_16x16x32_bf16 v[200:203], a[100:103], a[20:23], v[200:203]
    v_max3_f32 v244, v244, v196, v197
    v_max3_f32 v244, v244, v198, v199
    v_mfma_f32_16x16x32_bf16 v[200:203], a[104:107], a[24:27], v[200:203]
    v_mov_b32 v245, v244
    v_mul_f32 v14, v246, v14
    v_mfma_f32_16x16x32_bf16 v[200:203], a[108:111], a[28:31], v[200:203]
    v_permlane16_swap_b32 v244, v245
    v_smfmac_f32_16x16x64_bf16 a[168:171], a[172:175], v[208:215], v240
    v_max_f32 v244, v244, v245
    v_mov_b32 v245, v244
    v_mfma_f32_16x16x32_bf16 v[160:163], a[128:131], v[212:215], v[160:163]
    ds_read_b64_tr_b16 a[128:129], v242 offset:33792
    ds_read_b64_tr_b16 a[130:131], v242 offset:34304
    v_mfma_f32_16x16x32_bf16 v[164:167], a[132:135], v[212:215], v[164:167]
    v_permlane32_swap_b32 v244, v245
    v_mfma_f32_16x16x32_bf16 v[168:171], a[136:139], v[212:215], v[168:171]
    v_min_f32 v216, -v244, -v245
    v_add_f32 v192, v216, v192
    v_mfma_f32_16x16x32_bf16 v[172:175], a[140:143], v[212:215], v[172:175]
    v_add_f32 v193, v216, v193
    v_add_f32 v194, v216, v194
    v_mfma_f32_16x16x32_bf16 v[204:207], a[112:115], a[16:19], 0
    ds_read_b64_tr_b16 a[132:133], v242 offset:33800
    v_add_f32 v195, v216, v195
    v_mfma_f32_16x16x32_bf16 v[204:207], a[116:119], a[20:23], v[204:207]
    v_exp_f32 v192, v192
    v_mfma_f32_16x16x32_bf16 v[204:207], a[120:123], a[24:27], v[204:207]
    v_exp_f32 v193, v193
    v_mfma_f32_16x16x32_bf16 v[204:207], a[124:127], a[28:31], v[204:207]
    v_exp_f32 v194, v194
    v_mfma_f32_16x16x32_bf16 v[176:179], a[144:147], v[212:215], v[176:179]
    v_exp_f32 v195, v195
    v_mfma_f32_16x16x32_bf16 v[180:183], a[148:151], v[212:215], v[180:183]
    ds_read_b64_tr_b16 a[134:135], v242 offset:34312
    v_cvt_pk_bf16_f32 v208, v192, v193
    v_mfma_f32_16x16x32_bf16 v[184:187], a[152:155], v[212:215], v[184:187]
    ds_read_b64_tr_b16 a[136:137], v242 offset:33856
    v_cvt_pk_bf16_f32 v209, v194, v195
    v_mfma_f32_16x16x32_bf16 v[188:191], a[156:159], v[212:215], v[188:191]
    ds_read_b64_tr_b16 a[138:139], v242 offset:34368
    ds_read_b64_tr_b16 a[140:141], v242 offset:33864
    v_mfma_f32_16x16x32_bf16 v[192:195], a[96:99], a[32:35], 0
    ds_read_b64_tr_b16 a[142:143], v242 offset:34376
    v_add_f32 v196, v216, v196
    v_mfma_f32_16x16x32_bf16 v[192:195], a[100:103], a[36:39], v[192:195]
    v_add_f32 v197, v216, v197
    v_add_f32 v198, v216, v198
    v_add_f32 v199, v216, v199
    v_exp_f32 v196, v196
    v_exp_f32 v197, v197
    v_exp_f32 v198, v198
    v_exp_f32 v199, v199
    v_mfma_f32_16x16x32_bf16 v[192:195], a[104:107], a[40:43], v[192:195]
    v_cvt_pk_bf16_f32 v210, v196, v197
    v_cvt_pk_bf16_f32 v211, v198, v199
    v_mfma_f32_16x16x32_bf16 v[192:195], a[108:111], a[44:47], v[192:195]
    s_waitcnt lgkmcnt(6)
    v_mul_f32 v15, v246, v15
    v_cvt_pk_bf16_f32 v8, v8, v9
    v_cvt_pk_bf16_f32 v9, v10, v11
    v_cvt_pk_bf16_f32 v10, v12, v13
    v_cvt_pk_bf16_f32 v11, v14, v15
    v_mfma_f32_16x16x32_bf16 v[0:3], a[128:131], v[208:211], 0
    s_waitcnt lgkmcnt(4)
    ds_write_b128 v253, v[8:11] offset:0
    v_mfma_f32_16x16x32_bf16 v[4:7], a[132:135], v[208:211], 0
    s_waitcnt lgkmcnt(3)
    ds_read_b64_tr_b16 a[144:145], v242 offset:33920
    ds_read_b64_tr_b16 a[146:147], v242 offset:34432
    v_mfma_f32_16x16x32_bf16 v[8:11], a[136:139], v[208:211], 0
    s_waitcnt lgkmcnt(3)
    ds_read_b64_tr_b16 a[148:149], v242 offset:33928
    ds_read_b64_tr_b16 a[150:151], v242 offset:34440
    v_mfma_f32_16x16x32_bf16 v[12:15], a[140:143], v[208:211], 0
    ds_read_b64_tr_b16 a[152:153], v242 offset:33984
    ds_read_b64_tr_b16 a[154:155], v242 offset:34496
    v_mfma_f32_16x16x32_bf16 v[196:199], a[112:115], a[32:35], 0
    ds_read_b64_tr_b16 a[156:157], v242 offset:33992
    ds_read_b64_tr_b16 a[158:159], v242 offset:34504
    v_mfma_f32_16x16x32_bf16 v[196:199], a[116:119], a[36:39], v[196:199]
    ds_read_b128 a[48:51], v249 offset:8960
    v_pk_mul_f32 v[16:17], v[16:17], v[246:247] op_sel_hi:[1,0]
    v_pk_mul_f32 v[18:19], v[18:19], v[246:247] op_sel_hi:[1,0]
    v_pk_mul_f32 v[20:21], v[20:21], v[246:247] op_sel_hi:[1,0]
    v_pk_mul_f32 v[22:23], v[22:23], v[246:247] op_sel_hi:[1,0]
    v_cvt_pk_bf16_f32 v16, v16, v17
    v_cvt_pk_bf16_f32 v17, v18, v19
    v_cvt_pk_bf16_f32 v18, v20, v21
    v_cvt_pk_bf16_f32 v19, v22, v23
    v_mfma_f32_16x16x32_bf16 v[196:199], a[120:123], a[40:43], v[196:199]
    ds_read_b128 a[52:55], v249 offset:9024
    ds_write_b128 v252, v[16:19] offset:2048
    v_mfma_f32_16x16x32_bf16 v[196:199], a[124:127], a[44:47], v[196:199]
    s_waitcnt lgkmcnt(9)
    ds_read_b128 a[56:59], v249 offset:9088
    v_pk_mul_f32 v[24:25], v[24:25], v[246:247] op_sel_hi:[1,0]
    v_pk_mul_f32 v[26:27], v[26:27], v[246:247] op_sel_hi:[1,0]
    v_pk_mul_f32 v[28:29], v[28:29], v[246:247] op_sel_hi:[1,0]
    v_pk_mul_f32 v[30:31], v[30:31], v[246:247] op_sel_hi:[1,0]
    v_cvt_pk_bf16_f32 v24, v24, v25
    v_cvt_pk_bf16_f32 v25, v26, v27
    v_cvt_pk_bf16_f32 v26, v28, v29
    v_cvt_pk_bf16_f32 v27, v30, v31
    v_mfma_f32_16x16x32_bf16 v[16:19], a[144:147], v[208:211], 0
    s_waitcnt lgkmcnt(8)
    ds_read_b128 a[60:63], v249 offset:9152
    ds_write_b128 v253, v[24:27] offset:2048
    v_min_f32 v217, -v244, -v245
    v_min_f32 v218, -v244, -v245
    v_min_f32 v219, -v244, -v245
    v_max3_f32 v244, v200, v201, v202
    v_max_f32 v244, v244, v203
    v_max3_f32 v244, v244, v204, v205
    v_max3_f32 v244, v244, v206, v207
    v_mov_b32 v245, v244
    v_mfma_f32_16x16x32_bf16 v[20:23], a[148:151], v[208:211], 0
    s_waitcnt lgkmcnt(8)
    v_permlane16_swap_b32 v244, v245
    v_max_f32 v244, v244, v245
    v_mov_b32 v245, v244
    v_mfma_f32_16x16x32_bf16 v[24:27], a[152:155], v[208:211], 0
    s_waitcnt lgkmcnt(6)
    v_permlane32_swap_b32 v244, v245
    v_min_f32 v220, -v244, -v245
    v_add_f32 v200, v220, v200
    v_add_f32 v201, v220, v201
    v_add_f32 v202, v220, v202
    v_add_f32 v203, v220, v203
    v_exp_f32 v200, v200
    v_exp_f32 v201, v201
    v_exp_f32 v202, v202
    v_exp_f32 v203, v203
    v_mfma_f32_16x16x32_bf16 v[28:31], a[156:159], v[208:211], 0
    s_waitcnt lgkmcnt(5)
    v_cvt_pk_bf16_f32 v212, v200, v201
    v_cvt_pk_bf16_f32 v213, v202, v203
    v_mfma_f32_16x16x32_bf16 v[200:203], a[96:99], a[48:51], 0
    s_waitcnt lgkmcnt(4)
    v_accvgpr_read_b32 v247, a162
    v_accvgpr_read_b32 v248, a163
    v_mfma_f32_16x16x32_bf16 v[200:203], a[100:103], a[52:55], v[200:203]
    s_waitcnt lgkmcnt(2)
    s_add_u32 s20, s20, 8192
    v_add_f32 v247, v247, v248
    v_cmp_nge_f32 vcc, s30, v247
    v_rcp_f32 v247, v247
    v_mfma_f32_16x16x32_bf16 v[200:203], a[104:107], a[56:59], v[200:203]
    s_waitcnt lgkmcnt(1)
    s_or_b64 s[34:35], s[34:35], vcc
    v_add_f32 v204, v220, v204
    v_add_f32 v205, v220, v205
    v_add_f32 v206, v220, v206
    v_add_f32 v207, v220, v207
    v_exp_f32 v204, v204
    v_exp_f32 v205, v205
    v_exp_f32 v206, v206
    v_exp_f32 v207, v207
    v_pk_mul_f32 v[32:33], v[32:33], v[246:247] op_sel:[0,1] op_sel_hi:[1,1]
    v_pk_mul_f32 v[34:35], v[34:35], v[246:247] op_sel:[0,1] op_sel_hi:[1,1]
    v_pk_mul_f32 v[36:37], v[36:37], v[246:247] op_sel:[0,1] op_sel_hi:[1,1]
    v_pk_mul_f32 v[38:39], v[38:39], v[246:247] op_sel:[0,1] op_sel_hi:[1,1]
    v_cvt_pk_bf16_f32 v32, v32, v33
    v_cvt_pk_bf16_f32 v33, v34, v35
    v_cvt_pk_bf16_f32 v34, v36, v37
    v_cvt_pk_bf16_f32 v35, v38, v39
    v_accvgpr_write_b32 a160, 0
    v_accvgpr_write_b32 a161, 0
    v_accvgpr_write_b32 a162, 0
    v_accvgpr_write_b32 a163, 0
    v_mfma_f32_16x16x32_bf16 v[200:203], a[108:111], a[60:63], v[200:203]
    ds_write_b128 v252, v[32:35] offset:4096
    v_cvt_pk_bf16_f32 v214, v204, v205
    v_cvt_pk_bf16_f32 v215, v206, v207
    s_nop 1
    v_smfmac_f32_16x16x64_bf16 a[160:163], a[172:175], v[208:215], v240
    v_pk_mul_f32 v[40:41], v[40:41], v[246:247] op_sel:[0,1] op_sel_hi:[1,1]
    v_pk_mul_f32 v[42:43], v[42:43], v[246:247] op_sel:[0,1] op_sel_hi:[1,1]
    v_pk_mul_f32 v[44:45], v[44:45], v[246:247] op_sel:[0,1] op_sel_hi:[1,1]
    v_pk_mul_f32 v[46:47], v[46:47], v[246:247] op_sel:[0,1] op_sel_hi:[1,1]
    v_cvt_pk_bf16_f32 v40, v40, v41
    v_cvt_pk_bf16_f32 v41, v42, v43
    v_cvt_pk_bf16_f32 v42, v44, v45
    v_cvt_pk_bf16_f32 v43, v46, v47
    v_mfma_f32_16x16x32_bf16 v[32:35], a[128:131], v[212:215], 0
    ds_write_b128 v253, v[40:43] offset:4096
    v_mfma_f32_16x16x32_bf16 v[36:39], a[132:135], v[212:215], 0
    ds_read_b128 a[64:67], v249 offset:16896
    v_mul_f32 v48, v247, v48
    v_mfma_f32_16x16x32_bf16 v[40:43], a[136:139], v[212:215], 0
    v_mul_f32 v49, v247, v49
    v_mul_f32 v50, v247, v50
    v_mfma_f32_16x16x32_bf16 v[44:47], a[140:143], v[212:215], 0
    v_mul_f32 v51, v247, v51
    v_mul_f32 v52, v247, v52
    v_mfma_f32_16x16x32_bf16 v[204:207], a[112:115], a[48:51], 0
    v_mul_f32 v53, v247, v53
    v_mul_f32 v54, v247, v54
    v_mfma_f32_16x16x32_bf16 v[204:207], a[116:119], a[52:55], v[204:207]
    v_mul_f32 v55, v247, v55
    v_cvt_pk_bf16_f32 v48, v48, v49
    v_cvt_pk_bf16_f32 v49, v50, v51
    v_cvt_pk_bf16_f32 v50, v52, v53
    v_cvt_pk_bf16_f32 v51, v54, v55
    v_mfma_f32_16x16x32_bf16 v[204:207], a[120:123], a[56:59], v[204:207]
    ds_read_b128 a[68:71], v249 offset:16960
    ds_write_b128 v252, v[48:51] offset:6144
    v_mfma_f32_16x16x32_bf16 v[204:207], a[124:127], a[60:63], v[204:207]
    ds_read_b128 a[72:75], v249 offset:17024
    v_pk_mul_f32 v[56:57], v[56:57], v[246:247] op_sel:[0,1] op_sel_hi:[1,1]
    v_pk_mul_f32 v[58:59], v[58:59], v[246:247] op_sel:[0,1] op_sel_hi:[1,1]
    v_pk_mul_f32 v[60:61], v[60:61], v[246:247] op_sel:[0,1] op_sel_hi:[1,1]
    v_pk_mul_f32 v[62:63], v[62:63], v[246:247] op_sel:[0,1] op_sel_hi:[1,1]
    v_cvt_pk_bf16_f32 v56, v56, v57
    v_cvt_pk_bf16_f32 v57, v58, v59
    v_cvt_pk_bf16_f32 v58, v60, v61
    v_cvt_pk_bf16_f32 v59, v62, v63
    v_mfma_f32_16x16x32_bf16 v[48:51], a[144:147], v[212:215], 0
    ds_read_b128 a[76:79], v249 offset:17088
    ds_write_b128 v253, v[56:59] offset:6144
    v_min_f32 v221, -v244, -v245
    v_min_f32 v222, -v244, -v245
    v_min_f32 v223, -v244, -v245
    v_max3_f32 v244, v192, v193, v194
    v_max_f32 v244, v244, v195
    v_max3_f32 v244, v244, v196, v197
    v_max3_f32 v244, v244, v198, v199
    v_mov_b32 v245, v244
    v_mfma_f32_16x16x32_bf16 v[52:55], a[148:151], v[212:215], 0
    s_nop 0
    v_permlane16_swap_b32 v244, v245
    v_max_f32 v244, v244, v245
    v_mov_b32 v245, v244
    v_mfma_f32_16x16x32_bf16 v[56:59], a[152:155], v[212:215], 0
    s_nop 0
    v_permlane32_swap_b32 v244, v245
    v_min_f32 v224, -v244, -v245
    v_add_f32 v192, v224, v192
    v_add_f32 v193, v224, v193
    v_add_f32 v194, v224, v194
    v_add_f32 v195, v224, v195
    v_exp_f32 v192, v192
    v_exp_f32 v193, v193
    v_exp_f32 v194, v194
    v_exp_f32 v195, v195
    v_mfma_f32_16x16x32_bf16 v[60:63], a[156:159], v[212:215], 0
    s_waitcnt lgkmcnt(5)
    v_cvt_pk_bf16_f32 v208, v192, v193
    v_cvt_pk_bf16_f32 v209, v194, v195
    v_mfma_f32_16x16x32_bf16 v[192:195], a[96:99], a[64:67], 0
    s_waitcnt lgkmcnt(4)
    v_accvgpr_read_b32 v246, a164
    v_accvgpr_read_b32 v248, a165
    v_add_f32 v246, v246, v248
    v_cmp_nge_f32 vcc, s30, v246
    v_rcp_f32 v246, v246
    v_mfma_f32_16x16x32_bf16 v[192:195], a[100:103], a[68:71], v[192:195]
    s_waitcnt lgkmcnt(2)
    s_or_b64 s[34:35], s[34:35], vcc
    v_add_f32 v196, v224, v196
    v_add_f32 v197, v224, v197
    v_add_f32 v198, v224, v198
    v_add_f32 v199, v224, v199
    v_exp_f32 v196, v196
    v_exp_f32 v197, v197
    v_exp_f32 v198, v198
    v_exp_f32 v199, v199
    v_pk_mul_f32 v[64:65], v[64:65], v[246:247] op_sel_hi:[1,0]
    v_pk_mul_f32 v[66:67], v[66:67], v[246:247] op_sel_hi:[1,0]
    v_pk_mul_f32 v[68:69], v[68:69], v[246:247] op_sel_hi:[1,0]
    v_pk_mul_f32 v[70:71], v[70:71], v[246:247] op_sel_hi:[1,0]
    v_cvt_pk_bf16_f32 v64, v64, v65
    v_cvt_pk_bf16_f32 v65, v66, v67
    v_cvt_pk_bf16_f32 v66, v68, v69
    v_cvt_pk_bf16_f32 v67, v70, v71
    v_mfma_f32_16x16x32_bf16 v[192:195], a[104:107], a[72:75], v[192:195]
    s_waitcnt lgkmcnt(1)
    ds_write_b128 v252, v[64:67] offset:8192
    v_cvt_pk_bf16_f32 v210, v196, v197
    v_cvt_pk_bf16_f32 v211, v198, v199
    v_mfma_f32_16x16x32_bf16 v[192:195], a[108:111], a[76:79], v[192:195]
    v_pk_mul_f32 v[72:73], v[72:73], v[246:247] op_sel_hi:[1,0]
    v_pk_mul_f32 v[74:75], v[74:75], v[246:247] op_sel_hi:[1,0]
    v_pk_mul_f32 v[76:77], v[76:77], v[246:247] op_sel_hi:[1,0]
    v_pk_mul_f32 v[78:79], v[78:79], v[246:247] op_sel_hi:[1,0]
    v_cvt_pk_bf16_f32 v72, v72, v73
    v_cvt_pk_bf16_f32 v73, v74, v75
    v_cvt_pk_bf16_f32 v74, v76, v77
    v_cvt_pk_bf16_f32 v75, v78, v79
    v_mfma_f32_16x16x32_bf16 v[64:67], a[128:131], v[208:211], 0
    ds_write_b128 v253, v[72:75] offset:8192
    v_mfma_f32_16x16x32_bf16 v[68:71], a[132:135], v[208:211], 0
    ds_read_b128 a[80:83], v249 offset:17408
    v_mul_f32 v80, v246, v80
    v_mfma_f32_16x16x32_bf16 v[72:75], a[136:139], v[208:211], 0
    v_mul_f32 v81, v246, v81
    v_mul_f32 v82, v246, v82
    v_mfma_f32_16x16x32_bf16 v[76:79], a[140:143], v[208:211], 0
    v_mul_f32 v83, v246, v83
    v_mul_f32 v84, v246, v84
    v_mfma_f32_16x16x32_bf16 v[196:199], a[112:115], a[64:67], 0
    v_mul_f32 v85, v246, v85
    v_mul_f32 v86, v246, v86
    v_mfma_f32_16x16x32_bf16 v[196:199], a[116:119], a[68:71], v[196:199]
    v_mul_f32 v87, v246, v87
    v_cvt_pk_bf16_f32 v80, v80, v81
    v_cvt_pk_bf16_f32 v81, v82, v83
    v_cvt_pk_bf16_f32 v82, v84, v85
    v_cvt_pk_bf16_f32 v83, v86, v87
    v_mfma_f32_16x16x32_bf16 v[196:199], a[120:123], a[72:75], v[196:199]
    ds_read_b128 a[84:87], v249 offset:17472
    ds_write_b128 v252, v[80:83] offset:10240
    v_mfma_f32_16x16x32_bf16 v[196:199], a[124:127], a[76:79], v[196:199]
    ds_read_b128 a[88:91], v249 offset:17536
    v_pk_mul_f32 v[88:89], v[88:89], v[246:247] op_sel_hi:[1,0]
    v_pk_mul_f32 v[90:91], v[90:91], v[246:247] op_sel_hi:[1,0]
    v_pk_mul_f32 v[92:93], v[92:93], v[246:247] op_sel_hi:[1,0]
    v_pk_mul_f32 v[94:95], v[94:95], v[246:247] op_sel_hi:[1,0]
    v_cvt_pk_bf16_f32 v88, v88, v89
    v_cvt_pk_bf16_f32 v89, v90, v91
    v_cvt_pk_bf16_f32 v90, v92, v93
    v_cvt_pk_bf16_f32 v91, v94, v95
    v_mfma_f32_16x16x32_bf16 v[80:83], a[144:147], v[208:211], 0
    ds_read_b128 a[92:95], v249 offset:17600
    ds_write_b128 v253, v[88:91] offset:10240
    v_min_f32 v225, -v244, -v245
    v_min_f32 v226, -v244, -v245
    v_min_f32 v227, -v244, -v245
    v_max3_f32 v244, v200, v201, v202
    v_max_f32 v244, v244, v203
    v_max3_f32 v244, v244, v204, v205
    v_max3_f32 v244, v244, v206, v207
    v_mov_b32 v245, v244
    v_mfma_f32_16x16x32_bf16 v[84:87], a[148:151], v[208:211], 0
    s_waitcnt vmcnt(4)
    v_permlane16_swap_b32 v244, v245
    v_max_f32 v244, v244, v245
    v_mov_b32 v245, v244
    v_mfma_f32_16x16x32_bf16 v[88:91], a[152:155], v[208:211], 0
    s_barrier
    v_permlane32_swap_b32 v244, v245
    v_min_f32 v228, -v244, -v245
    v_add_f32 v200, v228, v200
    v_add_f32 v201, v228, v201
    v_add_f32 v202, v228, v202
    v_add_f32 v203, v228, v203
    v_exp_f32 v200, v200
    v_exp_f32 v201, v201
    v_exp_f32 v202, v202
    v_exp_f32 v203, v203
    v_mfma_f32_16x16x32_bf16 v[92:95], a[156:159], v[208:211], 0
    s_waitcnt lgkmcnt(5)
    v_cvt_pk_bf16_f32 v212, v200, v201
    v_cvt_pk_bf16_f32 v213, v202, v203
    v_mfma_f32_16x16x32_bf16 v[200:203], a[96:99], a[80:83], 0
    s_waitcnt lgkmcnt(4)
    v_accvgpr_read_b32 v247, a166
    v_accvgpr_read_b32 v248, a167
    v_mfma_f32_16x16x32_bf16 v[200:203], a[100:103], a[84:87], v[200:203]
    s_waitcnt lgkmcnt(2)
    v_add_f32 v247, v247, v248
    v_cmp_nge_f32 vcc, s30, v247
    v_rcp_f32 v247, v247
    v_mfma_f32_16x16x32_bf16 v[200:203], a[104:107], a[88:91], v[200:203]
    s_waitcnt lgkmcnt(1)
    s_or_b64 s[34:35], s[34:35], vcc
    v_add_f32 v204, v228, v204
    v_add_f32 v205, v228, v205
    v_add_f32 v206, v228, v206
    v_add_f32 v207, v228, v207
    v_exp_f32 v204, v204
    v_exp_f32 v205, v205
    v_exp_f32 v206, v206
    v_exp_f32 v207, v207
    v_pk_mul_f32 v[96:97], v[96:97], v[246:247] op_sel:[0,1] op_sel_hi:[1,1]
    v_pk_mul_f32 v[98:99], v[98:99], v[246:247] op_sel:[0,1] op_sel_hi:[1,1]
    v_pk_mul_f32 v[100:101], v[100:101], v[246:247] op_sel:[0,1] op_sel_hi:[1,1]
    v_pk_mul_f32 v[102:103], v[102:103], v[246:247] op_sel:[0,1] op_sel_hi:[1,1]
    v_cvt_pk_bf16_f32 v96, v96, v97
    v_cvt_pk_bf16_f32 v97, v98, v99
    v_cvt_pk_bf16_f32 v98, v100, v101
    v_cvt_pk_bf16_f32 v99, v102, v103
    v_accvgpr_write_b32 a164, 0
    v_accvgpr_write_b32 a165, 0
    v_accvgpr_write_b32 a166, 0
    v_accvgpr_write_b32 a167, 0
    v_mfma_f32_16x16x32_bf16 v[200:203], a[108:111], a[92:95], v[200:203]
    ds_write_b128 v252, v[96:99] offset:12288
    v_cvt_pk_bf16_f32 v214, v204, v205
    v_cvt_pk_bf16_f32 v215, v206, v207
    s_nop 1
    v_smfmac_f32_16x16x64_bf16 a[164:167], a[172:175], v[208:215], v240
    v_pk_mul_f32 v[104:105], v[104:105], v[246:247] op_sel:[0,1] op_sel_hi:[1,1]
    v_pk_mul_f32 v[106:107], v[106:107], v[246:247] op_sel:[0,1] op_sel_hi:[1,1]
    v_pk_mul_f32 v[108:109], v[108:109], v[246:247] op_sel:[0,1] op_sel_hi:[1,1]
    v_pk_mul_f32 v[110:111], v[110:111], v[246:247] op_sel:[0,1] op_sel_hi:[1,1]
    v_cvt_pk_bf16_f32 v104, v104, v105
    v_cvt_pk_bf16_f32 v105, v106, v107
    v_cvt_pk_bf16_f32 v106, v108, v109
    v_cvt_pk_bf16_f32 v107, v110, v111
    v_mfma_f32_16x16x32_bf16 v[96:99], a[128:131], v[212:215], 0
    ds_write_b128 v253, v[104:107] offset:12288
    v_mfma_f32_16x16x32_bf16 v[100:103], a[132:135], v[212:215], 0
    ds_read_b128 a[96:99], v241 offset:0
    v_mul_f32 v112, v247, v112
    v_mfma_f32_16x16x32_bf16 v[104:107], a[136:139], v[212:215], 0
    v_mul_f32 v113, v247, v113
    v_mul_f32 v114, v247, v114
    v_mfma_f32_16x16x32_bf16 v[108:111], a[140:143], v[212:215], 0
    v_mul_f32 v115, v247, v115
    v_mul_f32 v116, v247, v116
    v_mfma_f32_16x16x32_bf16 v[204:207], a[112:115], a[80:83], 0
    v_mul_f32 v117, v247, v117
    v_mul_f32 v118, v247, v118
    v_mfma_f32_16x16x32_bf16 v[204:207], a[116:119], a[84:87], v[204:207]
    v_mul_f32 v119, v247, v119
    v_cvt_pk_bf16_f32 v112, v112, v113
    v_cvt_pk_bf16_f32 v113, v114, v115
    v_cvt_pk_bf16_f32 v114, v116, v117
    v_cvt_pk_bf16_f32 v115, v118, v119
    v_mfma_f32_16x16x32_bf16 v[204:207], a[120:123], a[88:91], v[204:207]
    ds_read_b128 a[100:103], v241 offset:64
    ds_write_b128 v252, v[112:115] offset:14336
    v_mfma_f32_16x16x32_bf16 v[204:207], a[124:127], a[92:95], v[204:207]
    ds_read_b128 a[104:107], v241 offset:128
    v_pk_mul_f32 v[120:121], v[120:121], v[246:247] op_sel:[0,1] op_sel_hi:[1,1]
    v_pk_mul_f32 v[122:123], v[122:123], v[246:247] op_sel:[0,1] op_sel_hi:[1,1]
    v_pk_mul_f32 v[124:125], v[124:125], v[246:247] op_sel:[0,1] op_sel_hi:[1,1]
    v_pk_mul_f32 v[126:127], v[126:127], v[246:247] op_sel:[0,1] op_sel_hi:[1,1]
    v_cvt_pk_bf16_f32 v120, v120, v121
    v_cvt_pk_bf16_f32 v121, v122, v123
    v_cvt_pk_bf16_f32 v122, v124, v125
    v_cvt_pk_bf16_f32 v123, v126, v127
    v_mfma_f32_16x16x32_bf16 v[112:115], a[144:147], v[212:215], 0
    ds_read_b128 a[108:111], v241 offset:192
    ds_write_b128 v253, v[120:123] offset:14336
    v_min_f32 v229, -v244, -v245
    v_min_f32 v230, -v244, -v245
    v_min_f32 v231, -v244, -v245
    v_max3_f32 v244, v192, v193, v194
    v_max_f32 v244, v244, v195
    v_max3_f32 v244, v244, v196, v197
    v_max3_f32 v244, v244, v198, v199
    v_mov_b32 v245, v244
    v_mfma_f32_16x16x32_bf16 v[116:119], a[148:151], v[212:215], 0
    s_nop 0
    v_permlane16_swap_b32 v244, v245
    v_max_f32 v244, v244, v245
    v_mov_b32 v245, v244
    v_mfma_f32_16x16x32_bf16 v[120:123], a[152:155], v[212:215], 0
    s_add_u32 m0, s24, 33792
    v_permlane32_swap_b32 v244, v245
    v_min_f32 v232, -v244, -v245
    v_add_f32 v192, v232, v192
    v_add_f32 v193, v232, v193
    v_add_f32 v194, v232, v194
    v_add_f32 v195, v232, v195
    v_exp_f32 v192, v192
    v_exp_f32 v193, v193
    v_exp_f32 v194, v194
    v_exp_f32 v195, v195
    v_mfma_f32_16x16x32_bf16 v[124:127], a[156:159], v[212:215], 0
    s_waitcnt lgkmcnt(5)
    v_cvt_pk_bf16_f32 v208, v192, v193
    v_cvt_pk_bf16_f32 v209, v194, v195
    v_mfma_f32_16x16x32_bf16 v[192:195], a[96:99], a[0:3], v[216:219]
    s_waitcnt lgkmcnt(4)
    v_accvgpr_read_b32 v246, a168
    v_accvgpr_read_b32 v248, a169
    v_add_f32 v246, v246, v248
    v_cmp_nge_f32 vcc, s30, v246
    v_rcp_f32 v246, v246
    v_mfma_f32_16x16x32_bf16 v[192:195], a[100:103], a[4:7], v[192:195]
    s_waitcnt lgkmcnt(2)
    ds_read_b128 a[112:115], v241 offset:512
    v_add_f32 v196, v232, v196
    v_add_f32 v197, v232, v197
    v_add_f32 v198, v232, v198
    v_add_f32 v199, v232, v199
    v_exp_f32 v196, v196
    v_exp_f32 v197, v197
    v_exp_f32 v198, v198
    v_exp_f32 v199, v199
    v_pk_mul_f32 v[128:129], v[128:129], v[246:247] op_sel_hi:[1,0]
    v_pk_mul_f32 v[130:131], v[130:131], v[246:247] op_sel_hi:[1,0]
    v_pk_mul_f32 v[132:133], v[132:133], v[246:247] op_sel_hi:[1,0]
    v_pk_mul_f32 v[134:135], v[134:135], v[246:247] op_sel_hi:[1,0]
    v_cvt_pk_bf16_f32 v128, v128, v129
    v_cvt_pk_bf16_f32 v129, v130, v131
    v_cvt_pk_bf16_f32 v130, v132, v133
    v_cvt_pk_bf16_f32 v131, v134, v135
    v_mfma_f32_16x16x32_bf16 v[192:195], a[104:107], a[8:11], v[192:195]
    s_waitcnt lgkmcnt(2)
    ds_read_b128 a[116:119], v241 offset:576
    ds_write_b128 v252, v[128:131] offset:16384
    v_cvt_pk_bf16_f32 v210, v196, v197
    v_cvt_pk_bf16_f32 v211, v198, v199
    v_mfma_f32_16x16x32_bf16 v[192:195], a[108:111], a[12:15], v[192:195]
    s_or_b64 s[34:35], s[34:35], vcc
    ds_read_b128 a[120:123], v241 offset:640
    v_pk_mul_f32 v[136:137], v[136:137], v[246:247] op_sel_hi:[1,0]
    v_pk_mul_f32 v[138:139], v[138:139], v[246:247] op_sel_hi:[1,0]
    v_pk_mul_f32 v[140:141], v[140:141], v[246:247] op_sel_hi:[1,0]
    v_pk_mul_f32 v[142:143], v[142:143], v[246:247] op_sel_hi:[1,0]
    v_cvt_pk_bf16_f32 v136, v136, v137
    v_cvt_pk_bf16_f32 v137, v138, v139
    v_cvt_pk_bf16_f32 v138, v140, v141
    v_cvt_pk_bf16_f32 v139, v142, v143
    v_mfma_f32_16x16x32_bf16 v[128:131], a[128:131], v[208:211], 0
    ds_read_b128 a[124:127], v241 offset:704
    ds_write_b128 v253, v[136:139] offset:16384
    v_mfma_f32_16x16x32_bf16 v[132:135], a[132:135], v[208:211], 0
    buffer_load_dwordx4 v243, s[4:7], s20 offen nt lds
    v_mfma_f32_16x16x32_bf16 v[136:139], a[136:139], v[208:211], 0
    s_add_u32 m0, s24, 33824
    v_mul_f32 v144, v246, v144
    v_mul_f32 v145, v246, v145
    v_mfma_f32_16x16x32_bf16 v[140:143], a[140:143], v[208:211], 0
    s_waitcnt lgkmcnt(5)
    v_mul_f32 v146, v246, v146
    v_mul_f32 v147, v246, v147
    v_mfma_f32_16x16x32_bf16 v[196:199], a[112:115], a[0:3], v[216:219]
    s_waitcnt lgkmcnt(4)
    v_mul_f32 v148, v246, v148
    v_mul_f32 v149, v246, v149
    v_mfma_f32_16x16x32_bf16 v[196:199], a[116:119], a[4:7], v[196:199]
    s_waitcnt lgkmcnt(2)
    v_mul_f32 v150, v246, v150
    v_mul_f32 v151, v246, v151
    v_cvt_pk_bf16_f32 v144, v144, v145
    v_cvt_pk_bf16_f32 v145, v146, v147
    v_cvt_pk_bf16_f32 v146, v148, v149
    v_cvt_pk_bf16_f32 v147, v150, v151
    v_mfma_f32_16x16x32_bf16 v[196:199], a[120:123], a[8:11], v[196:199]
    s_waitcnt lgkmcnt(1)
    buffer_load_dwordx4 v243, s[4:7], s20 offen offset:1024 nt lds
    ds_write_b128 v252, v[144:147] offset:18432
    v_mfma_f32_16x16x32_bf16 v[196:199], a[124:127], a[12:15], v[196:199]
    s_add_u32 m0, s24, 42240
    v_pk_mul_f32 v[152:153], v[152:153], v[246:247] op_sel_hi:[1,0]
    v_pk_mul_f32 v[154:155], v[154:155], v[246:247] op_sel_hi:[1,0]
    v_pk_mul_f32 v[156:157], v[156:157], v[246:247] op_sel_hi:[1,0]
    v_pk_mul_f32 v[158:159], v[158:159], v[246:247] op_sel_hi:[1,0]
    v_cvt_pk_bf16_f32 v152, v152, v153
    v_cvt_pk_bf16_f32 v153, v154, v155
    v_cvt_pk_bf16_f32 v154, v156, v157
    v_cvt_pk_bf16_f32 v155, v158, v159
    v_mfma_f32_16x16x32_bf16 v[144:147], a[144:147], v[208:211], 0
    buffer_load_dwordx4 v243, s[8:11], s20 offen nt lds
    ds_write_b128 v253, v[152:155] offset:18432
    v_min_f32 v233, -v244, -v245
    v_min_f32 v234, -v244, -v245
    v_min_f32 v235, -v244, -v245
    v_max3_f32 v244, v200, v201, v202
    v_max_f32 v244, v244, v203
    v_max3_f32 v244, v244, v204, v205
    v_max3_f32 v244, v244, v206, v207
    v_mov_b32 v245, v244
    v_mfma_f32_16x16x32_bf16 v[148:151], a[148:151], v[208:211], 0
    s_add_u32 m0, s24, 42248
    v_permlane16_swap_b32 v244, v245
    v_max_f32 v244, v244, v245
    v_mov_b32 v245, v244
    v_mfma_f32_16x16x32_bf16 v[152:155], a[152:155], v[208:211], 0
    buffer_load_dwordx4 v243, s[8:11], s20 offen offset:1024 nt lds
    v_permlane32_swap_b32 v244, v245
    v_min_f32 v236, -v244, -v245
    v_add_f32 v200, v236, v200
    v_add_f32 v201, v236, v201
    v_add_f32 v202, v236, v202
    v_add_f32 v203, v236, v203
    v_exp_f32 v200, v200
    v_exp_f32 v201, v201
    v_exp_f32 v202, v202
    v_exp_f32 v203, v203
    v_mfma_f32_16x16x32_bf16 v[156:159], a[156:159], v[208:211], 0
    v_cvt_pk_bf16_f32 v212, v200, v201
    v_cvt_pk_bf16_f32 v213, v202, v203
    v_mfma_f32_16x16x32_bf16 v[200:203], a[96:99], a[16:19], v[220:223]
    v_accvgpr_read_b32 v247, a170
    v_accvgpr_read_b32 v248, a171
    v_mfma_f32_16x16x32_bf16 v[200:203], a[100:103], a[20:23], v[200:203]
    v_exp_f32 v192, v192
    v_add_f32 v247, v247, v248
    v_cmp_nge_f32 vcc, s30, v247
    v_rcp_f32 v247, v247
    v_mfma_f32_16x16x32_bf16 v[200:203], a[104:107], a[24:27], v[200:203]
    s_or_b64 s[34:35], s[34:35], vcc
    v_add_f32 v204, v236, v204
    v_add_f32 v205, v236, v205
    v_add_f32 v206, v236, v206
    v_add_f32 v207, v236, v207
    v_exp_f32 v204, v204
    v_exp_f32 v205, v205
    v_exp_f32 v206, v206
    v_exp_f32 v207, v207
    v_pk_mul_f32 v[160:161], v[160:161], v[246:247] op_sel:[0,1] op_sel_hi:[1,1]
    v_pk_mul_f32 v[162:163], v[162:163], v[246:247] op_sel:[0,1] op_sel_hi:[1,1]
    v_pk_mul_f32 v[164:165], v[164:165], v[246:247] op_sel:[0,1] op_sel_hi:[1,1]
    v_pk_mul_f32 v[166:167], v[166:167], v[246:247] op_sel:[0,1] op_sel_hi:[1,1]
    v_cvt_pk_bf16_f32 v160, v160, v161
    v_cvt_pk_bf16_f32 v161, v162, v163
    v_cvt_pk_bf16_f32 v162, v164, v165
    v_cvt_pk_bf16_f32 v163, v166, v167
    v_accvgpr_write_b32 a168, 0
    v_accvgpr_write_b32 a169, 0
    v_accvgpr_write_b32 a170, 0
    v_accvgpr_write_b32 a171, 0
    v_mfma_f32_16x16x32_bf16 v[200:203], a[108:111], a[28:31], v[200:203]
    ds_write_b128 v252, v[160:163] offset:20480
    v_exp_f32 v193, v193
    v_cvt_pk_bf16_f32 v214, v204, v205
    v_cvt_pk_bf16_f32 v215, v206, v207
    s_nop 1
    v_smfmac_f32_16x16x64_bf16 a[168:171], a[172:175], v[208:215], v240
    v_pk_mul_f32 v[168:169], v[168:169], v[246:247] op_sel:[0,1] op_sel_hi:[1,1]
    v_pk_mul_f32 v[170:171], v[170:171], v[246:247] op_sel:[0,1] op_sel_hi:[1,1]
    v_pk_mul_f32 v[172:173], v[172:173], v[246:247] op_sel:[0,1] op_sel_hi:[1,1]
    v_pk_mul_f32 v[174:175], v[174:175], v[246:247] op_sel:[0,1] op_sel_hi:[1,1]
    v_cvt_pk_bf16_f32 v168, v168, v169
    v_cvt_pk_bf16_f32 v169, v170, v171
    v_cvt_pk_bf16_f32 v170, v172, v173
    v_cvt_pk_bf16_f32 v171, v174, v175
    v_mfma_f32_16x16x32_bf16 v[160:163], a[128:131], v[212:215], 0
    ds_write_b128 v253, v[168:171] offset:20480
    v_mfma_f32_16x16x32_bf16 v[164:167], a[132:135], v[212:215], 0
    v_exp_f32 v194, v194
    v_mfma_f32_16x16x32_bf16 v[168:171], a[136:139], v[212:215], 0
    v_mul_f32 v176, v247, v176
    v_mul_f32 v177, v247, v177
    v_mfma_f32_16x16x32_bf16 v[172:175], a[140:143], v[212:215], 0
    v_exp_f32 v195, v195
    v_mfma_f32_16x16x32_bf16 v[204:207], a[112:115], a[16:19], v[220:223]
    v_cvt_pk_bf16_f32 v208, v192, v193
    v_cvt_pk_bf16_f32 v209, v194, v195
    v_mfma_f32_16x16x32_bf16 v[204:207], a[116:119], a[20:23], v[204:207]
    v_exp_f32 v196, v196
    v_mul_f32 v178, v247, v178
    v_mul_f32 v179, v247, v179
    v_mul_f32 v180, v247, v180
    v_mul_f32 v181, v247, v181
    v_mul_f32 v182, v247, v182
    v_mul_f32 v183, v247, v183
    v_cvt_pk_bf16_f32 v176, v176, v177
    v_cvt_pk_bf16_f32 v177, v178, v179
    v_cvt_pk_bf16_f32 v178, v180, v181
    v_cvt_pk_bf16_f32 v179, v182, v183
    v_mfma_f32_16x16x32_bf16 v[204:207], a[120:123], a[24:27], v[204:207]
    ds_write_b128 v252, v[176:179] offset:22528
    v_mfma_f32_16x16x32_bf16 v[204:207], a[124:127], a[28:31], v[204:207]
    v_exp_f32 v197, v197
    v_pk_mul_f32 v[184:185], v[184:185], v[246:247] op_sel:[0,1] op_sel_hi:[1,1]
    v_pk_mul_f32 v[186:187], v[186:187], v[246:247] op_sel:[0,1] op_sel_hi:[1,1]
    v_pk_mul_f32 v[188:189], v[188:189], v[246:247] op_sel:[0,1] op_sel_hi:[1,1]
    v_pk_mul_f32 v[190:191], v[190:191], v[246:247] op_sel:[0,1] op_sel_hi:[1,1]
    v_cvt_pk_bf16_f32 v184, v184, v185
    v_cvt_pk_bf16_f32 v185, v186, v187
    v_cvt_pk_bf16_f32 v186, v188, v189
    v_cvt_pk_bf16_f32 v187, v190, v191
    v_mfma_f32_16x16x32_bf16 v[176:179], a[144:147], v[212:215], 0
    ds_write_b128 v253, v[184:187] offset:22528
    v_mfma_f32_16x16x32_bf16 v[180:183], a[148:151], v[212:215], 0
    ds_read_b64_tr_b16 a[128:129], v242 offset:0
    ds_read_b64_tr_b16 a[130:131], v242 offset:512
    v_exp_f32 v198, v198
    v_mfma_f32_16x16x32_bf16 v[184:187], a[152:155], v[212:215], 0
    ds_read_b64_tr_b16 a[132:133], v242 offset:8
    ds_read_b64_tr_b16 a[134:135], v242 offset:520
    v_mfma_f32_16x16x32_bf16 v[188:191], a[156:159], v[212:215], 0
    ds_read_b64_tr_b16 a[136:137], v242 offset:64
    ds_read_b64_tr_b16 a[138:139], v242 offset:576
    v_exp_f32 v199, v199
    v_mfma_f32_16x16x32_bf16 v[192:195], a[96:99], a[32:35], v[224:227]
    ds_read_b64_tr_b16 a[140:141], v242 offset:72
    ds_read_b64_tr_b16 a[142:143], v242 offset:584
    v_cvt_pk_bf16_f32 v210, v196, v197
    v_cvt_pk_bf16_f32 v211, v198, v199
    v_mfma_f32_16x16x32_bf16 v[192:195], a[100:103], a[36:39], v[192:195]
    v_exp_f32 v200, v200
    v_mfma_f32_16x16x32_bf16 v[192:195], a[104:107], a[40:43], v[192:195]
    ds_read_b64_tr_b16 a[144:145], v242 offset:128
    ds_read_b64_tr_b16 a[146:147], v242 offset:640
    v_mfma_f32_16x16x32_bf16 v[192:195], a[108:111], a[44:47], v[192:195]
    s_waitcnt lgkmcnt(8)
    v_exp_f32 v201, v201
    v_mfma_f32_16x16x32_bf16 v[0:3], a[128:131], v[208:211], v[0:3]
    s_waitcnt lgkmcnt(6)
    ds_read_b64_tr_b16 a[148:149], v242 offset:136
    ds_read_b64_tr_b16 a[150:151], v242 offset:648
    v_mfma_f32_16x16x32_bf16 v[4:7], a[132:135], v[208:211], v[4:7]
    s_waitcnt lgkmcnt(6)
    v_exp_f32 v202, v202
    v_mfma_f32_16x16x32_bf16 v[8:11], a[136:139], v[208:211], v[8:11]
    s_waitcnt lgkmcnt(4)
    ds_read_b64_tr_b16 a[152:153], v242 offset:192
    ds_read_b64_tr_b16 a[154:155], v242 offset:704
    v_mfma_f32_16x16x32_bf16 v[12:15], a[140:143], v[208:211], v[12:15]
    v_exp_f32 v203, v203
    v_mfma_f32_16x16x32_bf16 v[196:199], a[112:115], a[32:35], v[224:227]
    ds_read_b64_tr_b16 a[156:157], v242 offset:200
    ds_read_b64_tr_b16 a[158:159], v242 offset:712
    v_cvt_pk_bf16_f32 v212, v200, v201
    v_cvt_pk_bf16_f32 v213, v202, v203
    v_mfma_f32_16x16x32_bf16 v[196:199], a[116:119], a[36:39], v[196:199]
    v_exp_f32 v204, v204
    v_mfma_f32_16x16x32_bf16 v[196:199], a[120:123], a[40:43], v[196:199]
    v_min_f32 v237, -v244, -v245
    v_min_f32 v238, -v244, -v245
    v_mfma_f32_16x16x32_bf16 v[196:199], a[124:127], a[44:47], v[196:199]
    s_waitcnt lgkmcnt(6)
    v_exp_f32 v205, v205
    v_mfma_f32_16x16x32_bf16 v[16:19], a[144:147], v[208:211], v[16:19]
    s_waitcnt lgkmcnt(4)
    v_min_f32 v239, -v244, -v245
    v_bfe_u32 v252, v243, 7, 3
    v_mfma_f32_16x16x32_bf16 v[20:23], a[148:151], v[208:211], v[20:23]
    s_waitcnt lgkmcnt(2)
    v_exp_f32 v206, v206
    v_mfma_f32_16x16x32_bf16 v[24:27], a[152:155], v[208:211], v[24:27]
    s_waitcnt lgkmcnt(0)
    v_bfe_u32 v253, v243, 4, 3
    v_xor_b32 v253, v252, v253
    v_mfma_f32_16x16x32_bf16 v[28:31], a[156:159], v[208:211], v[28:31]
    v_exp_f32 v207, v207
    v_mfma_f32_16x16x32_bf16 v[200:203], a[96:99], a[48:51], v[228:231]
    v_cvt_pk_bf16_f32 v214, v204, v205
    v_cvt_pk_bf16_f32 v215, v206, v207
    v_mfma_f32_16x16x32_bf16 v[200:203], a[100:103], a[52:55], v[200:203]
    s_add_u32 s20, s20, 8192
    v_exp_f32 v192, v192
    v_mfma_f32_16x16x32_bf16 v[200:203], a[104:107], a[56:59], v[200:203]
    v_lshl_add_u32 v252, v252, 3, v253
    v_lshlrev_b32 v252, 4, v252
    v_mfma_f32_16x16x32_bf16 v[200:203], a[108:111], a[60:63], v[200:203]
    v_exp_f32 v193, v193
    v_smfmac_f32_16x16x64_bf16 a[160:163], a[172:175], v[208:215], v240
    v_add_u32 v252, s42, v252
    v_mfma_f32_16x16x32_bf16 v[32:35], a[128:131], v[212:215], v[32:35]
    v_mfma_f32_16x16x32_bf16 v[36:39], a[132:135], v[212:215], v[36:39]
    v_exp_f32 v194, v194
    v_mfma_f32_16x16x32_bf16 v[40:43], a[136:139], v[212:215], v[40:43]
    v_mfma_f32_16x16x32_bf16 v[44:47], a[140:143], v[212:215], v[44:47]
    v_exp_f32 v195, v195
    v_mfma_f32_16x16x32_bf16 v[204:207], a[112:115], a[48:51], v[228:231]
    v_cvt_pk_bf16_f32 v208, v192, v193
    v_cvt_pk_bf16_f32 v209, v194, v195
    v_mfma_f32_16x16x32_bf16 v[204:207], a[116:119], a[52:55], v[204:207]
    v_exp_f32 v196, v196
    v_mfma_f32_16x16x32_bf16 v[204:207], a[120:123], a[56:59], v[204:207]
    v_mfma_f32_16x16x32_bf16 v[204:207], a[124:127], a[60:63], v[204:207]
    v_exp_f32 v197, v197
    v_mfma_f32_16x16x32_bf16 v[48:51], a[144:147], v[212:215], v[48:51]
    v_mfma_f32_16x16x32_bf16 v[52:55], a[148:151], v[212:215], v[52:55]
    v_exp_f32 v198, v198
    v_mfma_f32_16x16x32_bf16 v[56:59], a[152:155], v[212:215], v[56:59]
    v_mfma_f32_16x16x32_bf16 v[60:63], a[156:159], v[212:215], v[60:63]
    v_exp_f32 v199, v199
    v_mfma_f32_16x16x32_bf16 v[192:195], a[96:99], a[64:67], v[232:235]
    v_cvt_pk_bf16_f32 v210, v196, v197
    v_cvt_pk_bf16_f32 v211, v198, v199
    v_mfma_f32_16x16x32_bf16 v[192:195], a[100:103], a[68:71], v[192:195]
    v_exp_f32 v200, v200
    v_mfma_f32_16x16x32_bf16 v[192:195], a[104:107], a[72:75], v[192:195]
    v_mfma_f32_16x16x32_bf16 v[192:195], a[108:111], a[76:79], v[192:195]
    v_exp_f32 v201, v201
    v_mfma_f32_16x16x32_bf16 v[64:67], a[128:131], v[208:211], v[64:67]
    v_mfma_f32_16x16x32_bf16 v[68:71], a[132:135], v[208:211], v[68:71]
    v_exp_f32 v202, v202
    v_mfma_f32_16x16x32_bf16 v[72:75], a[136:139], v[208:211], v[72:75]
    v_mfma_f32_16x16x32_bf16 v[76:79], a[140:143], v[208:211], v[76:79]
    v_exp_f32 v203, v203
    v_mfma_f32_16x16x32_bf16 v[196:199], a[112:115], a[64:67], v[232:235]
    v_cvt_pk_bf16_f32 v212, v200, v201
    v_cvt_pk_bf16_f32 v213, v202, v203
    v_mfma_f32_16x16x32_bf16 v[196:199], a[116:119], a[68:71], v[196:199]
    v_exp_f32 v204, v204
    v_mfma_f32_16x16x32_bf16 v[196:199], a[120:123], a[72:75], v[196:199]
    v_mfma_f32_16x16x32_bf16 v[196:199], a[124:127], a[76:79], v[196:199]
    v_exp_f32 v205, v205
    v_mfma_f32_16x16x32_bf16 v[80:83], a[144:147], v[208:211], v[80:83]
    v_mfma_f32_16x16x32_bf16 v[84:87], a[148:151], v[208:211], v[84:87]
    s_waitcnt vmcnt(4)
    v_exp_f32 v206, v206
    v_mfma_f32_16x16x32_bf16 v[88:91], a[152:155], v[208:211], v[88:91]
    s_barrier
    v_mfma_f32_16x16x32_bf16 v[92:95], a[156:159], v[208:211], v[92:95]
    v_exp_f32 v207, v207
    v_mfma_f32_16x16x32_bf16 v[200:203], a[96:99], a[80:83], v[236:239]
    v_cvt_pk_bf16_f32 v214, v204, v205
    v_cvt_pk_bf16_f32 v215, v206, v207
    v_mfma_f32_16x16x32_bf16 v[200:203], a[100:103], a[84:87], v[200:203]
    v_exp_f32 v192, v192
    v_mfma_f32_16x16x32_bf16 v[200:203], a[104:107], a[88:91], v[200:203]
    ds_read_b128 a[96:99], v241 offset:16896
    ds_read_b128 a[100:103], v241 offset:16960
    v_mfma_f32_16x16x32_bf16 v[200:203], a[108:111], a[92:95], v[200:203]
    v_exp_f32 v193, v193
    v_smfmac_f32_16x16x64_bf16 a[164:167], a[172:175], v[208:215], v240
    ds_read_b128 a[104:107], v241 offset:17024
    ds_read_b128 a[108:111], v241 offset:17088
    v_mfma_f32_16x16x32_bf16 v[96:99], a[128:131], v[212:215], v[96:99]
    v_mfma_f32_16x16x32_bf16 v[100:103], a[132:135], v[212:215], v[100:103]
    v_exp_f32 v194, v194
    v_mfma_f32_16x16x32_bf16 v[104:107], a[136:139], v[212:215], v[104:107]
    v_mfma_f32_16x16x32_bf16 v[108:111], a[140:143], v[212:215], v[108:111]
    v_exp_f32 v195, v195
    v_mfma_f32_16x16x32_bf16 v[204:207], a[112:115], a[80:83], v[236:239]
    v_cvt_pk_bf16_f32 v208, v192, v193
    v_cvt_pk_bf16_f32 v209, v194, v195
    v_mfma_f32_16x16x32_bf16 v[204:207], a[116:119], a[84:87], v[204:207]
    v_exp_f32 v196, v196
    v_mfma_f32_16x16x32_bf16 v[204:207], a[120:123], a[88:91], v[204:207]
    ds_read_b128 a[112:115], v241 offset:17408
    ds_read_b128 a[116:119], v241 offset:17472
    v_mfma_f32_16x16x32_bf16 v[204:207], a[124:127], a[92:95], v[204:207]
    v_exp_f32 v197, v197
    v_mfma_f32_16x16x32_bf16 v[112:115], a[144:147], v[212:215], v[112:115]
    ds_read_b128 a[120:123], v241 offset:17536
    ds_read_b128 a[124:127], v241 offset:17600
    v_mfma_f32_16x16x32_bf16 v[116:119], a[148:151], v[212:215], v[116:119]
    v_exp_f32 v198, v198
    v_mfma_f32_16x16x32_bf16 v[120:123], a[152:155], v[212:215], v[120:123]
    s_add_u32 m0, s24, 0
    v_mfma_f32_16x16x32_bf16 v[124:127], a[156:159], v[212:215], v[124:127]
    s_waitcnt lgkmcnt(7)
    v_exp_f32 v199, v199
    v_mfma_f32_16x16x32_bf16 v[192:195], a[96:99], a[0:3], v[216:219]
    s_waitcnt lgkmcnt(6)
    v_cvt_pk_bf16_f32 v210, v196, v197
    v_cvt_pk_bf16_f32 v211, v198, v199
    v_mfma_f32_16x16x32_bf16 v[192:195], a[100:103], a[4:7], v[192:195]
    s_waitcnt lgkmcnt(5)
    v_exp_f32 v200, v200
    v_mfma_f32_16x16x32_bf16 v[192:195], a[104:107], a[8:11], v[192:195]
    s_waitcnt lgkmcnt(4)
    buffer_load_dwordx4 v243, s[4:7], s20 offen nt lds
    v_mfma_f32_16x16x32_bf16 v[192:195], a[108:111], a[12:15], v[192:195]
    s_add_u32 m0, s24, 32
    v_exp_f32 v201, v201
    v_mfma_f32_16x16x32_bf16 v[128:131], a[128:131], v[208:211], v[128:131]
    buffer_load_dwordx4 v243, s[4:7], s20 offen offset:1024 nt lds
    v_mfma_f32_16x16x32_bf16 v[132:135], a[132:135], v[208:211], v[132:135]
    s_add_u32 m0, s24, 8448
    v_exp_f32 v202, v202
    v_mfma_f32_16x16x32_bf16 v[136:139], a[136:139], v[208:211], v[136:139]
    buffer_load_dwordx4 v243, s[8:11], s20 offen nt lds
    v_mfma_f32_16x16x32_bf16 v[140:143], a[140:143], v[208:211], v[140:143]
    s_waitcnt lgkmcnt(3)
    v_exp_f32 v203, v203
    v_mfma_f32_16x16x32_bf16 v[196:199], a[112:115], a[0:3], v[216:219]
    s_waitcnt lgkmcnt(2)
    v_cvt_pk_bf16_f32 v212, v200, v201
    v_cvt_pk_bf16_f32 v213, v202, v203
    v_mfma_f32_16x16x32_bf16 v[196:199], a[116:119], a[4:7], v[196:199]
    s_waitcnt lgkmcnt(1)
    v_exp_f32 v204, v204
    v_mfma_f32_16x16x32_bf16 v[196:199], a[120:123], a[8:11], v[196:199]
    s_waitcnt lgkmcnt(0)
    v_mfma_f32_16x16x32_bf16 v[196:199], a[124:127], a[12:15], v[196:199]
    s_add_u32 m0, s24, 8456
    v_exp_f32 v205, v205
    v_mfma_f32_16x16x32_bf16 v[144:147], a[144:147], v[208:211], v[144:147]
    buffer_load_dwordx4 v243, s[8:11], s20 offen offset:1024 nt lds
    v_mfma_f32_16x16x32_bf16 v[148:151], a[148:151], v[208:211], v[148:151]
    v_exp_f32 v206, v206
    v_mfma_f32_16x16x32_bf16 v[152:155], a[152:155], v[208:211], v[152:155]
    v_mfma_f32_16x16x32_bf16 v[156:159], a[156:159], v[208:211], v[156:159]
    v_exp_f32 v207, v207
    v_mfma_f32_16x16x32_bf16 v[200:203], a[96:99], a[16:19], v[220:223]
    s_mov_b32 s38, 8
L_loop1:
    v_cvt_pk_bf16_f32 v214, v204, v205
    v_cvt_pk_bf16_f32 v215, v206, v207
    v_mfma_f32_16x16x32_bf16 v[200:203], a[100:103], a[20:23], v[200:203]
    v_exp_f32 v192, v192
    v_mfma_f32_16x16x32_bf16 v[200:203], a[104:107], a[24:27], v[200:203]
    s_lshr_b32 s32, s50, 1
    v_mfma_f32_16x16x32_bf16 v[200:203], a[108:111], a[28:31], v[200:203]
    s_lshl_b32 s32, s32, 13
    v_exp_f32 v193, v193
    v_smfmac_f32_16x16x64_bf16 a[168:171], a[172:175], v[208:215], v240
    s_and_b32 s33, s50, 1
    v_mfma_f32_16x16x32_bf16 v[160:163], a[128:131], v[212:215], v[160:163]
    s_lshl_b32 s33, s33, 9
    ds_read_b64_tr_b16 a[128:129], v242 offset:16896
    ds_read_b64_tr_b16 a[130:131], v242 offset:17408
    v_mfma_f32_16x16x32_bf16 v[164:167], a[132:135], v[212:215], v[164:167]
    s_add_u32 s51, s32, s33
    v_exp_f32 v194, v194
    v_mfma_f32_16x16x32_bf16 v[168:171], a[136:139], v[212:215], v[168:171]
    s_sub_u32 s32, s50, 6
    ds_read_b64_tr_b16 a[132:133], v242 offset:16904
    ds_read_b64_tr_b16 a[134:135], v242 offset:17416
    v_mfma_f32_16x16x32_bf16 v[172:175], a[140:143], v[212:215], v[172:175]
    s_ashr_i32 s32, s32, 31
    v_exp_f32 v195, v195
    v_mfma_f32_16x16x32_bf16 v[204:207], a[112:115], a[16:19], v[220:223]
    s_andn2_b32 s33, 0x40000000, s32
    v_cvt_pk_bf16_f32 v208, v192, v193
    v_cvt_pk_bf16_f32 v209, v194, v195
    v_mfma_f32_16x16x32_bf16 v[204:207], a[116:119], a[20:23], v[204:207]
    s_or_b32 s51, s51, s33
    v_exp_f32 v196, v196
    v_mfma_f32_16x16x32_bf16 v[204:207], a[120:123], a[24:27], v[204:207]
    s_and_b32 s62, 2048, s32
    ds_read_b64_tr_b16 a[136:137], v242 offset:16960
    ds_read_b64_tr_b16 a[138:139], v242 offset:17472
    v_mfma_f32_16x16x32_bf16 v[204:207], a[124:127], a[28:31], v[204:207]
    s_add_u32 s50, s50, 1
    v_exp_f32 v197, v197
    v_mfma_f32_16x16x32_bf16 v[176:179], a[144:147], v[212:215], v[176:179]
    ds_read_b64_tr_b16 a[140:141], v242 offset:16968
    ds_read_b64_tr_b16 a[142:143], v242 offset:17480
    v_mfma_f32_16x16x32_bf16 v[180:183], a[148:151], v[212:215], v[180:183]
    v_exp_f32 v198, v198
    v_mfma_f32_16x16x32_bf16 v[184:187], a[152:155], v[212:215], v[184:187]
    ds_read_b64_tr_b16 a[144:145], v242 offset:17024
    ds_read_b64_tr_b16 a[146:147], v242 offset:17536
    v_mfma_f32_16x16x32_bf16 v[188:191], a[156:159], v[212:215], v[188:191]
    v_exp_f32 v199, v199
    v_mfma_f32_16x16x32_bf16 v[192:195], a[96:99], a[32:35], v[224:227]
    v_cvt_pk_bf16_f32 v210, v196, v197
    v_cvt_pk_bf16_f32 v211, v198, v199
    v_mfma_f32_16x16x32_bf16 v[192:195], a[100:103], a[36:39], v[192:195]
    v_exp_f32 v200, v200
    v_mfma_f32_16x16x32_bf16 v[192:195], a[104:107], a[40:43], v[192:195]
    ds_read_b64_tr_b16 a[148:149], v242 offset:17032
    ds_read_b64_tr_b16 a[150:151], v242 offset:17544
    v_mfma_f32_16x16x32_bf16 v[192:195], a[108:111], a[44:47], v[192:195]
    s_waitcnt lgkmcnt(10)
    v_exp_f32 v201, v201
    v_mfma_f32_16x16x32_bf16 v[0:3], a[128:131], v[208:211], v[0:3]
    s_waitcnt lgkmcnt(8)
    ds_read_b64_tr_b16 a[152:153], v242 offset:17088
    ds_read_b64_tr_b16 a[154:155], v242 offset:17600
    v_mfma_f32_16x16x32_bf16 v[4:7], a[132:135], v[208:211], v[4:7]
    s_waitcnt lgkmcnt(8)
    v_exp_f32 v202, v202
    v_mfma_f32_16x16x32_bf16 v[8:11], a[136:139], v[208:211], v[8:11]
    s_waitcnt lgkmcnt(6)
    ds_read_b64_tr_b16 a[156:157], v242 offset:17096
    ds_read_b64_tr_b16 a[158:159], v242 offset:17608
    v_mfma_f32_16x16x32_bf16 v[12:15], a[140:143], v[208:211], v[12:15]
    v_exp_f32 v203, v203
    v_mfma_f32_16x16x32_bf16 v[196:199], a[112:115], a[32:35], v[224:227]
    v_cvt_pk_bf16_f32 v212, v200, v201
    v_cvt_pk_bf16_f32 v213, v202, v203
    v_mfma_f32_16x16x32_bf16 v[196:199], a[116:119], a[36:39], v[196:199]
    v_exp_f32 v204, v204
    v_mfma_f32_16x16x32_bf16 v[196:199], a[120:123], a[40:43], v[196:199]
    v_mfma_f32_16x16x32_bf16 v[196:199], a[124:127], a[44:47], v[196:199]
    s_waitcnt lgkmcnt(6)
    v_exp_f32 v205, v205
    v_mfma_f32_16x16x32_bf16 v[16:19], a[144:147], v[208:211], v[16:19]
    s_waitcnt lgkmcnt(4)
    v_mfma_f32_16x16x32_bf16 v[20:23], a[148:151], v[208:211], v[20:23]
    s_waitcnt lgkmcnt(2)
    v_exp_f32 v206, v206
    v_mfma_f32_16x16x32_bf16 v[24:27], a[152:155], v[208:211], v[24:27]
    s_waitcnt lgkmcnt(0)
    v_mfma_f32_16x16x32_bf16 v[28:31], a[156:159], v[208:211], v[28:31]
    v_exp_f32 v207, v207
    v_mfma_f32_16x16x32_bf16 v[200:203], a[96:99], a[48:51], v[228:231]
    v_cvt_pk_bf16_f32 v214, v204, v205
    v_cvt_pk_bf16_f32 v215, v206, v207
    v_mfma_f32_16x16x32_bf16 v[200:203], a[100:103], a[52:55], v[200:203]
    s_add_u32 s20, s20, 8192
    v_exp_f32 v192, v192
    v_mfma_f32_16x16x32_bf16 v[200:203], a[104:107], a[56:59], v[200:203]
    ds_read_b128 v[244:247], v252 offset:0
    ds_read_b128 v[248:251], v252 offset:1024
    v_mfma_f32_16x16x32_bf16 v[200:203], a[108:111], a[60:63], v[200:203]
    v_exp_f32 v193, v193
    v_smfmac_f32_16x16x64_bf16 a[160:163], a[172:175], v[208:215], v240
    v_add_u32 v252, s62, v252
    v_mfma_f32_16x16x32_bf16 v[32:35], a[128:131], v[212:215], v[32:35]
    v_mfma_f32_16x16x32_bf16 v[36:39], a[132:135], v[212:215], v[36:39]
    v_exp_f32 v194, v194
    v_mfma_f32_16x16x32_bf16 v[40:43], a[136:139], v[212:215], v[40:43]
    v_mfma_f32_16x16x32_bf16 v[44:47], a[140:143], v[212:215], v[44:47]
    v_exp_f32 v195, v195
    v_mfma_f32_16x16x32_bf16 v[204:207], a[112:115], a[48:51], v[228:231]
    v_cvt_pk_bf16_f32 v208, v192, v193
    v_cvt_pk_bf16_f32 v209, v194, v195
    v_mfma_f32_16x16x32_bf16 v[204:207], a[116:119], a[52:55], v[204:207]
    v_exp_f32 v196, v196
    v_mfma_f32_16x16x32_bf16 v[204:207], a[120:123], a[56:59], v[204:207]
    v_mfma_f32_16x16x32_bf16 v[204:207], a[124:127], a[60:63], v[204:207]
    v_exp_f32 v197, v197
    v_mfma_f32_16x16x32_bf16 v[48:51], a[144:147], v[212:215], v[48:51]
    v_mfma_f32_16x16x32_bf16 v[52:55], a[148:151], v[212:215], v[52:55]
    v_exp_f32 v198, v198
    v_mfma_f32_16x16x32_bf16 v[56:59], a[152:155], v[212:215], v[56:59]
    s_waitcnt lgkmcnt(1)
    buffer_store_dwordx4 v[244:247], v255, s[16:19], s51 offen offset:0 nt sc1
    v_mfma_f32_16x16x32_bf16 v[60:63], a[156:159], v[212:215], v[60:63]
    v_exp_f32 v199, v199
    v_mfma_f32_16x16x32_bf16 v[192:195], a[96:99], a[64:67], v[232:235]
    v_cvt_pk_bf16_f32 v210, v196, v197
    v_cvt_pk_bf16_f32 v211, v198, v199
    v_mfma_f32_16x16x32_bf16 v[192:195], a[100:103], a[68:71], v[192:195]
    v_exp_f32 v200, v200
    v_mfma_f32_16x16x32_bf16 v[192:195], a[104:107], a[72:75], v[192:195]
    s_waitcnt lgkmcnt(0)
    buffer_store_dwordx4 v[248:251], v255, s[16:19], s51 offen offset:256 nt sc1
    v_mfma_f32_16x16x32_bf16 v[192:195], a[108:111], a[76:79], v[192:195]
    v_exp_f32 v201, v201
    v_mfma_f32_16x16x32_bf16 v[64:67], a[128:131], v[208:211], v[64:67]
    v_mfma_f32_16x16x32_bf16 v[68:71], a[132:135], v[208:211], v[68:71]
    v_exp_f32 v202, v202
    v_mfma_f32_16x16x32_bf16 v[72:75], a[136:139], v[208:211], v[72:75]
    v_mfma_f32_16x16x32_bf16 v[76:79], a[140:143], v[208:211], v[76:79]
    v_exp_f32 v203, v203
    v_mfma_f32_16x16x32_bf16 v[196:199], a[112:115], a[64:67], v[232:235]
    v_cvt_pk_bf16_f32 v212, v200, v201
    v_cvt_pk_bf16_f32 v213, v202, v203
    v_mfma_f32_16x16x32_bf16 v[196:199], a[116:119], a[68:71], v[196:199]
    v_exp_f32 v204, v204
    v_mfma_f32_16x16x32_bf16 v[196:199], a[120:123], a[72:75], v[196:199]
    v_mfma_f32_16x16x32_bf16 v[196:199], a[124:127], a[76:79], v[196:199]
    v_exp_f32 v205, v205
    v_mfma_f32_16x16x32_bf16 v[80:83], a[144:147], v[208:211], v[80:83]
    v_mfma_f32_16x16x32_bf16 v[84:87], a[148:151], v[208:211], v[84:87]
    s_waitcnt vmcnt(6)
    v_exp_f32 v206, v206
    v_mfma_f32_16x16x32_bf16 v[88:91], a[152:155], v[208:211], v[88:91]
    s_barrier
    v_mfma_f32_16x16x32_bf16 v[92:95], a[156:159], v[208:211], v[92:95]
    v_exp_f32 v207, v207
    v_mfma_f32_16x16x32_bf16 v[200:203], a[96:99], a[80:83], v[236:239]
    v_cvt_pk_bf16_f32 v214, v204, v205
    v_cvt_pk_bf16_f32 v215, v206, v207
    v_mfma_f32_16x16x32_bf16 v[200:203], a[100:103], a[84:87], v[200:203]
    v_exp_f32 v192, v192
    v_mfma_f32_16x16x32_bf16 v[200:203], a[104:107], a[88:91], v[200:203]
    ds_read_b128 a[96:99], v241 offset:33792
    ds_read_b128 a[100:103], v241 offset:33856
    v_mfma_f32_16x16x32_bf16 v[200:203], a[108:111], a[92:95], v[200:203]
    v_exp_f32 v193, v193
    v_smfmac_f32_16x16x64_bf16 a[164:167], a[172:175], v[208:215], v240
    ds_read_b128 a[104:107], v241 offset:33920
    ds_read_b128 a[108:111], v241 offset:33984
    v_mfma_f32_16x16x32_bf16 v[96:99], a[128:131], v[212:215], v[96:99]
    v_mfma_f32_16x16x32_bf16 v[100:103], a[132:135], v[212:215], v[100:103]
    v_exp_f32 v194, v194
    v_mfma_f32_16x16x32_bf16 v[104:107], a[136:139], v[212:215], v[104:107]
    v_mfma_f32_16x16x32_bf16 v[108:111], a[140:143], v[212:215], v[108:111]
    v_exp_f32 v195, v195
    v_mfma_f32_16x16x32_bf16 v[204:207], a[112:115], a[80:83], v[236:239]
    v_cvt_pk_bf16_f32 v208, v192, v193
    v_cvt_pk_bf16_f32 v209, v194, v195
    v_mfma_f32_16x16x32_bf16 v[204:207], a[116:119], a[84:87], v[204:207]
    v_exp_f32 v196, v196
    v_mfma_f32_16x16x32_bf16 v[204:207], a[120:123], a[88:91], v[204:207]
    ds_read_b128 a[112:115], v241 offset:34304
    ds_read_b128 a[116:119], v241 offset:34368
    v_mfma_f32_16x16x32_bf16 v[204:207], a[124:127], a[92:95], v[204:207]
    v_exp_f32 v197, v197
    v_mfma_f32_16x16x32_bf16 v[112:115], a[144:147], v[212:215], v[112:115]
    ds_read_b128 a[120:123], v241 offset:34432
    ds_read_b128 a[124:127], v241 offset:34496
    v_mfma_f32_16x16x32_bf16 v[116:119], a[148:151], v[212:215], v[116:119]
    v_exp_f32 v198, v198
    v_mfma_f32_16x16x32_bf16 v[120:123], a[152:155], v[212:215], v[120:123]
    s_add_u32 m0, s24, 16896
    v_mfma_f32_16x16x32_bf16 v[124:127], a[156:159], v[212:215], v[124:127]
    s_waitcnt lgkmcnt(7)
    v_exp_f32 v199, v199
    v_mfma_f32_16x16x32_bf16 v[192:195], a[96:99], a[0:3], v[216:219]
    s_waitcnt lgkmcnt(6)
    v_cvt_pk_bf16_f32 v210, v196, v197
    v_cvt_pk_bf16_f32 v211, v198, v199
    v_mfma_f32_16x16x32_bf16 v[192:195], a[100:103], a[4:7], v[192:195]
    s_waitcnt lgkmcnt(5)
    v_exp_f32 v200, v200
    v_mfma_f32_16x16x32_bf16 v[192:195], a[104:107], a[8:11], v[192:195]
    s_waitcnt lgkmcnt(4)
    buffer_load_dwordx4 v243, s[4:7], s20 offen nt lds
    v_mfma_f32_16x16x32_bf16 v[192:195], a[108:111], a[12:15], v[192:195]
    s_add_u32 m0, s24, 16928
    v_exp_f32 v201, v201
    v_mfma_f32_16x16x32_bf16 v[128:131], a[128:131], v[208:211], v[128:131]
    buffer_load_dwordx4 v243, s[4:7], s20 offen offset:1024 nt lds
    v_mfma_f32_16x16x32_bf16 v[132:135], a[132:135], v[208:211], v[132:135]
    s_add_u32 m0, s24, 25344
    v_exp_f32 v202, v202
    v_mfma_f32_16x16x32_bf16 v[136:139], a[136:139], v[208:211], v[136:139]
    buffer_load_dwordx4 v243, s[8:11], s20 offen nt lds
    v_mfma_f32_16x16x32_bf16 v[140:143], a[140:143], v[208:211], v[140:143]
    s_waitcnt lgkmcnt(3)
    v_exp_f32 v203, v203
    v_mfma_f32_16x16x32_bf16 v[196:199], a[112:115], a[0:3], v[216:219]
    s_waitcnt lgkmcnt(2)
    v_cvt_pk_bf16_f32 v212, v200, v201
    v_cvt_pk_bf16_f32 v213, v202, v203
    v_mfma_f32_16x16x32_bf16 v[196:199], a[116:119], a[4:7], v[196:199]
    s_waitcnt lgkmcnt(1)
    v_exp_f32 v204, v204
    v_mfma_f32_16x16x32_bf16 v[196:199], a[120:123], a[8:11], v[196:199]
    s_waitcnt lgkmcnt(0)
    v_mfma_f32_16x16x32_bf16 v[196:199], a[124:127], a[12:15], v[196:199]
    s_add_u32 m0, s24, 25352
    v_exp_f32 v205, v205
    v_mfma_f32_16x16x32_bf16 v[144:147], a[144:147], v[208:211], v[144:147]
    buffer_load_dwordx4 v243, s[8:11], s20 offen offset:1024 nt lds
    v_mfma_f32_16x16x32_bf16 v[148:151], a[148:151], v[208:211], v[148:151]
    v_exp_f32 v206, v206
    v_mfma_f32_16x16x32_bf16 v[152:155], a[152:155], v[208:211], v[152:155]
    v_mfma_f32_16x16x32_bf16 v[156:159], a[156:159], v[208:211], v[156:159]
    v_exp_f32 v207, v207
    v_mfma_f32_16x16x32_bf16 v[200:203], a[96:99], a[16:19], v[220:223]
    v_cvt_pk_bf16_f32 v214, v204, v205
    v_cvt_pk_bf16_f32 v215, v206, v207
    v_mfma_f32_16x16x32_bf16 v[200:203], a[100:103], a[20:23], v[200:203]
    v_exp_f32 v192, v192
    v_mfma_f32_16x16x32_bf16 v[200:203], a[104:107], a[24:27], v[200:203]
    v_mfma_f32_16x16x32_bf16 v[200:203], a[108:111], a[28:31], v[200:203]
    v_exp_f32 v193, v193
    v_smfmac_f32_16x16x64_bf16 a[168:171], a[172:175], v[208:215], v240
    v_mfma_f32_16x16x32_bf16 v[160:163], a[128:131], v[212:215], v[160:163]
    ds_read_b64_tr_b16 a[128:129], v242 offset:33792
    ds_read_b64_tr_b16 a[130:131], v242 offset:34304
    v_mfma_f32_16x16x32_bf16 v[164:167], a[132:135], v[212:215], v[164:167]
    v_exp_f32 v194, v194
    v_mfma_f32_16x16x32_bf16 v[168:171], a[136:139], v[212:215], v[168:171]
    ds_read_b64_tr_b16 a[132:133], v242 offset:33800
    ds_read_b64_tr_b16 a[134:135], v242 offset:34312
    v_mfma_f32_16x16x32_bf16 v[172:175], a[140:143], v[212:215], v[172:175]
    v_exp_f32 v195, v195
    v_mfma_f32_16x16x32_bf16 v[204:207], a[112:115], a[16:19], v[220:223]
    v_cvt_pk_bf16_f32 v208, v192, v193
    v_cvt_pk_bf16_f32 v209, v194, v195
    v_mfma_f32_16x16x32_bf16 v[204:207], a[116:119], a[20:23], v[204:207]
    v_exp_f32 v196, v196
    v_mfma_f32_16x16x32_bf16 v[204:207], a[120:123], a[24:27], v[204:207]
    ds_read_b64_tr_b16 a[136:137], v242 offset:33856
    ds_read_b64_tr_b16 a[138:139], v242 offset:34368
    v_mfma_f32_16x16x32_bf16 v[204:207], a[124:127], a[28:31], v[204:207]
    v_exp_f32 v197, v197
    v_mfma_f32_16x16x32_bf16 v[176:179], a[144:147], v[212:215], v[176:179]
    ds_read_b64_tr_b16 a[140:141], v242 offset:33864
    ds_read_b64_tr_b16 a[142:143], v242 offset:34376
    v_mfma_f32_16x16x32_bf16 v[180:183], a[148:151], v[212:215], v[180:183]
    v_exp_f32 v198, v198
    v_mfma_f32_16x16x32_bf16 v[184:187], a[152:155], v[212:215], v[184:187]
    ds_read_b64_tr_b16 a[144:145], v242 offset:33920
    ds_read_b64_tr_b16 a[146:147], v242 offset:34432
    v_mfma_f32_16x16x32_bf16 v[188:191], a[156:159], v[212:215], v[188:191]
    v_exp_f32 v199, v199
    v_mfma_f32_16x16x32_bf16 v[192:195], a[96:99], a[32:35], v[224:227]
    v_cvt_pk_bf16_f32 v210, v196, v197
    v_cvt_pk_bf16_f32 v211, v198, v199
    v_mfma_f32_16x16x32_bf16 v[192:195], a[100:103], a[36:39], v[192:195]
    v_exp_f32 v200, v200
    v_mfma_f32_16x16x32_bf16 v[192:195], a[104:107], a[40:43], v[192:195]
    ds_read_b64_tr_b16 a[148:149], v242 offset:33928
    ds_read_b64_tr_b16 a[150:151], v242 offset:34440
    v_mfma_f32_16x16x32_bf16 v[192:195], a[108:111], a[44:47], v[192:195]
    s_waitcnt lgkmcnt(10)
    v_exp_f32 v201, v201
    v_mfma_f32_16x16x32_bf16 v[0:3], a[128:131], v[208:211], v[0:3]
    s_waitcnt lgkmcnt(8)
    ds_read_b64_tr_b16 a[152:153], v242 offset:33984
    ds_read_b64_tr_b16 a[154:155], v242 offset:34496
    v_mfma_f32_16x16x32_bf16 v[4:7], a[132:135], v[208:211], v[4:7]
    s_waitcnt lgkmcnt(8)
    v_exp_f32 v202, v202
    v_mfma_f32_16x16x32_bf16 v[8:11], a[136:139], v[208:211], v[8:11]
    s_waitcnt lgkmcnt(6)
    ds_read_b64_tr_b16 a[156:157], v242 offset:33992
    ds_read_b64_tr_b16 a[158:159], v242 offset:34504
    v_mfma_f32_16x16x32_bf16 v[12:15], a[140:143], v[208:211], v[12:15]
    v_exp_f32 v203, v203
    v_mfma_f32_16x16x32_bf16 v[196:199], a[112:115], a[32:35], v[224:227]
    v_cvt_pk_bf16_f32 v212, v200, v201
    v_cvt_pk_bf16_f32 v213, v202, v203
    v_mfma_f32_16x16x32_bf16 v[196:199], a[116:119], a[36:39], v[196:199]
    v_exp_f32 v204, v204
    v_mfma_f32_16x16x32_bf16 v[196:199], a[120:123], a[40:43], v[196:199]
    v_mfma_f32_16x16x32_bf16 v[196:199], a[124:127], a[44:47], v[196:199]
    s_waitcnt lgkmcnt(6)
    v_exp_f32 v205, v205
    v_mfma_f32_16x16x32_bf16 v[16:19], a[144:147], v[208:211], v[16:19]
    s_waitcnt lgkmcnt(4)
    v_mfma_f32_16x16x32_bf16 v[20:23], a[148:151], v[208:211], v[20:23]
    s_waitcnt lgkmcnt(2)
    v_exp_f32 v206, v206
    v_mfma_f32_16x16x32_bf16 v[24:27], a[152:155], v[208:211], v[24:27]
    s_waitcnt lgkmcnt(0)
    v_mfma_f32_16x16x32_bf16 v[28:31], a[156:159], v[208:211], v[28:31]
    v_exp_f32 v207, v207
    v_mfma_f32_16x16x32_bf16 v[200:203], a[96:99], a[48:51], v[228:231]
    v_cvt_pk_bf16_f32 v214, v204, v205
    v_cvt_pk_bf16_f32 v215, v206, v207
    v_mfma_f32_16x16x32_bf16 v[200:203], a[100:103], a[52:55], v[200:203]
    s_add_u32 s20, s20, 8192
    v_exp_f32 v192, v192
    v_mfma_f32_16x16x32_bf16 v[200:203], a[104:107], a[56:59], v[200:203]
    ds_read_b128 v[244:247], v252 offset:0
    ds_read_b128 v[248:251], v252 offset:1024
    v_mfma_f32_16x16x32_bf16 v[200:203], a[108:111], a[60:63], v[200:203]
    v_exp_f32 v193, v193
    v_smfmac_f32_16x16x64_bf16 a[160:163], a[172:175], v[208:215], v240
    v_add_u32 v252, s62, v252
    v_mfma_f32_16x16x32_bf16 v[32:35], a[128:131], v[212:215], v[32:35]
    v_mfma_f32_16x16x32_bf16 v[36:39], a[132:135], v[212:215], v[36:39]
    v_exp_f32 v194, v194
    v_mfma_f32_16x16x32_bf16 v[40:43], a[136:139], v[212:215], v[40:43]
    v_mfma_f32_16x16x32_bf16 v[44:47], a[140:143], v[212:215], v[44:47]
    v_exp_f32 v195, v195
    v_mfma_f32_16x16x32_bf16 v[204:207], a[112:115], a[48:51], v[228:231]
    v_cvt_pk_bf16_f32 v208, v192, v193
    v_cvt_pk_bf16_f32 v209, v194, v195
    v_mfma_f32_16x16x32_bf16 v[204:207], a[116:119], a[52:55], v[204:207]
    v_exp_f32 v196, v196
    v_mfma_f32_16x16x32_bf16 v[204:207], a[120:123], a[56:59], v[204:207]
    v_mfma_f32_16x16x32_bf16 v[204:207], a[124:127], a[60:63], v[204:207]
    v_exp_f32 v197, v197
    v_mfma_f32_16x16x32_bf16 v[48:51], a[144:147], v[212:215], v[48:51]
    v_mfma_f32_16x16x32_bf16 v[52:55], a[148:151], v[212:215], v[52:55]
    v_exp_f32 v198, v198
    v_mfma_f32_16x16x32_bf16 v[56:59], a[152:155], v[212:215], v[56:59]
    s_waitcnt lgkmcnt(1)
    buffer_store_dwordx4 v[244:247], v255, s[16:19], s51 offen offset:128 nt sc1
    v_mfma_f32_16x16x32_bf16 v[60:63], a[156:159], v[212:215], v[60:63]
    v_exp_f32 v199, v199
    v_mfma_f32_16x16x32_bf16 v[192:195], a[96:99], a[64:67], v[232:235]
    v_cvt_pk_bf16_f32 v210, v196, v197
    v_cvt_pk_bf16_f32 v211, v198, v199
    v_mfma_f32_16x16x32_bf16 v[192:195], a[100:103], a[68:71], v[192:195]
    v_exp_f32 v200, v200
    v_mfma_f32_16x16x32_bf16 v[192:195], a[104:107], a[72:75], v[192:195]
    s_waitcnt lgkmcnt(0)
    buffer_store_dwordx4 v[248:251], v255, s[16:19], s51 offen offset:384 nt sc1
    v_mfma_f32_16x16x32_bf16 v[192:195], a[108:111], a[76:79], v[192:195]
    v_exp_f32 v201, v201
    v_mfma_f32_16x16x32_bf16 v[64:67], a[128:131], v[208:211], v[64:67]
    v_mfma_f32_16x16x32_bf16 v[68:71], a[132:135], v[208:211], v[68:71]
    v_exp_f32 v202, v202
    v_mfma_f32_16x16x32_bf16 v[72:75], a[136:139], v[208:211], v[72:75]
    v_mfma_f32_16x16x32_bf16 v[76:79], a[140:143], v[208:211], v[76:79]
    v_exp_f32 v203, v203
    v_mfma_f32_16x16x32_bf16 v[196:199], a[112:115], a[64:67], v[232:235]
    v_cvt_pk_bf16_f32 v212, v200, v201
    v_cvt_pk_bf16_f32 v213, v202, v203
    v_mfma_f32_16x16x32_bf16 v[196:199], a[116:119], a[68:71], v[196:199]
    v_exp_f32 v204, v204
    v_mfma_f32_16x16x32_bf16 v[196:199], a[120:123], a[72:75], v[196:199]
    v_mfma_f32_16x16x32_bf16 v[196:199], a[124:127], a[76:79], v[196:199]
    v_exp_f32 v205, v205
    v_mfma_f32_16x16x32_bf16 v[80:83], a[144:147], v[208:211], v[80:83]
    v_mfma_f32_16x16x32_bf16 v[84:87], a[148:151], v[208:211], v[84:87]
    s_waitcnt vmcnt(8)
    v_exp_f32 v206, v206
    v_mfma_f32_16x16x32_bf16 v[88:91], a[152:155], v[208:211], v[88:91]
    s_barrier
    v_mfma_f32_16x16x32_bf16 v[92:95], a[156:159], v[208:211], v[92:95]
    v_exp_f32 v207, v207
    v_mfma_f32_16x16x32_bf16 v[200:203], a[96:99], a[80:83], v[236:239]
    v_cvt_pk_bf16_f32 v214, v204, v205
    v_cvt_pk_bf16_f32 v215, v206, v207
    v_mfma_f32_16x16x32_bf16 v[200:203], a[100:103], a[84:87], v[200:203]
    v_exp_f32 v192, v192
    v_mfma_f32_16x16x32_bf16 v[200:203], a[104:107], a[88:91], v[200:203]
    ds_read_b128 a[96:99], v241 offset:0
    ds_read_b128 a[100:103], v241 offset:64
    v_mfma_f32_16x16x32_bf16 v[200:203], a[108:111], a[92:95], v[200:203]
    v_exp_f32 v193, v193
    v_smfmac_f32_16x16x64_bf16 a[164:167], a[172:175], v[208:215], v240
    ds_read_b128 a[104:107], v241 offset:128
    ds_read_b128 a[108:111], v241 offset:192
    v_mfma_f32_16x16x32_bf16 v[96:99], a[128:131], v[212:215], v[96:99]
    v_mfma_f32_16x16x32_bf16 v[100:103], a[132:135], v[212:215], v[100:103]
    v_exp_f32 v194, v194
    v_mfma_f32_16x16x32_bf16 v[104:107], a[136:139], v[212:215], v[104:107]
    v_mfma_f32_16x16x32_bf16 v[108:111], a[140:143], v[212:215], v[108:111]
    v_exp_f32 v195, v195
    v_mfma_f32_16x16x32_bf16 v[204:207], a[112:115], a[80:83], v[236:239]
    v_cvt_pk_bf16_f32 v208, v192, v193
    v_cvt_pk_bf16_f32 v209, v194, v195
    v_mfma_f32_16x16x32_bf16 v[204:207], a[116:119], a[84:87], v[204:207]
    v_exp_f32 v196, v196
    v_mfma_f32_16x16x32_bf16 v[204:207], a[120:123], a[88:91], v[204:207]
    ds_read_b128 a[112:115], v241 offset:512
    ds_read_b128 a[116:119], v241 offset:576
    v_mfma_f32_16x16x32_bf16 v[204:207], a[124:127], a[92:95], v[204:207]
    v_exp_f32 v197, v197
    v_mfma_f32_16x16x32_bf16 v[112:115], a[144:147], v[212:215], v[112:115]
    ds_read_b128 a[120:123], v241 offset:640
    ds_read_b128 a[124:127], v241 offset:704
    v_mfma_f32_16x16x32_bf16 v[116:119], a[148:151], v[212:215], v[116:119]
    v_exp_f32 v198, v198
    v_mfma_f32_16x16x32_bf16 v[120:123], a[152:155], v[212:215], v[120:123]
    s_add_u32 m0, s24, 33792
    v_mfma_f32_16x16x32_bf16 v[124:127], a[156:159], v[212:215], v[124:127]
    s_waitcnt lgkmcnt(7)
    v_exp_f32 v199, v199
    v_mfma_f32_16x16x32_bf16 v[192:195], a[96:99], a[0:3], v[216:219]
    s_waitcnt lgkmcnt(6)
    v_cvt_pk_bf16_f32 v210, v196, v197
    v_cvt_pk_bf16_f32 v211, v198, v199
    v_mfma_f32_16x16x32_bf16 v[192:195], a[100:103], a[4:7], v[192:195]
    s_waitcnt lgkmcnt(5)
    v_exp_f32 v200, v200
    v_mfma_f32_16x16x32_bf16 v[192:195], a[104:107], a[8:11], v[192:195]
    s_waitcnt lgkmcnt(4)
    buffer_load_dwordx4 v243, s[4:7], s20 offen nt lds
    v_mfma_f32_16x16x32_bf16 v[192:195], a[108:111], a[12:15], v[192:195]
    s_add_u32 m0, s24, 33824
    v_exp_f32 v201, v201
    v_mfma_f32_16x16x32_bf16 v[128:131], a[128:131], v[208:211], v[128:131]
    buffer_load_dwordx4 v243, s[4:7], s20 offen offset:1024 nt lds
    v_mfma_f32_16x16x32_bf16 v[132:135], a[132:135], v[208:211], v[132:135]
    s_add_u32 m0, s24, 42240
    v_exp_f32 v202, v202
    v_mfma_f32_16x16x32_bf16 v[136:139], a[136:139], v[208:211], v[136:139]
    buffer_load_dwordx4 v243, s[8:11], s20 offen nt lds
    v_mfma_f32_16x16x32_bf16 v[140:143], a[140:143], v[208:211], v[140:143]
    s_waitcnt lgkmcnt(3)
    v_exp_f32 v203, v203
    v_mfma_f32_16x16x32_bf16 v[196:199], a[112:115], a[0:3], v[216:219]
    s_waitcnt lgkmcnt(2)
    v_cvt_pk_bf16_f32 v212, v200, v201
    v_cvt_pk_bf16_f32 v213, v202, v203
    v_mfma_f32_16x16x32_bf16 v[196:199], a[116:119], a[4:7], v[196:199]
    s_waitcnt lgkmcnt(1)
    v_exp_f32 v204, v204
    v_mfma_f32_16x16x32_bf16 v[196:199], a[120:123], a[8:11], v[196:199]
    s_waitcnt lgkmcnt(0)
    v_mfma_f32_16x16x32_bf16 v[196:199], a[124:127], a[12:15], v[196:199]
    s_add_u32 m0, s24, 42248
    v_exp_f32 v205, v205
    v_mfma_f32_16x16x32_bf16 v[144:147], a[144:147], v[208:211], v[144:147]
    buffer_load_dwordx4 v243, s[8:11], s20 offen offset:1024 nt lds
    v_mfma_f32_16x16x32_bf16 v[148:151], a[148:151], v[208:211], v[148:151]
    v_exp_f32 v206, v206
    v_mfma_f32_16x16x32_bf16 v[152:155], a[152:155], v[208:211], v[152:155]
    v_mfma_f32_16x16x32_bf16 v[156:159], a[156:159], v[208:211], v[156:159]
    v_exp_f32 v207, v207
    v_mfma_f32_16x16x32_bf16 v[200:203], a[96:99], a[16:19], v[220:223]
    v_cvt_pk_bf16_f32 v214, v204, v205
    v_cvt_pk_bf16_f32 v215, v206, v207
    v_mfma_f32_16x16x32_bf16 v[200:203], a[100:103], a[20:23], v[200:203]
    v_exp_f32 v192, v192
    v_mfma_f32_16x16x32_bf16 v[200:203], a[104:107], a[24:27], v[200:203]
    v_mfma_f32_16x16x32_bf16 v[200:203], a[108:111], a[28:31], v[200:203]
    v_exp_f32 v193, v193
    v_smfmac_f32_16x16x64_bf16 a[168:171], a[172:175], v[208:215], v240
    v_mfma_f32_16x16x32_bf16 v[160:163], a[128:131], v[212:215], v[160:163]
    ds_read_b64_tr_b16 a[128:129], v242 offset:0
    ds_read_b64_tr_b16 a[130:131], v242 offset:512
    v_mfma_f32_16x16x32_bf16 v[164:167], a[132:135], v[212:215], v[164:167]
    v_exp_f32 v194, v194
    v_mfma_f32_16x16x32_bf16 v[168:171], a[136:139], v[212:215], v[168:171]
    ds_read_b64_tr_b16 a[132:133], v242 offset:8
    ds_read_b64_tr_b16 a[134:135], v242 offset:520
    v_mfma_f32_16x16x32_bf16 v[172:175], a[140:143], v[212:215], v[172:175]
    v_exp_f32 v195, v195
    v_mfma_f32_16x16x32_bf16 v[204:207], a[112:115], a[16:19], v[220:223]
    v_cvt_pk_bf16_f32 v208, v192, v193
    v_cvt_pk_bf16_f32 v209, v194, v195
    v_mfma_f32_16x16x32_bf16 v[204:207], a[116:119], a[20:23], v[204:207]
    v_exp_f32 v196, v196
    v_mfma_f32_16x16x32_bf16 v[204:207], a[120:123], a[24:27], v[204:207]
    ds_read_b64_tr_b16 a[136:137], v242 offset:64
    ds_read_b64_tr_b16 a[138:139], v242 offset:576
    v_mfma_f32_16x16x32_bf16 v[204:207], a[124:127], a[28:31], v[204:207]
    v_exp_f32 v197, v197
    v_mfma_f32_16x16x32_bf16 v[176:179], a[144:147], v[212:215], v[176:179]
    ds_read_b64_tr_b16 a[140:141], v242 offset:72
    ds_read_b64_tr_b16 a[142:143], v242 offset:584
    v_mfma_f32_16x16x32_bf16 v[180:183], a[148:151], v[212:215], v[180:183]
    v_exp_f32 v198, v198
    v_mfma_f32_16x16x32_bf16 v[184:187], a[152:155], v[212:215], v[184:187]
    ds_read_b64_tr_b16 a[144:145], v242 offset:128
    ds_read_b64_tr_b16 a[146:147], v242 offset:640
    v_mfma_f32_16x16x32_bf16 v[188:191], a[156:159], v[212:215], v[188:191]
    v_exp_f32 v199, v199
    v_mfma_f32_16x16x32_bf16 v[192:195], a[96:99], a[32:35], v[224:227]
    v_cvt_pk_bf16_f32 v210, v196, v197
    v_cvt_pk_bf16_f32 v211, v198, v199
    v_mfma_f32_16x16x32_bf16 v[192:195], a[100:103], a[36:39], v[192:195]
    v_exp_f32 v200, v200
    v_mfma_f32_16x16x32_bf16 v[192:195], a[104:107], a[40:43], v[192:195]
    ds_read_b64_tr_b16 a[148:149], v242 offset:136
    ds_read_b64_tr_b16 a[150:151], v242 offset:648
    v_mfma_f32_16x16x32_bf16 v[192:195], a[108:111], a[44:47], v[192:195]
    s_waitcnt lgkmcnt(10)
    v_exp_f32 v201, v201
    v_mfma_f32_16x16x32_bf16 v[0:3], a[128:131], v[208:211], v[0:3]
    s_waitcnt lgkmcnt(8)
    ds_read_b64_tr_b16 a[152:153], v242 offset:192
    ds_read_b64_tr_b16 a[154:155], v242 offset:704
    v_mfma_f32_16x16x32_bf16 v[4:7], a[132:135], v[208:211], v[4:7]
    s_waitcnt lgkmcnt(8)
    v_exp_f32 v202, v202
    v_mfma_f32_16x16x32_bf16 v[8:11], a[136:139], v[208:211], v[8:11]
    s_waitcnt lgkmcnt(6)
    ds_read_b64_tr_b16 a[156:157], v242 offset:200
    ds_read_b64_tr_b16 a[158:159], v242 offset:712
    v_mfma_f32_16x16x32_bf16 v[12:15], a[140:143], v[208:211], v[12:15]
    v_exp_f32 v203, v203
    v_mfma_f32_16x16x32_bf16 v[196:199], a[112:115], a[32:35], v[224:227]
    v_cvt_pk_bf16_f32 v212, v200, v201
    v_cvt_pk_bf16_f32 v213, v202, v203
    v_mfma_f32_16x16x32_bf16 v[196:199], a[116:119], a[36:39], v[196:199]
    v_exp_f32 v204, v204
    v_mfma_f32_16x16x32_bf16 v[196:199], a[120:123], a[40:43], v[196:199]
    v_mfma_f32_16x16x32_bf16 v[196:199], a[124:127], a[44:47], v[196:199]
    s_waitcnt lgkmcnt(6)
    v_exp_f32 v205, v205
    v_mfma_f32_16x16x32_bf16 v[16:19], a[144:147], v[208:211], v[16:19]
    s_waitcnt lgkmcnt(4)
    v_mfma_f32_16x16x32_bf16 v[20:23], a[148:151], v[208:211], v[20:23]
    s_waitcnt lgkmcnt(2)
    v_exp_f32 v206, v206
    v_mfma_f32_16x16x32_bf16 v[24:27], a[152:155], v[208:211], v[24:27]
    s_waitcnt lgkmcnt(0)
    v_mfma_f32_16x16x32_bf16 v[28:31], a[156:159], v[208:211], v[28:31]
    v_exp_f32 v207, v207
    v_mfma_f32_16x16x32_bf16 v[200:203], a[96:99], a[48:51], v[228:231]
    v_cvt_pk_bf16_f32 v214, v204, v205
    v_cvt_pk_bf16_f32 v215, v206, v207
    v_mfma_f32_16x16x32_bf16 v[200:203], a[100:103], a[52:55], v[200:203]
    s_add_u32 s20, s20, 8192
    v_exp_f32 v192, v192
    v_mfma_f32_16x16x32_bf16 v[200:203], a[104:107], a[56:59], v[200:203]
    v_mfma_f32_16x16x32_bf16 v[200:203], a[108:111], a[60:63], v[200:203]
    v_exp_f32 v193, v193
    v_smfmac_f32_16x16x64_bf16 a[160:163], a[172:175], v[208:215], v240
    v_mfma_f32_16x16x32_bf16 v[32:35], a[128:131], v[212:215], v[32:35]
    v_mfma_f32_16x16x32_bf16 v[36:39], a[132:135], v[212:215], v[36:39]
    v_exp_f32 v194, v194
    v_mfma_f32_16x16x32_bf16 v[40:43], a[136:139], v[212:215], v[40:43]
    v_mfma_f32_16x16x32_bf16 v[44:47], a[140:143], v[212:215], v[44:47]
    v_exp_f32 v195, v195
    v_mfma_f32_16x16x32_bf16 v[204:207], a[112:115], a[48:51], v[228:231]
    v_cvt_pk_bf16_f32 v208, v192, v193
    v_cvt_pk_bf16_f32 v209, v194, v195
    v_mfma_f32_16x16x32_bf16 v[204:207], a[116:119], a[52:55], v[204:207]
    v_exp_f32 v196, v196
    v_mfma_f32_16x16x32_bf16 v[204:207], a[120:123], a[56:59], v[204:207]
    v_mfma_f32_16x16x32_bf16 v[204:207], a[124:127], a[60:63], v[204:207]
    v_exp_f32 v197, v197
    v_mfma_f32_16x16x32_bf16 v[48:51], a[144:147], v[212:215], v[48:51]
    v_mfma_f32_16x16x32_bf16 v[52:55], a[148:151], v[212:215], v[52:55]
    v_exp_f32 v198, v198
    v_mfma_f32_16x16x32_bf16 v[56:59], a[152:155], v[212:215], v[56:59]
    v_mfma_f32_16x16x32_bf16 v[60:63], a[156:159], v[212:215], v[60:63]
    v_exp_f32 v199, v199
    v_mfma_f32_16x16x32_bf16 v[192:195], a[96:99], a[64:67], v[232:235]
    v_cvt_pk_bf16_f32 v210, v196, v197
    v_cvt_pk_bf16_f32 v211, v198, v199
    v_mfma_f32_16x16x32_bf16 v[192:195], a[100:103], a[68:71], v[192:195]
    v_exp_f32 v200, v200
    v_mfma_f32_16x16x32_bf16 v[192:195], a[104:107], a[72:75], v[192:195]
    v_mfma_f32_16x16x32_bf16 v[192:195], a[108:111], a[76:79], v[192:195]
    v_exp_f32 v201, v201
    v_mfma_f32_16x16x32_bf16 v[64:67], a[128:131], v[208:211], v[64:67]
    v_mfma_f32_16x16x32_bf16 v[68:71], a[132:135], v[208:211], v[68:71]
    v_exp_f32 v202, v202
    v_mfma_f32_16x16x32_bf16 v[72:75], a[136:139], v[208:211], v[72:75]
    v_mfma_f32_16x16x32_bf16 v[76:79], a[140:143], v[208:211], v[76:79]
    v_exp_f32 v203, v203
    v_mfma_f32_16x16x32_bf16 v[196:199], a[112:115], a[64:67], v[232:235]
    v_cvt_pk_bf16_f32 v212, v200, v201
    v_cvt_pk_bf16_f32 v213, v202, v203
    v_mfma_f32_16x16x32_bf16 v[196:199], a[116:119], a[68:71], v[196:199]
    v_exp_f32 v204, v204
    v_mfma_f32_16x16x32_bf16 v[196:199], a[120:123], a[72:75], v[196:199]
    v_mfma_f32_16x16x32_bf16 v[196:199], a[124:127], a[76:79], v[196:199]
    v_exp_f32 v205, v205
    v_mfma_f32_16x16x32_bf16 v[80:83], a[144:147], v[208:211], v[80:83]
    v_mfma_f32_16x16x32_bf16 v[84:87], a[148:151], v[208:211], v[84:87]
    s_waitcnt vmcnt(6)
    v_exp_f32 v206, v206
    v_mfma_f32_16x16x32_bf16 v[88:91], a[152:155], v[208:211], v[88:91]
    s_barrier
    v_mfma_f32_16x16x32_bf16 v[92:95], a[156:159], v[208:211], v[92:95]
    v_exp_f32 v207, v207
    v_mfma_f32_16x16x32_bf16 v[200:203], a[96:99], a[80:83], v[236:239]
    v_cvt_pk_bf16_f32 v214, v204, v205
    v_cvt_pk_bf16_f32 v215, v206, v207
    v_mfma_f32_16x16x32_bf16 v[200:203], a[100:103], a[84:87], v[200:203]
    v_exp_f32 v192, v192
    v_mfma_f32_16x16x32_bf16 v[200:203], a[104:107], a[88:91], v[200:203]
    ds_read_b128 a[96:99], v241 offset:16896
    ds_read_b128 a[100:103], v241 offset:16960
    v_mfma_f32_16x16x32_bf16 v[200:203], a[108:111], a[92:95], v[200:203]
    v_exp_f32 v193, v193
    v_smfmac_f32_16x16x64_bf16 a[164:167], a[172:175], v[208:215], v240
    ds_read_b128 a[104:107], v241 offset:17024
    ds_read_b128 a[108:111], v241 offset:17088
    v_mfma_f32_16x16x32_bf16 v[96:99], a[128:131], v[212:215], v[96:99]
    v_mfma_f32_16x16x32_bf16 v[100:103], a[132:135], v[212:215], v[100:103]
    v_exp_f32 v194, v194
    v_mfma_f32_16x16x32_bf16 v[104:107], a[136:139], v[212:215], v[104:107]
    v_mfma_f32_16x16x32_bf16 v[108:111], a[140:143], v[212:215], v[108:111]
    v_exp_f32 v195, v195
    v_mfma_f32_16x16x32_bf16 v[204:207], a[112:115], a[80:83], v[236:239]
    v_cvt_pk_bf16_f32 v208, v192, v193
    v_cvt_pk_bf16_f32 v209, v194, v195
    v_mfma_f32_16x16x32_bf16 v[204:207], a[116:119], a[84:87], v[204:207]
    v_exp_f32 v196, v196
    v_mfma_f32_16x16x32_bf16 v[204:207], a[120:123], a[88:91], v[204:207]
    ds_read_b128 a[112:115], v241 offset:17408
    ds_read_b128 a[116:119], v241 offset:17472
    v_mfma_f32_16x16x32_bf16 v[204:207], a[124:127], a[92:95], v[204:207]
    v_exp_f32 v197, v197
    v_mfma_f32_16x16x32_bf16 v[112:115], a[144:147], v[212:215], v[112:115]
    ds_read_b128 a[120:123], v241 offset:17536
    ds_read_b128 a[124:127], v241 offset:17600
    v_mfma_f32_16x16x32_bf16 v[116:119], a[148:151], v[212:215], v[116:119]
    v_exp_f32 v198, v198
    v_mfma_f32_16x16x32_bf16 v[120:123], a[152:155], v[212:215], v[120:123]
    s_add_u32 m0, s24, 0
    v_mfma_f32_16x16x32_bf16 v[124:127], a[156:159], v[212:215], v[124:127]
    s_waitcnt lgkmcnt(7)
    v_exp_f32 v199, v199
    v_mfma_f32_16x16x32_bf16 v[192:195], a[96:99], a[0:3], v[216:219]
    s_waitcnt lgkmcnt(6)
    v_cvt_pk_bf16_f32 v210, v196, v197
    v_cvt_pk_bf16_f32 v211, v198, v199
    v_mfma_f32_16x16x32_bf16 v[192:195], a[100:103], a[4:7], v[192:195]
    s_waitcnt lgkmcnt(5)
    v_exp_f32 v200, v200
    v_mfma_f32_16x16x32_bf16 v[192:195], a[104:107], a[8:11], v[192:195]
    s_waitcnt lgkmcnt(4)
    buffer_load_dwordx4 v243, s[4:7], s20 offen nt lds
    v_mfma_f32_16x16x32_bf16 v[192:195], a[108:111], a[12:15], v[192:195]
    s_add_u32 m0, s24, 32
    v_exp_f32 v201, v201
    v_mfma_f32_16x16x32_bf16 v[128:131], a[128:131], v[208:211], v[128:131]
    buffer_load_dwordx4 v243, s[4:7], s20 offen offset:1024 nt lds
    v_mfma_f32_16x16x32_bf16 v[132:135], a[132:135], v[208:211], v[132:135]
    s_add_u32 m0, s24, 8448
    v_exp_f32 v202, v202
    v_mfma_f32_16x16x32_bf16 v[136:139], a[136:139], v[208:211], v[136:139]
    buffer_load_dwordx4 v243, s[8:11], s20 offen nt lds
    v_mfma_f32_16x16x32_bf16 v[140:143], a[140:143], v[208:211], v[140:143]
    s_waitcnt lgkmcnt(3)
    v_exp_f32 v203, v203
    v_mfma_f32_16x16x32_bf16 v[196:199], a[112:115], a[0:3], v[216:219]
    s_waitcnt lgkmcnt(2)
    v_cvt_pk_bf16_f32 v212, v200, v201
    v_cvt_pk_bf16_f32 v213, v202, v203
    v_mfma_f32_16x16x32_bf16 v[196:199], a[116:119], a[4:7], v[196:199]
    s_waitcnt lgkmcnt(1)
    v_exp_f32 v204, v204
    v_mfma_f32_16x16x32_bf16 v[196:199], a[120:123], a[8:11], v[196:199]
    s_waitcnt lgkmcnt(0)
    v_mfma_f32_16x16x32_bf16 v[196:199], a[124:127], a[12:15], v[196:199]
    s_add_u32 m0, s24, 8456
    v_exp_f32 v205, v205
    v_mfma_f32_16x16x32_bf16 v[144:147], a[144:147], v[208:211], v[144:147]
    buffer_load_dwordx4 v243, s[8:11], s20 offen offset:1024 nt lds
    v_mfma_f32_16x16x32_bf16 v[148:151], a[148:151], v[208:211], v[148:151]
    v_exp_f32 v206, v206
    v_mfma_f32_16x16x32_bf16 v[152:155], a[152:155], v[208:211], v[152:155]
    v_mfma_f32_16x16x32_bf16 v[156:159], a[156:159], v[208:211], v[156:159]
    s_sub_u32 s38, s38, 1
    v_exp_f32 v207, v207
    v_mfma_f32_16x16x32_bf16 v[200:203], a[96:99], a[16:19], v[220:223]
    s_cbranch_scc0 L_loop1
    v_cvt_pk_bf16_f32 v214, v204, v205
    v_cvt_pk_bf16_f32 v215, v206, v207
    v_mfma_f32_16x16x32_bf16 v[200:203], a[100:103], a[20:23], v[200:203]
    v_exp_f32 v192, v192
    v_mfma_f32_16x16x32_bf16 v[200:203], a[104:107], a[24:27], v[200:203]
    v_bfe_u32 v253, v243, 7, 3
    v_bfe_u32 v244, v243, 4, 3
    v_mfma_f32_16x16x32_bf16 v[200:203], a[108:111], a[28:31], v[200:203]
    v_exp_f32 v193, v193
    v_smfmac_f32_16x16x64_bf16 a[168:171], a[172:175], v[208:215], v240
    v_xor_b32 v244, v253, v244
    v_lshl_add_u32 v253, v253, 3, v244
    v_mfma_f32_16x16x32_bf16 v[160:163], a[128:131], v[212:215], v[160:163]
    ds_read_b64_tr_b16 a[128:129], v242 offset:16896
    ds_read_b64_tr_b16 a[130:131], v242 offset:17408
    v_mfma_f32_16x16x32_bf16 v[164:167], a[132:135], v[212:215], v[164:167]
    v_exp_f32 v194, v194
    v_mfma_f32_16x16x32_bf16 v[168:171], a[136:139], v[212:215], v[168:171]
    ds_read_b64_tr_b16 a[132:133], v242 offset:16904
    ds_read_b64_tr_b16 a[134:135], v242 offset:17416
    v_mfma_f32_16x16x32_bf16 v[172:175], a[140:143], v[212:215], v[172:175]
    v_exp_f32 v195, v195
    v_mfma_f32_16x16x32_bf16 v[204:207], a[112:115], a[16:19], v[220:223]
    v_cvt_pk_bf16_f32 v208, v192, v193
    v_cvt_pk_bf16_f32 v209, v194, v195
    v_mfma_f32_16x16x32_bf16 v[204:207], a[116:119], a[20:23], v[204:207]
    v_exp_f32 v196, v196
    v_mfma_f32_16x16x32_bf16 v[204:207], a[120:123], a[24:27], v[204:207]
    ds_read_b64_tr_b16 a[136:137], v242 offset:16960
    ds_read_b64_tr_b16 a[138:139], v242 offset:17472
    v_mfma_f32_16x16x32_bf16 v[204:207], a[124:127], a[28:31], v[204:207]
    v_exp_f32 v197, v197
    v_mfma_f32_16x16x32_bf16 v[176:179], a[144:147], v[212:215], v[176:179]
    ds_read_b64_tr_b16 a[140:141], v242 offset:16968
    ds_read_b64_tr_b16 a[142:143], v242 offset:17480
    v_mfma_f32_16x16x32_bf16 v[180:183], a[148:151], v[212:215], v[180:183]
    v_exp_f32 v198, v198
    v_mfma_f32_16x16x32_bf16 v[184:187], a[152:155], v[212:215], v[184:187]
    ds_read_b64_tr_b16 a[144:145], v242 offset:17024
    ds_read_b64_tr_b16 a[146:147], v242 offset:17536
    v_mfma_f32_16x16x32_bf16 v[188:191], a[156:159], v[212:215], v[188:191]
    v_exp_f32 v199, v199
    v_mfma_f32_16x16x32_bf16 v[192:195], a[96:99], a[32:35], v[224:227]
    v_cvt_pk_bf16_f32 v210, v196, v197
    v_cvt_pk_bf16_f32 v211, v198, v199
    v_mfma_f32_16x16x32_bf16 v[192:195], a[100:103], a[36:39], v[192:195]
    v_exp_f32 v200, v200
    v_mfma_f32_16x16x32_bf16 v[192:195], a[104:107], a[40:43], v[192:195]
    ds_read_b64_tr_b16 a[148:149], v242 offset:17032
    ds_read_b64_tr_b16 a[150:151], v242 offset:17544
    v_mfma_f32_16x16x32_bf16 v[192:195], a[108:111], a[44:47], v[192:195]
    s_waitcnt lgkmcnt(10)
    v_exp_f32 v201, v201
    v_mfma_f32_16x16x32_bf16 v[0:3], a[128:131], v[208:211], v[0:3]
    s_waitcnt lgkmcnt(8)
    ds_read_b64_tr_b16 a[152:153], v242 offset:17088
    ds_read_b64_tr_b16 a[154:155], v242 offset:17600
    v_mfma_f32_16x16x32_bf16 v[4:7], a[132:135], v[208:211], v[4:7]
    s_waitcnt lgkmcnt(8)
    v_exp_f32 v202, v202
    v_mfma_f32_16x16x32_bf16 v[8:11], a[136:139], v[208:211], v[8:11]
    s_waitcnt lgkmcnt(6)
    ds_read_b64_tr_b16 a[156:157], v242 offset:17096
    ds_read_b64_tr_b16 a[158:159], v242 offset:17608
    v_mfma_f32_16x16x32_bf16 v[12:15], a[140:143], v[208:211], v[12:15]
    v_exp_f32 v203, v203
    v_mfma_f32_16x16x32_bf16 v[196:199], a[112:115], a[32:35], v[224:227]
    v_cvt_pk_bf16_f32 v212, v200, v201
    v_cvt_pk_bf16_f32 v213, v202, v203
    v_mfma_f32_16x16x32_bf16 v[196:199], a[116:119], a[36:39], v[196:199]
    v_exp_f32 v204, v204
    v_mfma_f32_16x16x32_bf16 v[196:199], a[120:123], a[40:43], v[196:199]
    v_lshlrev_b32 v253, 4, v253
    v_add_u32 v253, s42, v253
    v_mfma_f32_16x16x32_bf16 v[196:199], a[124:127], a[44:47], v[196:199]
    s_waitcnt lgkmcnt(6)
    v_exp_f32 v205, v205
    v_mfma_f32_16x16x32_bf16 v[16:19], a[144:147], v[208:211], v[16:19]
    s_waitcnt lgkmcnt(4)
    v_bfe_u32 v252, v243, 4, 4
    v_bfe_u32 v244, v243, 8, 2
    v_mfma_f32_16x16x32_bf16 v[20:23], a[148:151], v[208:211], v[20:23]
    s_waitcnt lgkmcnt(2)
    v_exp_f32 v206, v206
    v_mfma_f32_16x16x32_bf16 v[24:27], a[152:155], v[208:211], v[24:27]
    s_waitcnt lgkmcnt(0)
    v_xor_b32 v244, v252, v244
    v_and_b32 v244, 7, v244
    v_mfma_f32_16x16x32_bf16 v[28:31], a[156:159], v[208:211], v[28:31]
    v_exp_f32 v207, v207
    v_mfma_f32_16x16x32_bf16 v[200:203], a[96:99], a[48:51], v[228:231]
    v_cvt_pk_bf16_f32 v214, v204, v205
    v_cvt_pk_bf16_f32 v215, v206, v207
    v_mfma_f32_16x16x32_bf16 v[200:203], a[100:103], a[52:55], v[200:203]
    v_exp_f32 v192, v192
    v_mfma_f32_16x16x32_bf16 v[200:203], a[104:107], a[56:59], v[200:203]
    v_lshl_add_u32 v252, v252, 3, v244
    v_lshlrev_b32 v252, 4, v252
    v_mfma_f32_16x16x32_bf16 v[200:203], a[108:111], a[60:63], v[200:203]
    v_exp_f32 v193, v193
    v_smfmac_f32_16x16x64_bf16 a[160:163], a[172:175], v[208:215], v240
    v_xor_b32 v251, 64, v252
    v_add_u32 v251, s42, v251
    v_mfma_f32_16x16x32_bf16 v[32:35], a[128:131], v[212:215], v[32:35]
    v_add_u32 v252, s42, v252
    v_mfma_f32_16x16x32_bf16 v[36:39], a[132:135], v[212:215], v[36:39]
    v_exp_f32 v194, v194
    v_mfma_f32_16x16x32_bf16 v[40:43], a[136:139], v[212:215], v[40:43]
    v_mfma_f32_16x16x32_bf16 v[44:47], a[140:143], v[212:215], v[44:47]
    v_exp_f32 v195, v195
    v_mfma_f32_16x16x32_bf16 v[204:207], a[112:115], a[48:51], v[228:231]
    v_cvt_pk_bf16_f32 v208, v192, v193
    v_cvt_pk_bf16_f32 v209, v194, v195
    v_mfma_f32_16x16x32_bf16 v[204:207], a[116:119], a[52:55], v[204:207]
    v_exp_f32 v196, v196
    v_mfma_f32_16x16x32_bf16 v[204:207], a[120:123], a[56:59], v[204:207]
    v_mfma_f32_16x16x32_bf16 v[204:207], a[124:127], a[60:63], v[204:207]
    v_exp_f32 v197, v197
    v_mfma_f32_16x16x32_bf16 v[48:51], a[144:147], v[212:215], v[48:51]
    v_mfma_f32_16x16x32_bf16 v[52:55], a[148:151], v[212:215], v[52:55]
    v_exp_f32 v198, v198
    v_mfma_f32_16x16x32_bf16 v[56:59], a[152:155], v[212:215], v[56:59]
    v_mfma_f32_16x16x32_bf16 v[60:63], a[156:159], v[212:215], v[60:63]
    v_exp_f32 v199, v199
    v_mfma_f32_16x16x32_bf16 v[192:195], a[96:99], a[64:67], v[232:235]
    v_cvt_pk_bf16_f32 v210, v196, v197
    v_cvt_pk_bf16_f32 v211, v198, v199
    v_mfma_f32_16x16x32_bf16 v[192:195], a[100:103], a[68:71], v[192:195]
    v_exp_f32 v200, v200
    v_mfma_f32_16x16x32_bf16 v[192:195], a[104:107], a[72:75], v[192:195]
    v_mfma_f32_16x16x32_bf16 v[192:195], a[108:111], a[76:79], v[192:195]
    v_exp_f32 v201, v201
    v_mfma_f32_16x16x32_bf16 v[64:67], a[128:131], v[208:211], v[64:67]
    v_mfma_f32_16x16x32_bf16 v[68:71], a[132:135], v[208:211], v[68:71]
    v_exp_f32 v202, v202
    v_mfma_f32_16x16x32_bf16 v[72:75], a[136:139], v[208:211], v[72:75]
    v_mfma_f32_16x16x32_bf16 v[76:79], a[140:143], v[208:211], v[76:79]
    v_exp_f32 v203, v203
    v_mfma_f32_16x16x32_bf16 v[196:199], a[112:115], a[64:67], v[232:235]
    v_cvt_pk_bf16_f32 v212, v200, v201
    v_cvt_pk_bf16_f32 v213, v202, v203
    v_mfma_f32_16x16x32_bf16 v[196:199], a[116:119], a[68:71], v[196:199]
    v_exp_f32 v204, v204
    v_mfma_f32_16x16x32_bf16 v[196:199], a[120:123], a[72:75], v[196:199]
    v_mfma_f32_16x16x32_bf16 v[196:199], a[124:127], a[76:79], v[196:199]
    v_exp_f32 v205, v205
    v_mfma_f32_16x16x32_bf16 v[80:83], a[144:147], v[208:211], v[80:83]
    v_mfma_f32_16x16x32_bf16 v[84:87], a[148:151], v[208:211], v[84:87]
    s_waitcnt vmcnt(4)
    v_exp_f32 v206, v206
    v_mfma_f32_16x16x32_bf16 v[88:91], a[152:155], v[208:211], v[88:91]
    s_barrier
    v_mfma_f32_16x16x32_bf16 v[92:95], a[156:159], v[208:211], v[92:95]
    v_exp_f32 v207, v207
    v_mfma_f32_16x16x32_bf16 v[200:203], a[96:99], a[80:83], v[236:239]
    v_cvt_pk_bf16_f32 v214, v204, v205
    v_cvt_pk_bf16_f32 v215, v206, v207
    v_mfma_f32_16x16x32_bf16 v[200:203], a[100:103], a[84:87], v[200:203]
    v_exp_f32 v192, v192
    v_mfma_f32_16x16x32_bf16 v[200:203], a[104:107], a[88:91], v[200:203]
    ds_read_b128 a[96:99], v241 offset:33792
    ds_read_b128 a[100:103], v241 offset:33856
    v_mfma_f32_16x16x32_bf16 v[200:203], a[108:111], a[92:95], v[200:203]
    v_exp_f32 v193, v193
    v_smfmac_f32_16x16x64_bf16 a[164:167], a[172:175], v[208:215], v240
    ds_read_b128 a[104:107], v241 offset:33920
    ds_read_b128 a[108:111], v241 offset:33984
    v_mfma_f32_16x16x32_bf16 v[96:99], a[128:131], v[212:215], v[96:99]
    v_mfma_f32_16x16x32_bf16 v[100:103], a[132:135], v[212:215], v[100:103]
    v_exp_f32 v194, v194
    v_mfma_f32_16x16x32_bf16 v[104:107], a[136:139], v[212:215], v[104:107]
    v_mfma_f32_16x16x32_bf16 v[108:111], a[140:143], v[212:215], v[108:111]
    v_exp_f32 v195, v195
    v_mfma_f32_16x16x32_bf16 v[204:207], a[112:115], a[80:83], v[236:239]
    v_cvt_pk_bf16_f32 v208, v192, v193
    v_cvt_pk_bf16_f32 v209, v194, v195
    v_mfma_f32_16x16x32_bf16 v[204:207], a[116:119], a[84:87], v[204:207]
    v_exp_f32 v196, v196
    v_mfma_f32_16x16x32_bf16 v[204:207], a[120:123], a[88:91], v[204:207]
    ds_read_b128 a[112:115], v241 offset:34304
    ds_read_b128 a[116:119], v241 offset:34368
    v_mfma_f32_16x16x32_bf16 v[204:207], a[124:127], a[92:95], v[204:207]
    v_exp_f32 v197, v197
    v_mfma_f32_16x16x32_bf16 v[112:115], a[144:147], v[212:215], v[112:115]
    ds_read_b128 a[120:123], v241 offset:34432
    ds_read_b128 a[124:127], v241 offset:34496
    v_mfma_f32_16x16x32_bf16 v[116:119], a[148:151], v[212:215], v[116:119]
    v_exp_f32 v198, v198
    v_mfma_f32_16x16x32_bf16 v[120:123], a[152:155], v[212:215], v[120:123]
    v_mfma_f32_16x16x32_bf16 v[124:127], a[156:159], v[212:215], v[124:127]
    s_waitcnt lgkmcnt(7)
    v_exp_f32 v199, v199
    v_mfma_f32_16x16x32_bf16 v[192:195], a[96:99], a[0:3], v[216:219]
    s_waitcnt lgkmcnt(6)
    v_cvt_pk_bf16_f32 v210, v196, v197
    v_cvt_pk_bf16_f32 v211, v198, v199
    v_mfma_f32_16x16x32_bf16 v[192:195], a[100:103], a[4:7], v[192:195]
    s_waitcnt lgkmcnt(5)
    v_exp_f32 v200, v200
    v_mfma_f32_16x16x32_bf16 v[192:195], a[104:107], a[8:11], v[192:195]
    s_waitcnt lgkmcnt(4)
    v_mfma_f32_16x16x32_bf16 v[192:195], a[108:111], a[12:15], v[192:195]
    v_exp_f32 v201, v201
    v_mfma_f32_16x16x32_bf16 v[128:131], a[128:131], v[208:211], v[128:131]
    v_mfma_f32_16x16x32_bf16 v[132:135], a[132:135], v[208:211], v[132:135]
    v_exp_f32 v202, v202
    v_mfma_f32_16x16x32_bf16 v[136:139], a[136:139], v[208:211], v[136:139]
    v_mfma_f32_16x16x32_bf16 v[140:143], a[140:143], v[208:211], v[140:143]
    s_waitcnt lgkmcnt(3)
    v_exp_f32 v203, v203
    v_mfma_f32_16x16x32_bf16 v[196:199], a[112:115], a[0:3], v[216:219]
    s_waitcnt lgkmcnt(2)
    v_cvt_pk_bf16_f32 v212, v200, v201
    v_cvt_pk_bf16_f32 v213, v202, v203
    v_mfma_f32_16x16x32_bf16 v[196:199], a[116:119], a[4:7], v[196:199]
    s_waitcnt lgkmcnt(1)
    v_exp_f32 v204, v204
    v_mfma_f32_16x16x32_bf16 v[196:199], a[120:123], a[8:11], v[196:199]
    s_waitcnt lgkmcnt(0)
    v_mfma_f32_16x16x32_bf16 v[196:199], a[124:127], a[12:15], v[196:199]
    v_exp_f32 v205, v205
    v_mfma_f32_16x16x32_bf16 v[144:147], a[144:147], v[208:211], v[144:147]
    v_mfma_f32_16x16x32_bf16 v[148:151], a[148:151], v[208:211], v[148:151]
    v_exp_f32 v206, v206
    v_mfma_f32_16x16x32_bf16 v[152:155], a[152:155], v[208:211], v[152:155]
    v_mfma_f32_16x16x32_bf16 v[156:159], a[156:159], v[208:211], v[156:159]
    v_exp_f32 v207, v207
    v_mfma_f32_16x16x32_bf16 v[200:203], a[96:99], a[16:19], v[220:223]
    v_cvt_pk_bf16_f32 v214, v204, v205
    v_cvt_pk_bf16_f32 v215, v206, v207
    v_mfma_f32_16x16x32_bf16 v[200:203], a[100:103], a[20:23], v[200:203]
    v_exp_f32 v192, v192
    v_mfma_f32_16x16x32_bf16 v[200:203], a[104:107], a[24:27], v[200:203]
    v_mfma_f32_16x16x32_bf16 v[200:203], a[108:111], a[28:31], v[200:203]
    v_exp_f32 v193, v193
    v_smfmac_f32_16x16x64_bf16 a[168:171], a[172:175], v[208:215], v240
    v_mfma_f32_16x16x32_bf16 v[160:163], a[128:131], v[212:215], v[160:163]
    ds_read_b64_tr_b16 a[128:129], v242 offset:33792
    ds_read_b64_tr_b16 a[130:131], v242 offset:34304
    v_mfma_f32_16x16x32_bf16 v[164:167], a[132:135], v[212:215], v[164:167]
    v_exp_f32 v194, v194
    v_mfma_f32_16x16x32_bf16 v[168:171], a[136:139], v[212:215], v[168:171]
    ds_read_b64_tr_b16 a[132:133], v242 offset:33800
    ds_read_b64_tr_b16 a[134:135], v242 offset:34312
    v_mfma_f32_16x16x32_bf16 v[172:175], a[140:143], v[212:215], v[172:175]
    v_exp_f32 v195, v195
    v_mfma_f32_16x16x32_bf16 v[204:207], a[112:115], a[16:19], v[220:223]
    v_cvt_pk_bf16_f32 v208, v192, v193
    v_cvt_pk_bf16_f32 v209, v194, v195
    v_mfma_f32_16x16x32_bf16 v[204:207], a[116:119], a[20:23], v[204:207]
    v_exp_f32 v196, v196
    v_mfma_f32_16x16x32_bf16 v[204:207], a[120:123], a[24:27], v[204:207]
    ds_read_b64_tr_b16 a[136:137], v242 offset:33856
    ds_read_b64_tr_b16 a[138:139], v242 offset:34368
    v_mfma_f32_16x16x32_bf16 v[204:207], a[124:127], a[28:31], v[204:207]
    v_exp_f32 v197, v197
    v_mfma_f32_16x16x32_bf16 v[176:179], a[144:147], v[212:215], v[176:179]
    ds_read_b64_tr_b16 a[140:141], v242 offset:33864
    ds_read_b64_tr_b16 a[142:143], v242 offset:34376
    v_mfma_f32_16x16x32_bf16 v[180:183], a[148:151], v[212:215], v[180:183]
    v_exp_f32 v198, v198
    v_mfma_f32_16x16x32_bf16 v[184:187], a[152:155], v[212:215], v[184:187]
    ds_read_b64_tr_b16 a[144:145], v242 offset:33920
    ds_read_b64_tr_b16 a[146:147], v242 offset:34432
    v_mfma_f32_16x16x32_bf16 v[188:191], a[156:159], v[212:215], v[188:191]
    v_exp_f32 v199, v199
    v_mfma_f32_16x16x32_bf16 v[192:195], a[96:99], a[32:35], v[224:227]
    v_cvt_pk_bf16_f32 v210, v196, v197
    v_cvt_pk_bf16_f32 v211, v198, v199
    v_mfma_f32_16x16x32_bf16 v[192:195], a[100:103], a[36:39], v[192:195]
    v_exp_f32 v200, v200
    v_mfma_f32_16x16x32_bf16 v[192:195], a[104:107], a[40:43], v[192:195]
    ds_read_b64_tr_b16 a[148:149], v242 offset:33928
    ds_read_b64_tr_b16 a[150:151], v242 offset:34440
    v_mfma_f32_16x16x32_bf16 v[192:195], a[108:111], a[44:47], v[192:195]
    s_waitcnt lgkmcnt(10)
    v_exp_f32 v201, v201
    v_mfma_f32_16x16x32_bf16 v[0:3], a[128:131], v[208:211], v[0:3]
    s_waitcnt lgkmcnt(8)
    ds_read_b64_tr_b16 a[152:153], v242 offset:33984
    ds_read_b64_tr_b16 a[154:155], v242 offset:34496
    v_mfma_f32_16x16x32_bf16 v[4:7], a[132:135], v[208:211], v[4:7]
    s_waitcnt lgkmcnt(8)
    v_exp_f32 v202, v202
    v_mfma_f32_16x16x32_bf16 v[8:11], a[136:139], v[208:211], v[8:11]
    s_waitcnt lgkmcnt(6)
    ds_read_b64_tr_b16 a[156:157], v242 offset:33992
    ds_read_b64_tr_b16 a[158:159], v242 offset:34504
    v_mfma_f32_16x16x32_bf16 v[12:15], a[140:143], v[208:211], v[12:15]
    v_exp_f32 v203, v203
    v_mfma_f32_16x16x32_bf16 v[196:199], a[112:115], a[32:35], v[224:227]
    v_cvt_pk_bf16_f32 v212, v200, v201
    v_cvt_pk_bf16_f32 v213, v202, v203
    v_mfma_f32_16x16x32_bf16 v[196:199], a[116:119], a[36:39], v[196:199]
    v_exp_f32 v204, v204
    v_mfma_f32_16x16x32_bf16 v[196:199], a[120:123], a[40:43], v[196:199]
    v_mfma_f32_16x16x32_bf16 v[196:199], a[124:127], a[44:47], v[196:199]
    s_waitcnt lgkmcnt(6)
    v_exp_f32 v205, v205
    v_mfma_f32_16x16x32_bf16 v[16:19], a[144:147], v[208:211], v[16:19]
    s_waitcnt lgkmcnt(4)
    v_mfma_f32_16x16x32_bf16 v[20:23], a[148:151], v[208:211], v[20:23]
    s_waitcnt lgkmcnt(2)
    v_exp_f32 v206, v206
    v_mfma_f32_16x16x32_bf16 v[24:27], a[152:155], v[208:211], v[24:27]
    s_waitcnt lgkmcnt(0)
    v_mfma_f32_16x16x32_bf16 v[28:31], a[156:159], v[208:211], v[28:31]
    v_exp_f32 v207, v207
    v_mfma_f32_16x16x32_bf16 v[200:203], a[96:99], a[48:51], v[228:231]
    v_cvt_pk_bf16_f32 v214, v204, v205
    v_cvt_pk_bf16_f32 v215, v206, v207
    v_mfma_f32_16x16x32_bf16 v[200:203], a[100:103], a[52:55], v[200:203]
    v_exp_f32 v192, v192
    v_mfma_f32_16x16x32_bf16 v[200:203], a[104:107], a[56:59], v[200:203]
    v_mfma_f32_16x16x32_bf16 v[200:203], a[108:111], a[60:63], v[200:203]
    v_exp_f32 v193, v193
    v_smfmac_f32_16x16x64_bf16 a[160:163], a[172:175], v[208:215], v240
    v_mfma_f32_16x16x32_bf16 v[32:35], a[128:131], v[212:215], v[32:35]
    v_mfma_f32_16x16x32_bf16 v[36:39], a[132:135], v[212:215], v[36:39]
    v_exp_f32 v194, v194
    v_mfma_f32_16x16x32_bf16 v[40:43], a[136:139], v[212:215], v[40:43]
    v_mfma_f32_16x16x32_bf16 v[44:47], a[140:143], v[212:215], v[44:47]
    v_exp_f32 v195, v195
    v_mfma_f32_16x16x32_bf16 v[204:207], a[112:115], a[48:51], v[228:231]
    v_cvt_pk_bf16_f32 v208, v192, v193
    v_cvt_pk_bf16_f32 v209, v194, v195
    v_mfma_f32_16x16x32_bf16 v[204:207], a[116:119], a[52:55], v[204:207]
    v_exp_f32 v196, v196
    v_mfma_f32_16x16x32_bf16 v[204:207], a[120:123], a[56:59], v[204:207]
    v_mfma_f32_16x16x32_bf16 v[204:207], a[124:127], a[60:63], v[204:207]
    v_exp_f32 v197, v197
    v_mfma_f32_16x16x32_bf16 v[48:51], a[144:147], v[212:215], v[48:51]
    v_mfma_f32_16x16x32_bf16 v[52:55], a[148:151], v[212:215], v[52:55]
    v_exp_f32 v198, v198
    v_mfma_f32_16x16x32_bf16 v[56:59], a[152:155], v[212:215], v[56:59]
    v_mfma_f32_16x16x32_bf16 v[60:63], a[156:159], v[212:215], v[60:63]
    v_exp_f32 v199, v199
    v_mfma_f32_16x16x32_bf16 v[192:195], a[96:99], a[64:67], v[232:235]
    v_cvt_pk_bf16_f32 v210, v196, v197
    v_cvt_pk_bf16_f32 v211, v198, v199
    v_mfma_f32_16x16x32_bf16 v[192:195], a[100:103], a[68:71], v[192:195]
    v_exp_f32 v200, v200
    v_mfma_f32_16x16x32_bf16 v[192:195], a[104:107], a[72:75], v[192:195]
    v_mfma_f32_16x16x32_bf16 v[192:195], a[108:111], a[76:79], v[192:195]
    v_exp_f32 v201, v201
    v_mfma_f32_16x16x32_bf16 v[64:67], a[128:131], v[208:211], v[64:67]
    v_mfma_f32_16x16x32_bf16 v[68:71], a[132:135], v[208:211], v[68:71]
    v_exp_f32 v202, v202
    v_mfma_f32_16x16x32_bf16 v[72:75], a[136:139], v[208:211], v[72:75]
    v_mfma_f32_16x16x32_bf16 v[76:79], a[140:143], v[208:211], v[76:79]
    v_exp_f32 v203, v203
    v_mfma_f32_16x16x32_bf16 v[196:199], a[112:115], a[64:67], v[232:235]
    v_cvt_pk_bf16_f32 v212, v200, v201
    v_cvt_pk_bf16_f32 v213, v202, v203
    v_mfma_f32_16x16x32_bf16 v[196:199], a[116:119], a[68:71], v[196:199]
    v_exp_f32 v204, v204
    v_mfma_f32_16x16x32_bf16 v[196:199], a[120:123], a[72:75], v[196:199]
    v_mfma_f32_16x16x32_bf16 v[196:199], a[124:127], a[76:79], v[196:199]
    v_exp_f32 v205, v205
    v_mfma_f32_16x16x32_bf16 v[80:83], a[144:147], v[208:211], v[80:83]
    v_mfma_f32_16x16x32_bf16 v[84:87], a[148:151], v[208:211], v[84:87]
    s_waitcnt vmcnt(0)
    v_exp_f32 v206, v206
    v_mfma_f32_16x16x32_bf16 v[88:91], a[152:155], v[208:211], v[88:91]
    s_barrier
    v_mfma_f32_16x16x32_bf16 v[92:95], a[156:159], v[208:211], v[92:95]
    v_exp_f32 v207, v207
    v_mfma_f32_16x16x32_bf16 v[200:203], a[96:99], a[80:83], v[236:239]
    v_cvt_pk_bf16_f32 v214, v204, v205
    v_cvt_pk_bf16_f32 v215, v206, v207
    v_mfma_f32_16x16x32_bf16 v[200:203], a[100:103], a[84:87], v[200:203]
    v_exp_f32 v192, v192
    v_mfma_f32_16x16x32_bf16 v[200:203], a[104:107], a[88:91], v[200:203]
    ds_read_b128 a[96:99], v241 offset:0
    ds_read_b128 a[100:103], v241 offset:64
    v_mfma_f32_16x16x32_bf16 v[200:203], a[108:111], a[92:95], v[200:203]
    v_exp_f32 v193, v193
    v_smfmac_f32_16x16x64_bf16 a[164:167], a[172:175], v[208:215], v240
    ds_read_b128 a[104:107], v241 offset:128
    ds_read_b128 a[108:111], v241 offset:192
    v_mfma_f32_16x16x32_bf16 v[96:99], a[128:131], v[212:215], v[96:99]
    v_mfma_f32_16x16x32_bf16 v[100:103], a[132:135], v[212:215], v[100:103]
    v_exp_f32 v194, v194
    v_mfma_f32_16x16x32_bf16 v[104:107], a[136:139], v[212:215], v[104:107]
    v_mfma_f32_16x16x32_bf16 v[108:111], a[140:143], v[212:215], v[108:111]
    v_exp_f32 v195, v195
    v_mfma_f32_16x16x32_bf16 v[204:207], a[112:115], a[80:83], v[236:239]
    v_cvt_pk_bf16_f32 v208, v192, v193
    v_cvt_pk_bf16_f32 v209, v194, v195
    v_mfma_f32_16x16x32_bf16 v[204:207], a[116:119], a[84:87], v[204:207]
    v_exp_f32 v196, v196
    v_mfma_f32_16x16x32_bf16 v[204:207], a[120:123], a[88:91], v[204:207]
    ds_read_b128 a[112:115], v241 offset:512
    ds_read_b128 a[116:119], v241 offset:576
    v_mfma_f32_16x16x32_bf16 v[204:207], a[124:127], a[92:95], v[204:207]
    v_exp_f32 v197, v197
    v_mfma_f32_16x16x32_bf16 v[112:115], a[144:147], v[212:215], v[112:115]
    ds_read_b128 a[120:123], v241 offset:640
    ds_read_b128 a[124:127], v241 offset:704
    v_mfma_f32_16x16x32_bf16 v[116:119], a[148:151], v[212:215], v[116:119]
    v_exp_f32 v198, v198
    v_mfma_f32_16x16x32_bf16 v[120:123], a[152:155], v[212:215], v[120:123]
    v_mfma_f32_16x16x32_bf16 v[124:127], a[156:159], v[212:215], v[124:127]
    s_waitcnt lgkmcnt(7)
    v_exp_f32 v199, v199
    v_mfma_f32_16x16x32_bf16 v[192:195], a[96:99], a[0:3], v[216:219]
    s_waitcnt lgkmcnt(6)
    v_cvt_pk_bf16_f32 v210, v196, v197
    v_cvt_pk_bf16_f32 v211, v198, v199
    v_mfma_f32_16x16x32_bf16 v[192:195], a[100:103], a[4:7], v[192:195]
    s_waitcnt lgkmcnt(5)
    v_exp_f32 v200, v200
    v_mfma_f32_16x16x32_bf16 v[192:195], a[104:107], a[8:11], v[192:195]
    s_waitcnt lgkmcnt(4)
    v_mfma_f32_16x16x32_bf16 v[192:195], a[108:111], a[12:15], v[192:195]
    v_exp_f32 v201, v201
    v_mfma_f32_16x16x32_bf16 v[128:131], a[128:131], v[208:211], v[128:131]
    v_mfma_f32_16x16x32_bf16 v[132:135], a[132:135], v[208:211], v[132:135]
    v_exp_f32 v202, v202
    v_mfma_f32_16x16x32_bf16 v[136:139], a[136:139], v[208:211], v[136:139]
    v_mfma_f32_16x16x32_bf16 v[140:143], a[140:143], v[208:211], v[140:143]
    s_waitcnt lgkmcnt(3)
    v_exp_f32 v203, v203
    v_mfma_f32_16x16x32_bf16 v[196:199], a[112:115], a[0:3], v[216:219]
    s_waitcnt lgkmcnt(2)
    v_cvt_pk_bf16_f32 v212, v200, v201
    v_cvt_pk_bf16_f32 v213, v202, v203
    v_mfma_f32_16x16x32_bf16 v[196:199], a[116:119], a[4:7], v[196:199]
    s_waitcnt lgkmcnt(1)
    v_exp_f32 v204, v204
    v_mfma_f32_16x16x32_bf16 v[196:199], a[120:123], a[8:11], v[196:199]
    s_waitcnt lgkmcnt(0)
    v_mfma_f32_16x16x32_bf16 v[196:199], a[124:127], a[12:15], v[196:199]
    v_exp_f32 v205, v205
    v_mfma_f32_16x16x32_bf16 v[144:147], a[144:147], v[208:211], v[144:147]
    v_mfma_f32_16x16x32_bf16 v[148:151], a[148:151], v[208:211], v[148:151]
    v_exp_f32 v206, v206
    v_mfma_f32_16x16x32_bf16 v[152:155], a[152:155], v[208:211], v[152:155]
    v_mfma_f32_16x16x32_bf16 v[156:159], a[156:159], v[208:211], v[156:159]
    v_exp_f32 v207, v207
    v_mfma_f32_16x16x32_bf16 v[200:203], a[96:99], a[16:19], v[220:223]
    v_cvt_pk_bf16_f32 v214, v204, v205
    v_cvt_pk_bf16_f32 v215, v206, v207
    v_mfma_f32_16x16x32_bf16 v[200:203], a[100:103], a[20:23], v[200:203]
    v_exp_f32 v192, v192
    v_mfma_f32_16x16x32_bf16 v[200:203], a[104:107], a[24:27], v[200:203]
    v_mfma_f32_16x16x32_bf16 v[200:203], a[108:111], a[28:31], v[200:203]
    v_exp_f32 v193, v193
    v_smfmac_f32_16x16x64_bf16 a[168:171], a[172:175], v[208:215], v240
    v_mfma_f32_16x16x32_bf16 v[160:163], a[128:131], v[212:215], v[160:163]
    ds_read_b64_tr_b16 a[128:129], v242 offset:0
    ds_read_b64_tr_b16 a[130:131], v242 offset:512
    v_mfma_f32_16x16x32_bf16 v[164:167], a[132:135], v[212:215], v[164:167]
    v_exp_f32 v194, v194
    v_mfma_f32_16x16x32_bf16 v[168:171], a[136:139], v[212:215], v[168:171]
    ds_read_b64_tr_b16 a[132:133], v242 offset:8
    ds_read_b64_tr_b16 a[134:135], v242 offset:520
    v_mfma_f32_16x16x32_bf16 v[172:175], a[140:143], v[212:215], v[172:175]
    v_exp_f32 v195, v195
    v_mfma_f32_16x16x32_bf16 v[204:207], a[112:115], a[16:19], v[220:223]
    v_cvt_pk_bf16_f32 v208, v192, v193
    v_cvt_pk_bf16_f32 v209, v194, v195
    v_mfma_f32_16x16x32_bf16 v[204:207], a[116:119], a[20:23], v[204:207]
    v_exp_f32 v196, v196
    v_mfma_f32_16x16x32_bf16 v[204:207], a[120:123], a[24:27], v[204:207]
    ds_read_b64_tr_b16 a[136:137], v242 offset:64
    ds_read_b64_tr_b16 a[138:139], v242 offset:576
    v_mfma_f32_16x16x32_bf16 v[204:207], a[124:127], a[28:31], v[204:207]
    v_exp_f32 v197, v197
    v_mfma_f32_16x16x32_bf16 v[176:179], a[144:147], v[212:215], v[176:179]
    ds_read_b64_tr_b16 a[140:141], v242 offset:72
    ds_read_b64_tr_b16 a[142:143], v242 offset:584
    v_mfma_f32_16x16x32_bf16 v[180:183], a[148:151], v[212:215], v[180:183]
    v_exp_f32 v198, v198
    v_mfma_f32_16x16x32_bf16 v[184:187], a[152:155], v[212:215], v[184:187]
    ds_read_b64_tr_b16 a[144:145], v242 offset:128
    ds_read_b64_tr_b16 a[146:147], v242 offset:640
    v_mfma_f32_16x16x32_bf16 v[188:191], a[156:159], v[212:215], v[188:191]
    v_exp_f32 v199, v199
    v_mfma_f32_16x16x32_bf16 v[192:195], a[96:99], a[32:35], v[224:227]
    v_cvt_pk_bf16_f32 v210, v196, v197
    v_cvt_pk_bf16_f32 v211, v198, v199
    v_mfma_f32_16x16x32_bf16 v[192:195], a[100:103], a[36:39], v[192:195]
    v_exp_f32 v200, v200
    v_mfma_f32_16x16x32_bf16 v[192:195], a[104:107], a[40:43], v[192:195]
    ds_read_b64_tr_b16 a[148:149], v242 offset:136
    ds_read_b64_tr_b16 a[150:151], v242 offset:648
    v_mfma_f32_16x16x32_bf16 v[192:195], a[108:111], a[44:47], v[192:195]
    s_waitcnt lgkmcnt(10)
    v_exp_f32 v201, v201
    v_mfma_f32_16x16x32_bf16 v[0:3], a[128:131], v[208:211], v[0:3]
    s_waitcnt lgkmcnt(8)
    ds_read_b64_tr_b16 a[152:153], v242 offset:192
    ds_read_b64_tr_b16 a[154:155], v242 offset:704
    v_mfma_f32_16x16x32_bf16 v[4:7], a[132:135], v[208:211], v[4:7]
    s_waitcnt lgkmcnt(8)
    v_exp_f32 v202, v202
    v_mfma_f32_16x16x32_bf16 v[8:11], a[136:139], v[208:211], v[8:11]
    s_waitcnt lgkmcnt(6)
    ds_read_b64_tr_b16 a[156:157], v242 offset:200
    ds_read_b64_tr_b16 a[158:159], v242 offset:712
    v_mfma_f32_16x16x32_bf16 v[12:15], a[140:143], v[208:211], v[12:15]
    v_exp_f32 v203, v203
    v_mfma_f32_16x16x32_bf16 v[196:199], a[112:115], a[32:35], v[224:227]
    v_cvt_pk_bf16_f32 v212, v200, v201
    v_cvt_pk_bf16_f32 v213, v202, v203
    v_mfma_f32_16x16x32_bf16 v[196:199], a[116:119], a[36:39], v[196:199]
    v_exp_f32 v204, v204
    v_mfma_f32_16x16x32_bf16 v[196:199], a[120:123], a[40:43], v[196:199]
    v_mfma_f32_16x16x32_bf16 v[196:199], a[124:127], a[44:47], v[196:199]
    s_waitcnt lgkmcnt(6)
    v_exp_f32 v205, v205
    v_mfma_f32_16x16x32_bf16 v[16:19], a[144:147], v[208:211], v[16:19]
    s_waitcnt lgkmcnt(4)
    v_mfma_f32_16x16x32_bf16 v[20:23], a[148:151], v[208:211], v[20:23]
    s_waitcnt lgkmcnt(2)
    v_exp_f32 v206, v206
    v_mfma_f32_16x16x32_bf16 v[24:27], a[152:155], v[208:211], v[24:27]
    s_waitcnt lgkmcnt(0)
    v_mfma_f32_16x16x32_bf16 v[28:31], a[156:159], v[208:211], v[28:31]
    v_exp_f32 v207, v207
    v_mfma_f32_16x16x32_bf16 v[200:203], a[96:99], a[48:51], v[228:231]
    v_cvt_pk_bf16_f32 v214, v204, v205
    v_cvt_pk_bf16_f32 v215, v206, v207
    v_mfma_f32_16x16x32_bf16 v[200:203], a[100:103], a[52:55], v[200:203]
    v_exp_f32 v192, v192
    v_mfma_f32_16x16x32_bf16 v[200:203], a[104:107], a[56:59], v[200:203]
    v_mfma_f32_16x16x32_bf16 v[200:203], a[108:111], a[60:63], v[200:203]
    v_exp_f32 v193, v193
    v_smfmac_f32_16x16x64_bf16 a[160:163], a[172:175], v[208:215], v240
    s_mov_b32 s41, 98304
    v_mfma_f32_16x16x32_bf16 v[32:35], a[128:131], v[212:215], v[32:35]
    v_mfma_f32_16x16x32_bf16 v[36:39], a[132:135], v[212:215], v[36:39]
    v_exp_f32 v194, v194
    v_mfma_f32_16x16x32_bf16 v[40:43], a[136:139], v[212:215], v[40:43]
    v_mfma_f32_16x16x32_bf16 v[44:47], a[140:143], v[212:215], v[44:47]
    v_exp_f32 v195, v195
    v_mfma_f32_16x16x32_bf16 v[204:207], a[112:115], a[48:51], v[228:231]
    v_accvgpr_read_b32 v246, a160
    v_accvgpr_read_b32 v248, a161
    v_add_f32 v246, v246, v248
    v_cmp_nge_f32 vcc, s30, v246
    v_rcp_f32 v246, v246
    v_accvgpr_read_b32 v247, a162
    v_accvgpr_read_b32 v248, a163
    v_add_f32 v247, v247, v248
    v_cvt_pk_bf16_f32 v208, v192, v193
    v_cvt_pk_bf16_f32 v209, v194, v195
    v_mfma_f32_16x16x32_bf16 v[204:207], a[116:119], a[52:55], v[204:207]
    s_or_b64 s[36:37], s[36:37], vcc
    v_pk_mul_f32 v[0:1], v[0:1], v[246:247] op_sel_hi:[1,0]
    v_pk_mul_f32 v[2:3], v[2:3], v[246:247] op_sel_hi:[1,0]
    v_pk_mul_f32 v[4:5], v[4:5], v[246:247] op_sel_hi:[1,0]
    v_pk_mul_f32 v[6:7], v[6:7], v[246:247] op_sel_hi:[1,0]
    v_cvt_pk_bf16_f32 v0, v0, v1
    v_cvt_pk_bf16_f32 v1, v2, v3
    v_cvt_pk_bf16_f32 v2, v4, v5
    v_cvt_pk_bf16_f32 v3, v6, v7
    v_pk_mul_f32 v[8:9], v[8:9], v[246:247] op_sel_hi:[1,0]
    v_pk_mul_f32 v[10:11], v[10:11], v[246:247] op_sel_hi:[1,0]
    v_pk_mul_f32 v[12:13], v[12:13], v[246:247] op_sel_hi:[1,0]
    v_pk_mul_f32 v[14:15], v[14:15], v[246:247] op_sel_hi:[1,0]
    v_cvt_pk_bf16_f32 v8, v8, v9
    v_cvt_pk_bf16_f32 v9, v10, v11
    v_cvt_pk_bf16_f32 v10, v12, v13
    v_cvt_pk_bf16_f32 v11, v14, v15
    v_pk_mul_f32 v[16:17], v[16:17], v[246:247] op_sel_hi:[1,0]
    v_pk_mul_f32 v[18:19], v[18:19], v[246:247] op_sel_hi:[1,0]
    v_pk_mul_f32 v[20:21], v[20:21], v[246:247] op_sel_hi:[1,0]
    v_pk_mul_f32 v[22:23], v[22:23], v[246:247] op_sel_hi:[1,0]
    v_cvt_pk_bf16_f32 v16, v16, v17
    v_cvt_pk_bf16_f32 v17, v18, v19
    v_cvt_pk_bf16_f32 v18, v20, v21
    v_cvt_pk_bf16_f32 v19, v22, v23
    v_pk_mul_f32 v[24:25], v[24:25], v[246:247] op_sel_hi:[1,0]
    v_pk_mul_f32 v[26:27], v[26:27], v[246:247] op_sel_hi:[1,0]
    v_pk_mul_f32 v[28:29], v[28:29], v[246:247] op_sel_hi:[1,0]
    v_pk_mul_f32 v[30:31], v[30:31], v[246:247] op_sel_hi:[1,0]
    v_cvt_pk_bf16_f32 v24, v24, v25
    v_cvt_pk_bf16_f32 v25, v26, v27
    v_cvt_pk_bf16_f32 v26, v28, v29
    v_cvt_pk_bf16_f32 v27, v30, v31
    v_exp_f32 v196, v196
    v_mfma_f32_16x16x32_bf16 v[204:207], a[120:123], a[56:59], v[204:207]
    ds_write_b128 v252, v[0:3] offset:0
    ds_write_b128 v251, v[8:11] offset:0
    ds_read_b128 v[4:7], v253 offset:0
    ds_read_b128 v[12:15], v253 offset:1024
    ds_write_b128 v252, v[16:19] offset:2048
    ds_write_b128 v251, v[24:27] offset:2048
    ds_read_b128 v[20:23], v253 offset:2048
    ds_read_b128 v[28:31], v253 offset:3072
    v_cmp_nge_f32 vcc, s30, v247
    v_rcp_f32 v247, v247
    v_mfma_f32_16x16x32_bf16 v[204:207], a[124:127], a[60:63], v[204:207]
    s_or_b64 s[36:37], s[36:37], vcc
    v_pk_mul_f32 v[32:33], v[32:33], v[246:247] op_sel:[0,1] op_sel_hi:[1,1]
    v_pk_mul_f32 v[34:35], v[34:35], v[246:247] op_sel:[0,1] op_sel_hi:[1,1]
    v_pk_mul_f32 v[36:37], v[36:37], v[246:247] op_sel:[0,1] op_sel_hi:[1,1]
    v_pk_mul_f32 v[38:39], v[38:39], v[246:247] op_sel:[0,1] op_sel_hi:[1,1]
    v_cvt_pk_bf16_f32 v32, v32, v33
    v_cvt_pk_bf16_f32 v33, v34, v35
    v_cvt_pk_bf16_f32 v34, v36, v37
    v_cvt_pk_bf16_f32 v35, v38, v39
    v_exp_f32 v197, v197
    v_mfma_f32_16x16x32_bf16 v[48:51], a[144:147], v[212:215], v[48:51]
    ds_write_b128 v252, v[32:35] offset:4096
    v_pk_mul_f32 v[40:41], v[40:41], v[246:247] op_sel:[0,1] op_sel_hi:[1,1]
    v_pk_mul_f32 v[42:43], v[42:43], v[246:247] op_sel:[0,1] op_sel_hi:[1,1]
    v_pk_mul_f32 v[44:45], v[44:45], v[246:247] op_sel:[0,1] op_sel_hi:[1,1]
    v_pk_mul_f32 v[46:47], v[46:47], v[246:247] op_sel:[0,1] op_sel_hi:[1,1]
    v_cvt_pk_bf16_f32 v40, v40, v41
    v_cvt_pk_bf16_f32 v41, v42, v43
    v_cvt_pk_bf16_f32 v42, v44, v45
    v_cvt_pk_bf16_f32 v43, v46, v47
    v_mfma_f32_16x16x32_bf16 v[52:55], a[148:151], v[212:215], v[52:55]
    ds_write_b128 v251, v[40:43] offset:4096
    ds_read_b128 v[36:39], v253 offset:4096
    ds_read_b128 v[44:47], v253 offset:5120
    v_exp_f32 v198, v198
    v_mfma_f32_16x16x32_bf16 v[56:59], a[152:155], v[212:215], v[56:59]
    v_mfma_f32_16x16x32_bf16 v[60:63], a[156:159], v[212:215], v[60:63]
    v_exp_f32 v199, v199
    v_mfma_f32_16x16x32_bf16 v[192:195], a[96:99], a[64:67], v[232:235]
    v_cvt_pk_bf16_f32 v210, v196, v197
    v_cvt_pk_bf16_f32 v211, v198, v199
    v_mfma_f32_16x16x32_bf16 v[192:195], a[100:103], a[68:71], v[192:195]
    v_exp_f32 v200, v200
    v_mfma_f32_16x16x32_bf16 v[192:195], a[104:107], a[72:75], v[192:195]
    v_pk_mul_f32 v[48:49], v[48:49], v[246:247] op_sel:[0,1] op_sel_hi:[1,1]
    v_pk_mul_f32 v[50:51], v[50:51], v[246:247] op_sel:[0,1] op_sel_hi:[1,1]
    v_pk_mul_f32 v[52:53], v[52:53], v[246:247] op_sel:[0,1] op_sel_hi:[1,1]
    v_pk_mul_f32 v[54:55], v[54:55], v[246:247] op_sel:[0,1] op_sel_hi:[1,1]
    v_cvt_pk_bf16_f32 v48, v48, v49
    v_cvt_pk_bf16_f32 v49, v50, v51
    v_cvt_pk_bf16_f32 v50, v52, v53
    v_cvt_pk_bf16_f32 v51, v54, v55
    v_mfma_f32_16x16x32_bf16 v[192:195], a[108:111], a[76:79], v[192:195]
    ds_write_b128 v252, v[48:51] offset:6144
    v_exp_f32 v201, v201
    v_mfma_f32_16x16x32_bf16 v[64:67], a[128:131], v[208:211], v[64:67]
    v_pk_mul_f32 v[56:57], v[56:57], v[246:247] op_sel:[0,1] op_sel_hi:[1,1]
    v_pk_mul_f32 v[58:59], v[58:59], v[246:247] op_sel:[0,1] op_sel_hi:[1,1]
    v_pk_mul_f32 v[60:61], v[60:61], v[246:247] op_sel:[0,1] op_sel_hi:[1,1]
    v_pk_mul_f32 v[62:63], v[62:63], v[246:247] op_sel:[0,1] op_sel_hi:[1,1]
    v_cvt_pk_bf16_f32 v56, v56, v57
    v_cvt_pk_bf16_f32 v57, v58, v59
    v_cvt_pk_bf16_f32 v58, v60, v61
    v_cvt_pk_bf16_f32 v59, v62, v63
    v_mfma_f32_16x16x32_bf16 v[68:71], a[132:135], v[208:211], v[68:71]
    s_waitcnt lgkmcnt(5)
    buffer_store_dwordx4 v[4:7], v255, s[16:19], s41 offen offset:0 nt sc1
    buffer_store_dwordx4 v[12:15], v255, s[16:19], s41 offen offset:256 nt sc1
    buffer_store_dwordx4 v[20:23], v255, s[16:19], s41 offen offset:128 nt sc1
    buffer_store_dwordx4 v[28:31], v255, s[16:19], s41 offen offset:384 nt sc1
    ds_write_b128 v251, v[56:59] offset:6144
    ds_read_b128 v[52:55], v253 offset:6144
    ds_read_b128 v[60:63], v253 offset:7168
    v_exp_f32 v202, v202
    v_mfma_f32_16x16x32_bf16 v[72:75], a[136:139], v[208:211], v[72:75]
    s_mov_b32 s41, 98816
    v_mfma_f32_16x16x32_bf16 v[76:79], a[140:143], v[208:211], v[76:79]
    v_exp_f32 v203, v203
    v_mfma_f32_16x16x32_bf16 v[196:199], a[112:115], a[64:67], v[232:235]
    s_waitcnt lgkmcnt(4)
    buffer_store_dwordx4 v[36:39], v255, s[16:19], s41 offen offset:0 nt sc1
    buffer_store_dwordx4 v[44:47], v255, s[16:19], s41 offen offset:256 nt sc1
    v_cvt_pk_bf16_f32 v212, v200, v201
    v_cvt_pk_bf16_f32 v213, v202, v203
    v_mfma_f32_16x16x32_bf16 v[196:199], a[116:119], a[68:71], v[196:199]
    v_exp_f32 v204, v204
    v_mfma_f32_16x16x32_bf16 v[196:199], a[120:123], a[72:75], v[196:199]
    v_exp_f32 v192, v192
    v_mfma_f32_16x16x32_bf16 v[196:199], a[124:127], a[76:79], v[196:199]
    v_exp_f32 v205, v205
    v_mfma_f32_16x16x32_bf16 v[80:83], a[144:147], v[208:211], v[80:83]
    v_exp_f32 v193, v193
    v_mfma_f32_16x16x32_bf16 v[84:87], a[148:151], v[208:211], v[84:87]
    v_exp_f32 v206, v206
    v_mfma_f32_16x16x32_bf16 v[88:91], a[152:155], v[208:211], v[88:91]
    v_exp_f32 v194, v194
    v_mfma_f32_16x16x32_bf16 v[92:95], a[156:159], v[208:211], v[92:95]
    v_exp_f32 v207, v207
    v_mfma_f32_16x16x32_bf16 v[200:203], a[96:99], a[80:83], v[236:239]
    s_waitcnt lgkmcnt(0)
    buffer_store_dwordx4 v[52:55], v255, s[16:19], s41 offen offset:128 nt sc1
    buffer_store_dwordx4 v[60:63], v255, s[16:19], s41 offen offset:384 nt sc1
    v_cvt_pk_bf16_f32 v214, v204, v205
    v_cvt_pk_bf16_f32 v215, v206, v207
    v_mfma_f32_16x16x32_bf16 v[200:203], a[100:103], a[84:87], v[200:203]
    v_exp_f32 v195, v195
    v_mfma_f32_16x16x32_bf16 v[200:203], a[104:107], a[88:91], v[200:203]
    v_exp_f32 v196, v196
    v_mfma_f32_16x16x32_bf16 v[200:203], a[108:111], a[92:95], v[200:203]
    v_exp_f32 v197, v197
    v_smfmac_f32_16x16x64_bf16 a[164:167], a[172:175], v[208:215], v240
    s_mov_b32 s41, 106496
    v_exp_f32 v198, v198
    v_mfma_f32_16x16x32_bf16 v[96:99], a[128:131], v[212:215], v[96:99]
    v_exp_f32 v199, v199
    v_mfma_f32_16x16x32_bf16 v[100:103], a[132:135], v[212:215], v[100:103]
    v_cvt_pk_bf16_f32 v208, v192, v193
    v_cvt_pk_bf16_f32 v209, v194, v195
    v_mfma_f32_16x16x32_bf16 v[104:107], a[136:139], v[212:215], v[104:107]
    v_cvt_pk_bf16_f32 v210, v196, v197
    v_cvt_pk_bf16_f32 v211, v198, v199
    v_mfma_f32_16x16x32_bf16 v[108:111], a[140:143], v[212:215], v[108:111]
    v_exp_f32 v200, v200
    v_mfma_f32_16x16x32_bf16 v[204:207], a[112:115], a[80:83], v[236:239]
    v_exp_f32 v201, v201
    v_mfma_f32_16x16x32_bf16 v[204:207], a[116:119], a[84:87], v[204:207]
    v_exp_f32 v202, v202
    v_mfma_f32_16x16x32_bf16 v[204:207], a[120:123], a[88:91], v[204:207]
    v_exp_f32 v203, v203
    v_mfma_f32_16x16x32_bf16 v[204:207], a[124:127], a[92:95], v[204:207]
    v_accvgpr_read_b32 v246, a164
    v_accvgpr_read_b32 v248, a165
    v_mfma_f32_16x16x32_bf16 v[112:115], a[144:147], v[212:215], v[112:115]
    v_add_f32 v246, v246, v248
    v_cmp_nge_f32 vcc, s30, v246
    v_mfma_f32_16x16x32_bf16 v[116:119], a[148:151], v[212:215], v[116:119]
    s_nop 0
    s_or_b64 s[36:37], s[36:37], vcc
    v_rcp_f32 v246, v246
    v_mfma_f32_16x16x32_bf16 v[120:123], a[152:155], v[212:215], v[120:123]
    v_mul_f32 v64, v246, v64
    v_mul_f32 v65, v246, v65
    v_mfma_f32_16x16x32_bf16 v[124:127], a[156:159], v[212:215], v[124:127]
    v_exp_f32 v204, v204
    v_mfma_f32_16x16x32_bf16 v[128:131], a[128:131], v[208:211], v[128:131]
    v_exp_f32 v205, v205
    v_mfma_f32_16x16x32_bf16 v[132:135], a[132:135], v[208:211], v[132:135]
    v_exp_f32 v206, v206
    v_mfma_f32_16x16x32_bf16 v[136:139], a[136:139], v[208:211], v[136:139]
    v_exp_f32 v207, v207
    v_mfma_f32_16x16x32_bf16 v[140:143], a[140:143], v[208:211], v[140:143]
    v_cvt_pk_bf16_f32 v212, v200, v201
    v_cvt_pk_bf16_f32 v213, v202, v203
    v_mfma_f32_16x16x32_bf16 v[144:147], a[144:147], v[208:211], v[144:147]
    v_cvt_pk_bf16_f32 v214, v204, v205
    v_cvt_pk_bf16_f32 v215, v206, v207
    v_mfma_f32_16x16x32_bf16 v[148:151], a[148:151], v[208:211], v[148:151]
    v_mul_f32 v66, v246, v66
    v_mul_f32 v67, v246, v67
    v_mfma_f32_16x16x32_bf16 v[152:155], a[152:155], v[208:211], v[152:155]
    v_mul_f32 v68, v246, v68
    v_mul_f32 v69, v246, v69
    v_mfma_f32_16x16x32_bf16 v[156:159], a[156:159], v[208:211], v[156:159]
    v_mul_f32 v70, v246, v70
    v_mul_f32 v71, v246, v71
    v_mfma_f32_16x16x32_bf16 v[160:163], a[128:131], v[212:215], v[160:163]
    v_cvt_pk_bf16_f32 v64, v64, v65
    v_cvt_pk_bf16_f32 v65, v66, v67
    v_smfmac_f32_16x16x64_bf16 a[168:171], a[172:175], v[208:215], v240
    v_cvt_pk_bf16_f32 v66, v68, v69
    v_cvt_pk_bf16_f32 v67, v70, v71
    v_mfma_f32_16x16x32_bf16 v[164:167], a[132:135], v[212:215], v[164:167]
    ds_write_b128 v252, v[64:67] offset:8192
    v_mfma_f32_16x16x32_bf16 v[168:171], a[136:139], v[212:215], v[168:171]
    v_mul_f32 v72, v246, v72
    v_mul_f32 v73, v246, v73
    v_mfma_f32_16x16x32_bf16 v[172:175], a[140:143], v[212:215], v[172:175]
    v_mul_f32 v74, v246, v74
    v_mul_f32 v75, v246, v75
    v_mfma_f32_16x16x32_bf16 v[176:179], a[144:147], v[212:215], v[176:179]
    v_mul_f32 v76, v246, v76
    v_mul_f32 v77, v246, v77
    v_mfma_f32_16x16x32_bf16 v[180:183], a[148:151], v[212:215], v[180:183]
    v_mul_f32 v78, v246, v78
    v_mul_f32 v79, v246, v79
    v_mfma_f32_16x16x32_bf16 v[184:187], a[152:155], v[212:215], v[184:187]
    v_cvt_pk_bf16_f32 v72, v72, v73
    v_cvt_pk_bf16_f32 v73, v74, v75
    v_mfma_f32_16x16x32_bf16 v[188:191], a[156:159], v[212:215], v[188:191]
    v_cvt_pk_bf16_f32 v74, v76, v77
    v_cvt_pk_bf16_f32 v75, v78, v79
    ds_write_b128 v251, v[72:75] offset:8192
    ds_read_b128 v[68:71], v253 offset:8192
    ds_read_b128 v[76:79], v253 offset:9216
    v_pk_mul_f32 v[80:81], v[80:81], v[246:247] op_sel_hi:[1,0]
    v_pk_mul_f32 v[82:83], v[82:83], v[246:247] op_sel_hi:[1,0]
    v_pk_mul_f32 v[84:85], v[84:85], v[246:247] op_sel_hi:[1,0]
    v_pk_mul_f32 v[86:87], v[86:87], v[246:247] op_sel_hi:[1,0]
    v_cvt_pk_bf16_f32 v80, v80, v81
    v_cvt_pk_bf16_f32 v81, v82, v83
    v_cvt_pk_bf16_f32 v82, v84, v85
    v_cvt_pk_bf16_f32 v83, v86, v87
    ds_write_b128 v252, v[80:83] offset:10240
    v_pk_mul_f32 v[88:89], v[88:89], v[246:247] op_sel_hi:[1,0]
    v_pk_mul_f32 v[90:91], v[90:91], v[246:247] op_sel_hi:[1,0]
    v_pk_mul_f32 v[92:93], v[92:93], v[246:247] op_sel_hi:[1,0]
    v_pk_mul_f32 v[94:95], v[94:95], v[246:247] op_sel_hi:[1,0]
    v_cvt_pk_bf16_f32 v88, v88, v89
    v_cvt_pk_bf16_f32 v89, v90, v91
    v_cvt_pk_bf16_f32 v90, v92, v93
    v_cvt_pk_bf16_f32 v91, v94, v95
    ds_write_b128 v251, v[88:91] offset:10240
    ds_read_b128 v[84:87], v253 offset:10240
    ds_read_b128 v[92:95], v253 offset:11264
    v_accvgpr_read_b32 v247, a166
    v_accvgpr_read_b32 v248, a167
    v_add_f32 v247, v247, v248
    v_cmp_nge_f32 vcc, s30, v247
    s_nop 1
    s_or_b64 s[36:37], s[36:37], vcc
    s_waitcnt lgkmcnt(5)
    buffer_store_dwordx4 v[68:71], v255, s[16:19], s41 offen offset:0 nt sc1
    s_waitcnt lgkmcnt(4)
    buffer_store_dwordx4 v[76:79], v255, s[16:19], s41 offen offset:256 nt sc1
    v_rcp_f32 v247, v247
    v_accvgpr_read_b32 v246, a168
    v_accvgpr_read_b32 v248, a169
    v_pk_mul_f32 v[96:97], v[96:97], v[246:247] op_sel:[0,1] op_sel_hi:[1,1]
    v_pk_mul_f32 v[98:99], v[98:99], v[246:247] op_sel:[0,1] op_sel_hi:[1,1]
    v_pk_mul_f32 v[100:101], v[100:101], v[246:247] op_sel:[0,1] op_sel_hi:[1,1]
    v_pk_mul_f32 v[102:103], v[102:103], v[246:247] op_sel:[0,1] op_sel_hi:[1,1]
    v_cvt_pk_bf16_f32 v96, v96, v97
    v_cvt_pk_bf16_f32 v97, v98, v99
    v_cvt_pk_bf16_f32 v98, v100, v101
    v_cvt_pk_bf16_f32 v99, v102, v103
    ds_write_b128 v252, v[96:99] offset:12288
    v_mul_f32 v104, v247, v104
    v_mul_f32 v105, v247, v105
    v_mul_f32 v106, v247, v106
    v_mul_f32 v107, v247, v107
    v_mul_f32 v108, v247, v108
    v_mul_f32 v109, v247, v109
    s_waitcnt lgkmcnt(2)
    buffer_store_dwordx4 v[84:87], v255, s[16:19], s41 offen offset:128 nt sc1
    s_waitcnt lgkmcnt(1)
    buffer_store_dwordx4 v[92:95], v255, s[16:19], s41 offen offset:384 nt sc1
    s_mov_b32 s41, 107008
    v_mul_f32 v110, v247, v110
    v_mul_f32 v111, v247, v111
    v_cvt_pk_bf16_f32 v104, v104, v105
    v_cvt_pk_bf16_f32 v105, v106, v107
    v_cvt_pk_bf16_f32 v106, v108, v109
    v_cvt_pk_bf16_f32 v107, v110, v111
    ds_write_b128 v251, v[104:107] offset:12288
    ds_read_b128 v[100:103], v253 offset:12288
    ds_read_b128 v[108:111], v253 offset:13312
    v_pk_mul_f32 v[112:113], v[112:113], v[246:247] op_sel:[0,1] op_sel_hi:[1,1]
    v_pk_mul_f32 v[114:115], v[114:115], v[246:247] op_sel:[0,1] op_sel_hi:[1,1]
    v_pk_mul_f32 v[116:117], v[116:117], v[246:247] op_sel:[0,1] op_sel_hi:[1,1]
    v_pk_mul_f32 v[118:119], v[118:119], v[246:247] op_sel:[0,1] op_sel_hi:[1,1]
    v_cvt_pk_bf16_f32 v112, v112, v113
    v_cvt_pk_bf16_f32 v113, v114, v115
    v_cvt_pk_bf16_f32 v114, v116, v117
    v_cvt_pk_bf16_f32 v115, v118, v119
    ds_write_b128 v252, v[112:115] offset:14336
    v_pk_mul_f32 v[120:121], v[120:121], v[246:247] op_sel:[0,1] op_sel_hi:[1,1]
    v_pk_mul_f32 v[122:123], v[122:123], v[246:247] op_sel:[0,1] op_sel_hi:[1,1]
    v_pk_mul_f32 v[124:125], v[124:125], v[246:247] op_sel:[0,1] op_sel_hi:[1,1]
    v_pk_mul_f32 v[126:127], v[126:127], v[246:247] op_sel:[0,1] op_sel_hi:[1,1]
    v_cvt_pk_bf16_f32 v120, v120, v121
    v_cvt_pk_bf16_f32 v121, v122, v123
    v_cvt_pk_bf16_f32 v122, v124, v125
    v_cvt_pk_bf16_f32 v123, v126, v127
    ds_write_b128 v251, v[120:123] offset:14336
    ds_read_b128 v[116:119], v253 offset:14336
    ds_read_b128 v[124:127], v253 offset:15360
    v_add_f32 v246, v246, v248
    v_cmp_nge_f32 vcc, s30, v246
    s_nop 1
    s_or_b64 s[36:37], s[36:37], vcc
    v_rcp_f32 v246, v246
    s_waitcnt lgkmcnt(5)
    buffer_store_dwordx4 v[100:103], v255, s[16:19], s41 offen offset:0 nt sc1
    s_waitcnt lgkmcnt(4)
    buffer_store_dwordx4 v[108:111], v255, s[16:19], s41 offen offset:256 nt sc1
    v_pk_mul_f32 v[128:129], v[128:129], v[246:247] op_sel_hi:[1,0]
    v_pk_mul_f32 v[130:131], v[130:131], v[246:247] op_sel_hi:[1,0]
    v_pk_mul_f32 v[132:133], v[132:133], v[246:247] op_sel_hi:[1,0]
    v_pk_mul_f32 v[134:135], v[134:135], v[246:247] op_sel_hi:[1,0]
    v_cvt_pk_bf16_f32 v128, v128, v129
    v_cvt_pk_bf16_f32 v129, v130, v131
    v_cvt_pk_bf16_f32 v130, v132, v133
    v_cvt_pk_bf16_f32 v131, v134, v135
    ds_write_b128 v252, v[128:131] offset:16384
    v_pk_mul_f32 v[136:137], v[136:137], v[246:247] op_sel_hi:[1,0]
    v_pk_mul_f32 v[138:139], v[138:139], v[246:247] op_sel_hi:[1,0]
    v_pk_mul_f32 v[140:141], v[140:141], v[246:247] op_sel_hi:[1,0]
    v_pk_mul_f32 v[142:143], v[142:143], v[246:247] op_sel_hi:[1,0]
    v_cvt_pk_bf16_f32 v136, v136, v137
    v_cvt_pk_bf16_f32 v137, v138, v139
    s_waitcnt lgkmcnt(2)
    buffer_store_dwordx4 v[116:119], v255, s[16:19], s41 offen offset:128 nt sc1
    s_waitcnt lgkmcnt(1)
    buffer_store_dwordx4 v[124:127], v255, s[16:19], s41 offen offset:384 nt sc1
    s_mov_b32 s41, 114688
    v_cvt_pk_bf16_f32 v138, v140, v141
    v_cvt_pk_bf16_f32 v139, v142, v143
    ds_write_b128 v251, v[136:139] offset:16384
    ds_read_b128 v[132:135], v253 offset:16384
    ds_read_b128 v[140:143], v253 offset:17408
    v_pk_mul_f32 v[144:145], v[144:145], v[246:247] op_sel_hi:[1,0]
    v_pk_mul_f32 v[146:147], v[146:147], v[246:247] op_sel_hi:[1,0]
    v_pk_mul_f32 v[148:149], v[148:149], v[246:247] op_sel_hi:[1,0]
    v_pk_mul_f32 v[150:151], v[150:151], v[246:247] op_sel_hi:[1,0]
    v_cvt_pk_bf16_f32 v144, v144, v145
    v_cvt_pk_bf16_f32 v145, v146, v147
    v_cvt_pk_bf16_f32 v146, v148, v149
    v_cvt_pk_bf16_f32 v147, v150, v151
    ds_write_b128 v252, v[144:147] offset:18432
    v_pk_mul_f32 v[152:153], v[152:153], v[246:247] op_sel_hi:[1,0]
    v_pk_mul_f32 v[154:155], v[154:155], v[246:247] op_sel_hi:[1,0]
    v_pk_mul_f32 v[156:157], v[156:157], v[246:247] op_sel_hi:[1,0]
    v_pk_mul_f32 v[158:159], v[158:159], v[246:247] op_sel_hi:[1,0]
    v_cvt_pk_bf16_f32 v152, v152, v153
    v_cvt_pk_bf16_f32 v153, v154, v155
    v_cvt_pk_bf16_f32 v154, v156, v157
    v_cvt_pk_bf16_f32 v155, v158, v159
    ds_write_b128 v251, v[152:155] offset:18432
    ds_read_b128 v[148:151], v253 offset:18432
    ds_read_b128 v[156:159], v253 offset:19456
    v_accvgpr_read_b32 v247, a170
    v_accvgpr_read_b32 v248, a171
    v_add_f32 v247, v247, v248
    v_cmp_nge_f32 vcc, s30, v247
    s_nop 1
    s_or_b64 s[36:37], s[36:37], vcc
    s_waitcnt lgkmcnt(5)
    buffer_store_dwordx4 v[132:135], v255, s[16:19], s41 offen offset:0 nt sc1
    s_waitcnt lgkmcnt(4)
    buffer_store_dwordx4 v[140:143], v255, s[16:19], s41 offen offset:256 nt sc1
    v_rcp_f32 v247, v247
    s_nop 0
    v_pk_mul_f32 v[160:161], v[160:161], v[246:247] op_sel:[0,1] op_sel_hi:[1,1]
    v_pk_mul_f32 v[162:163], v[162:163], v[246:247] op_sel:[0,1] op_sel_hi:[1,1]
    v_pk_mul_f32 v[164:165], v[164:165], v[246:247] op_sel:[0,1] op_sel_hi:[1,1]
    v_pk_mul_f32 v[166:167], v[166:167], v[246:247] op_sel:[0,1] op_sel_hi:[1,1]
    v_cvt_pk_bf16_f32 v160, v160, v161
    v_cvt_pk_bf16_f32 v161, v162, v163
    v_cvt_pk_bf16_f32 v162, v164, v165
    v_cvt_pk_bf16_f32 v163, v166, v167
    ds_write_b128 v252, v[160:163] offset:20480
    v_mul_f32 v168, v247, v168
    v_mul_f32 v169, v247, v169
    v_mul_f32 v170, v247, v170
    v_mul_f32 v171, v247, v171
    v_mul_f32 v172, v247, v172
    v_mul_f32 v173, v247, v173
    s_waitcnt lgkmcnt(2)
    buffer_store_dwordx4 v[148:151], v255, s[16:19], s41 offen offset:128 nt sc1
    s_waitcnt lgkmcnt(1)
    buffer_store_dwordx4 v[156:159], v255, s[16:19], s41 offen offset:384 nt sc1
    s_mov_b32 s41, 115200
    v_mul_f32 v174, v247, v174
    v_mul_f32 v175, v247, v175
    v_cvt_pk_bf16_f32 v168, v168, v169
    v_cvt_pk_bf16_f32 v169, v170, v171
    v_cvt_pk_bf16_f32 v170, v172, v173
    v_cvt_pk_bf16_f32 v171, v174, v175
    ds_write_b128 v251, v[168:171] offset:20480
    ds_read_b128 v[164:167], v253 offset:20480
    ds_read_b128 v[172:175], v253 offset:21504
    v_pk_mul_f32 v[176:177], v[176:177], v[246:247] op_sel:[0,1] op_sel_hi:[1,1]
    v_pk_mul_f32 v[178:179], v[178:179], v[246:247] op_sel:[0,1] op_sel_hi:[1,1]
    v_pk_mul_f32 v[180:181], v[180:181], v[246:247] op_sel:[0,1] op_sel_hi:[1,1]
    v_pk_mul_f32 v[182:183], v[182:183], v[246:247] op_sel:[0,1] op_sel_hi:[1,1]
    v_cvt_pk_bf16_f32 v176, v176, v177
    v_cvt_pk_bf16_f32 v177, v178, v179
    v_cvt_pk_bf16_f32 v178, v180, v181
    v_cvt_pk_bf16_f32 v179, v182, v183
    ds_write_b128 v252, v[176:179] offset:22528
    v_pk_mul_f32 v[184:185], v[184:185], v[246:247] op_sel:[0,1] op_sel_hi:[1,1]
    v_pk_mul_f32 v[186:187], v[186:187], v[246:247] op_sel:[0,1] op_sel_hi:[1,1]
    v_pk_mul_f32 v[188:189], v[188:189], v[246:247] op_sel:[0,1] op_sel_hi:[1,1]
    v_pk_mul_f32 v[190:191], v[190:191], v[246:247] op_sel:[0,1] op_sel_hi:[1,1]
    v_cvt_pk_bf16_f32 v184, v184, v185
    v_cvt_pk_bf16_f32 v185, v186, v187
    v_cvt_pk_bf16_f32 v186, v188, v189
    v_cvt_pk_bf16_f32 v187, v190, v191
    ds_write_b128 v251, v[184:187] offset:22528
    ds_read_b128 v[180:183], v253 offset:22528
    ds_read_b128 v[188:191], v253 offset:23552
    s_waitcnt lgkmcnt(5)
    buffer_store_dwordx4 v[164:167], v255, s[16:19], s41 offen offset:0 nt sc1
    s_waitcnt lgkmcnt(4)
    buffer_store_dwordx4 v[172:175], v255, s[16:19], s41 offen offset:256 nt sc1
    s_waitcnt lgkmcnt(1)
    buffer_store_dwordx4 v[180:183], v255, s[16:19], s41 offen offset:128 nt sc1
    s_waitcnt lgkmcnt(0)
    buffer_store_dwordx4 v[188:191], v255, s[16:19], s41 offen offset:384 nt sc1
    s_or_b64 s[54:55], s[34:35], s[36:37]
    s_cbranch_scc1 L_slow
L_done:
    s_endpgm
L_code_end:
L_slow:
    s_waitcnt vmcnt(0) lgkmcnt(0)
    s_mov_b32 s52, s42
    v_and_b32 v1, 63, v243
    v_lshrrev_b32 v162, 4, v243
    v_and_b32 v162, 63, v162
    v_and_b32 v2, 15, v162
    v_lshrrev_b32 v3, 4, v162
    v_and_b32 v4, 7, v2
    v_mul_u32_u24 v160, 1056, v4
    v_lshrrev_b32 v4, 3, v2
    v_lshl_add_u32 v160, v4, 8, v160
    v_lshl_add_u32 v160, v3, 4, v160
    v_add_u32 v160, s52, v160
    v_bfe_u32 v4, v162, 2, 3
    v_mul_u32_u24 v161, 1056, v4
    v_lshrrev_b32 v4, 5, v162
    v_lshl_add_u32 v161, v4, 8, v161
    v_and_b32 v4, 3, v162
    v_lshl_add_u32 v161, v4, 3, v161
    v_add_u32 v161, 8448, v161
    v_add_u32 v161, s52, v161
    v_lshlrev_b32 v4, 4, v3
    v_sub_u32 v163, v254, v4
    v_and_b32 v4, 1, v3
    v_lshl_add_u32 v163, v4, 5, v163
    v_lshrrev_b32 v4, 1, v3
    v_lshl_add_u32 v163, v4, 4, v163
    v_lshlrev_b32 v162, 4, v162
    s_mov_b32 s53, 0
L_slow_head:
    s_cmp_eq_u32 s53, 0
    s_cselect_b64 s[54:55], s[34:35], s[36:37]
    s_cmp_eq_u64 s[54:55], 0
    s_cbranch_scc1 L_slow_next
    s_mov_b32 s56, 0
L_slow_blk:
    s_mul_i32 s57, s53, 98304
    s_lshr_b32 s58, s56, 1
    s_lshl_b32 s58, s58, 13
    s_add_u32 s57, s57, s58
    s_and_b32 s58, s56, 1
    s_lshl_b32 s58, s58, 9
    s_add_u32 s57, s57, s58
    buffer_load_dwordx4 v[0:3], v254, s[12:15], s57 offen offset:0
    buffer_load_dwordx4 v[4:7], v254, s[12:15], s57 offen offset:64
    buffer_load_dwordx4 v[8:11], v254, s[12:15], s57 offen offset:128
    buffer_load_dwordx4 v[12:15], v254, s[12:15], s57 offen offset:192
    s_waitcnt vmcnt(0)
    v_lshlrev_b32 v42, 16, v0
    v_and_b32 v43, s31, v0
    v_mul_f32 v42, s28, v42
    v_mul_f32 v43, s28, v43
    v_cvt_pk_bf16_f32 v16, v42, v43
    v_lshlrev_b32 v42, 16, v1
    v_and_b32 v43, s31, v1
    v_mul_f32 v42, s28, v42
    v_mul_f32 v43, s28, v43
    v_cvt_pk_bf16_f32 v17, v42, v43
    v_lshlrev_b32 v42, 16, v2
    v_and_b32 v43, s31, v2
    v_mul_f32 v42, s28, v42
    v_mul_f32 v43, s28, v43
    v_cvt_pk_bf16_f32 v18, v42, v43
    v_lshlrev_b32 v42, 16, v3
    v_and_b32 v43, s31, v3
    v_mul_f32 v42, s28, v42
    v_mul_f32 v43, s28, v43
    v_cvt_pk_bf16_f32 v19, v42, v43
    v_lshlrev_b32 v42, 16, v4
    v_and_b32 v43, s31, v4
    v_mul_f32 v42, s28, v42
    v_mul_f32 v43, s28, v43
    v_cvt_pk_bf16_f32 v20, v42, v43
    v_lshlrev_b32 v42, 16, v5
    v_and_b32 v43, s31, v5
    v_mul_f32 v42, s28, v42
    v_mul_f32 v43, s28, v43
    v_cvt_pk_bf16_f32 v21, v42, v43
    v_lshlrev_b32 v42, 16, v6
    v_and_b32 v43, s31, v6
    v_mul_f32 v42, s28, v42
    v_mul_f32 v43, s28, v43
    v_cvt_pk_bf16_f32 v22, v42, v43
    v_lshlrev_b32 v42, 16, v7
    v_and_b32 v43, s31, v7
    v_mul_f32 v42, s28, v42
    v_mul_f32 v43, s28, v43
    v_cvt_pk_bf16_f32 v23, v42, v43
    v_lshlrev_b32 v42, 16, v8
    v_and_b32 v43, s31, v8
    v_mul_f32 v42, s28, v42
    v_mul_f32 v43, s28, v43
    v_cvt_pk_bf16_f32 v24, v42, v43
    v_lshlrev_b32 v42, 16, v9
    v_and_b32 v43, s31, v9
    v_mul_f32 v42, s28, v42
    v_mul_f32 v43, s28, v43
    v_cvt_pk_bf16_f32 v25, v42, v43
    v_lshlrev_b32 v42, 16, v10
    v_and_b32 v43, s31, v10
    v_mul_f32 v42, s28, v42
    v_mul_f32 v43, s28, v43
    v_cvt_pk_bf16_f32 v26, v42, v43
    v_lshlrev_b32 v42, 16, v11
    v_and_b32 v43, s31, v11
    v_mul_f32 v42, s28, v42
    v_mul_f32 v43, s28, v43
    v_cvt_pk_bf16_f32 v27, v42, v43
    v_lshlrev_b32 v42, 16, v12
    v_and_b32 v43, s31, v12
    v_mul_f32 v42, s28, v42
    v_mul_f32 v43, s28, v43
    v_cvt_pk_bf16_f32 v28, v42, v43
    v_lshlrev_b32 v42, 16, v13
    v_and_b32 v43, s31, v13
    v_mul_f32 v42, s28, v42
    v_mul_f32 v43, s28, v43
    v_cvt_pk_bf16_f32 v29, v42, v43
    v_lshlrev_b32 v42, 16, v14
    v_and_b32 v43, s31, v14
    v_mul_f32 v42, s28, v42
    v_mul_f32 v43, s28, v43
    v_cvt_pk_bf16_f32 v30, v42, v43
    v_lshlrev_b32 v42, 16, v15
    v_and_b32 v43, s31, v15
    v_mul_f32 v42, s28, v42
    v_mul_f32 v43, s28, v43
    v_cvt_pk_bf16_f32 v31, v42, v43
    v_mov_b32 v32, 0xff800000
    v_mov_b32 v33, 0
    v_mov_b32 v64, 0
    v_mov_b32 v65, 0
    v_mov_b32 v66, 0
    v_mov_b32 v67, 0
    v_mov_b32 v68, 0
    v_mov_b32 v69, 0
    v_mov_b32 v70, 0
    v_mov_b32 v71, 0
    v_mov_b32 v72, 0
    v_mov_b32 v73, 0
    v_mov_b32 v74, 0
    v_mov_b32 v75, 0
    v_mov_b32 v76, 0
    v_mov_b32 v77, 0
    v_mov_b32 v78, 0
    v_mov_b32 v79, 0
    v_mov_b32 v80, 0
    v_mov_b32 v81, 0
    v_mov_b32 v82, 0
    v_mov_b32 v83, 0
    v_mov_b32 v84, 0
    v_mov_b32 v85, 0
    v_mov_b32 v86, 0
    v_mov_b32 v87, 0
    v_mov_b32 v88, 0
    v_mov_b32 v89, 0
    v_mov_b32 v90, 0
    v_mov_b32 v91, 0
    v_mov_b32 v92, 0
    v_mov_b32 v93, 0
    v_mov_b32 v94, 0
    v_mov_b32 v95, 0
    s_mul_i32 s59, s53, 262144
    s_mov_b32 s60, 0
L_slow_tile:
    s_add_u32 m0, s52, 0
    s_add_u32 s61, s59, 0
    buffer_load_dwordx4 v162, s[4:7], s61 offen lds
    s_add_u32 m0, s52, 8448
    s_add_u32 s61, s59, 0
    buffer_load_dwordx4 v162, s[8:11], s61 offen lds
    s_add_u32 m0, s52, 1056
    s_add_u32 s61, s59, 1024
    buffer_load_dwordx4 v162, s[4:7], s61 offen lds
    s_add_u32 m0, s52, 9504
    s_add_u32 s61, s59, 1024
    buffer_load_dwordx4 v162, s[8:11], s61 offen lds
    s_add_u32 m0, s52, 2112
    s_add_u32 s61, s59, 2048
    buffer_load_dwordx4 v162, s[4:7], s61 offen lds
    s_add_u32 m0, s52, 10560
    s_add_u32 s61, s59, 2048
    buffer_load_dwordx4 v162, s[8:11], s61 offen lds
    s_add_u32 m0, s52, 3168
    s_add_u32 s61, s59, 3072
    buffer_load_dwordx4 v162, s[4:7], s61 offen lds
    s_add_u32 m0, s52, 11616
    s_add_u32 s61, s59, 3072
    buffer_load_dwordx4 v162, s[8:11], s61 offen lds
    s_add_u32 m0, s52, 4224
    s_add_u32 s61, s59, 4096
    buffer_load_dwordx4 v162, s[4:7], s61 offen lds
    s_add_u32 m0, s52, 12672
    s_add_u32 s61, s59, 4096
    buffer_load_dwordx4 v162, s[8:11], s61 offen lds
    s_add_u32 m0, s52, 5280
    s_add_u32 s61, s59, 5120
    buffer_load_dwordx4 v162, s[4:7], s61 offen lds
    s_add_u32 m0, s52, 13728
    s_add_u32 s61, s59, 5120
    buffer_load_dwordx4 v162, s[8:11], s61 offen lds
    s_add_u32 m0, s52, 6336
    s_add_u32 s61, s59, 6144
    buffer_load_dwordx4 v162, s[4:7], s61 offen lds
    s_add_u32 m0, s52, 14784
    s_add_u32 s61, s59, 6144
    buffer_load_dwordx4 v162, s[8:11], s61 offen lds
    s_add_u32 m0, s52, 7392
    s_add_u32 s61, s59, 7168
    buffer_load_dwordx4 v162, s[4:7], s61 offen lds
    s_add_u32 m0, s52, 15840
    s_add_u32 s61, s59, 7168
    buffer_load_dwordx4 v162, s[8:11], s61 offen lds
    s_waitcnt vmcnt(0)
    ds_read_b128 v[96:99], v160 offset:0
    ds_read_b128 v[100:103], v160 offset:64
    ds_read_b128 v[104:107], v160 offset:128
    ds_read_b128 v[108:111], v160 offset:192
    ds_read_b128 v[112:115], v160 offset:512
    ds_read_b128 v[116:119], v160 offset:576
    ds_read_b128 v[120:123], v160 offset:640
    ds_read_b128 v[124:127], v160 offset:704
    s_waitcnt lgkmcnt(0)
    ds_read_b64_tr_b16 v[128:129], v161 offset:0
    ds_read_b64_tr_b16 v[130:131], v161 offset:512
    ds_read_b64_tr_b16 v[132:133], v161 offset:32
    ds_read_b64_tr_b16 v[134:135], v161 offset:544
    ds_read_b64_tr_b16 v[136:137], v161 offset:64
    ds_read_b64_tr_b16 v[138:139], v161 offset:576
    ds_read_b64_tr_b16 v[140:141], v161 offset:96
    ds_read_b64_tr_b16 v[142:143], v161 offset:608
    s_waitcnt lgkmcnt(0)
    ds_read_b64_tr_b16 v[144:145], v161 offset:128
    ds_read_b64_tr_b16 v[146:147], v161 offset:640
    ds_read_b64_tr_b16 v[148:149], v161 offset:160
    ds_read_b64_tr_b16 v[150:151], v161 offset:672
    ds_read_b64_tr_b16 v[152:153], v161 offset:192
    ds_read_b64_tr_b16 v[154:155], v161 offset:704
    ds_read_b64_tr_b16 v[156:157], v161 offset:224
    ds_read_b64_tr_b16 v[158:159], v161 offset:736
    s_waitcnt lgkmcnt(0)
    v_mfma_f32_16x16x32_bf16 v[34:37], v[96:99], v[16:19], 0
    v_mfma_f32_16x16x32_bf16 v[34:37], v[100:103], v[20:23], v[34:37]
    v_mfma_f32_16x16x32_bf16 v[34:37], v[104:107], v[24:27], v[34:37]
    v_mfma_f32_16x16x32_bf16 v[34:37], v[108:111], v[28:31], v[34:37]
    v_mfma_f32_16x16x32_bf16 v[38:41], v[112:115], v[16:19], 0
    v_mfma_f32_16x16x32_bf16 v[38:41], v[116:119], v[20:23], v[38:41]
    v_mfma_f32_16x16x32_bf16 v[38:41], v[120:123], v[24:27], v[38:41]
    v_mfma_f32_16x16x32_bf16 v[38:41], v[124:127], v[28:31], v[38:41]
    s_nop 15
    v_max3_f32 v42, v34, v35, v36
    v_max3_f32 v42, v42, v37, v38
    v_max3_f32 v42, v42, v39, v40
    v_max3_f32 v42, v42, v41, v32
    v_mov_b32 v43, v42
    s_nop 2
    v_permlane16_swap_b32 v42, v43
    s_nop 2
    v_max_f32 v42, v42, v43
    v_mov_b32 v43, v42
    s_nop 2
    v_permlane32_swap_b32 v42, v43
    s_nop 2
    v_max_f32 v42, v42, v43
    v_sub_f32 v44, v32, v42
    v_exp_f32 v44, v44
    v_mov_b32 v32, v42
    v_sub_f32 v34, v34, v42
    v_sub_f32 v35, v35, v42
    v_sub_f32 v36, v36, v42
    v_sub_f32 v37, v37, v42
    v_sub_f32 v38, v38, v42
    v_sub_f32 v39, v39, v42
    v_sub_f32 v40, v40, v42
    v_sub_f32 v41, v41, v42
    v_exp_f32 v34, v34
    v_exp_f32 v35, v35
    v_exp_f32 v36, v36
    v_exp_f32 v37, v37
    v_exp_f32 v38, v38
    v_exp_f32 v39, v39
    v_exp_f32 v40, v40
    v_exp_f32 v41, v41
    s_nop 1
    v_mul_f32 v33, v33, v44
    v_cvt_pk_bf16_f32 v48, v34, v35
    v_cvt_pk_bf16_f32 v49, v36, v37
    v_cvt_pk_bf16_f32 v50, v38, v39
    v_cvt_pk_bf16_f32 v51, v40, v41
    v_lshlrev_b32 v45, 16, v48
    v_and_b32 v46, s31, v48
    v_add_f32 v33, v33, v45
    v_add_f32 v33, v33, v46
    v_lshlrev_b32 v45, 16, v49
    v_and_b32 v46, s31, v49
    v_add_f32 v33, v33, v45
    v_add_f32 v33, v33, v46
    v_lshlrev_b32 v45, 16, v50
    v_and_b32 v46, s31, v50
    v_add_f32 v33, v33, v45
    v_add_f32 v33, v33, v46
    v_lshlrev_b32 v45, 16, v51
    v_and_b32 v46, s31, v51
    v_add_f32 v33, v33, v45
    v_add_f32 v33, v33, v46
    v_mul_f32 v64, v64, v44
    v_mul_f32 v65, v65, v44
    v_mul_f32 v66, v66, v44
    v_mul_f32 v67, v67, v44
    v_mul_f32 v68, v68, v44
    v_mul_f32 v69, v69, v44
    v_mul_f32 v70, v70, v44
    v_mul_f32 v71, v71, v44
    v_mul_f32 v72, v72, v44
    v_mul_f32 v73, v73, v44
    v_mul_f32 v74, v74, v44
    v_mul_f32 v75, v75, v44
    v_mul_f32 v76, v76, v44
    v_mul_f32 v77, v77, v44
    v_mul_f32 v78, v78, v44
    v_mul_f32 v79, v79, v44
    v_mul_f32 v80, v80, v44
    v_mul_f32 v81, v81, v44
    v_mul_f32 v82, v82, v44
    v_mul_f32 v83, v83, v44
    v_mul_f32 v84, v84, v44
    v_mul_f32 v85, v85, v44
    v_mul_f32 v86, v86, v44
    v_mul_f32 v87, v87, v44
    v_mul_f32 v88, v88, v44
    v_mul_f32 v89, v89, v44
    v_mul_f32 v90, v90, v44
    v_mul_f32 v91, v91, v44
    v_mul_f32 v92, v92, v44
    v_mul_f32 v93, v93, v44
    v_mul_f32 v94, v94, v44
    v_mul_f32 v95, v95, v44
    s_nop 2
    v_mfma_f32_16x16x32_bf16 v[64:67], v[128:131], v[48:51], v[64:67]
    v_mfma_f32_16x16x32_bf16 v[68:71], v[132:135], v[48:51], v[68:71]
    v_mfma_f32_16x16x32_bf16 v[72:75], v[136:139], v[48:51], v[72:75]
    v_mfma_f32_16x16x32_bf16 v[76:79], v[140:143], v[48:51], v[76:79]
    v_mfma_f32_16x16x32_bf16 v[80:83], v[144:147], v[48:51], v[80:83]
    v_mfma_f32_16x16x32_bf16 v[84:87], v[148:151], v[48:51], v[84:87]
    v_mfma_f32_16x16x32_bf16 v[88:91], v[152:155], v[48:51], v[88:91]
    v_mfma_f32_16x16x32_bf16 v[92:95], v[156:159], v[48:51], v[92:95]
    s_nop 15
    s_add_u32 s59, s59, 8192
    s_add_u32 s60, s60, 1
    s_cmp_lt_u32 s60, 32
    s_cbranch_scc1 L_slow_tile
    v_mov_b32 v43, v33
    s_nop 2
    v_permlane16_swap_b32 v33, v43
    s_nop 2
    v_add_f32 v33, v33, v43
    v_mov_b32 v43, v33
    s_nop 2
    v_permlane32_swap_b32 v33, v43
    s_nop 2
    v_add_f32 v33, v33, v43
    v_rcp_f32 v33, v33
    s_nop 1
    v_mul_f32 v64, v64, v33
    v_mul_f32 v65, v65, v33
    v_mul_f32 v66, v66, v33
    v_mul_f32 v67, v67, v33
    v_mul_f32 v68, v68, v33
    v_mul_f32 v69, v69, v33
    v_mul_f32 v70, v70, v33
    v_mul_f32 v71, v71, v33
    v_mul_f32 v72, v72, v33
    v_mul_f32 v73, v73, v33
    v_mul_f32 v74, v74, v33
    v_mul_f32 v75, v75, v33
    v_mul_f32 v76, v76, v33
    v_mul_f32 v77, v77, v33
    v_mul_f32 v78, v78, v33
    v_mul_f32 v79, v79, v33
    v_mul_f32 v80, v80, v33
    v_mul_f32 v81, v81, v33
    v_mul_f32 v82, v82, v33
    v_mul_f32 v83, v83, v33
    v_mul_f32 v84, v84, v33
    v_mul_f32 v85, v85, v33
    v_mul_f32 v86, v86, v33
    v_mul_f32 v87, v87, v33
    v_mul_f32 v88, v88, v33
    v_mul_f32 v89, v89, v33
    v_mul_f32 v90, v90, v33
    v_mul_f32 v91, v91, v33
    v_mul_f32 v92, v92, v33
    v_mul_f32 v93, v93, v33
    v_mul_f32 v94, v94, v33
    v_mul_f32 v95, v95, v33
    v_cvt_pk_bf16_f32 v64, v64, v65
    v_cvt_pk_bf16_f32 v65, v66, v67
    v_cvt_pk_bf16_f32 v66, v68, v69
    v_cvt_pk_bf16_f32 v67, v70, v71
    s_nop 2
    v_permlane16_swap_b32 v64, v66
    v_permlane16_swap_b32 v65, v67
    s_nop 2
    buffer_store_dwordx4 v[64:67], v163, s[16:19], s57 offen offset:0
    v_cvt_pk_bf16_f32 v72, v72, v73
    v_cvt_pk_bf16_f32 v73, v74, v75
    v_cvt_pk_bf16_f32 v74, v76, v77
    v_cvt_pk_bf16_f32 v75, v78, v79
    s_nop 2
    v_permlane16_swap_b32 v72, v74
    v_permlane16_swap_b32 v73, v75
    s_nop 2
    buffer_store_dwordx4 v[72:75], v163, s[16:19], s57 offen offset:64
    v_cvt_pk_bf16_f32 v80, v80, v81
    v_cvt_pk_bf16_f32 v81, v82, v83
    v_cvt_pk_bf16_f32 v82, v84, v85
    v_cvt_pk_bf16_f32 v83, v86, v87
    s_nop 2
    v_permlane16_swap_b32 v80, v82
    v_permlane16_swap_b32 v81, v83
    s_nop 2
    buffer_store_dwordx4 v[80:83], v163, s[16:19], s57 offen offset:128
    v_cvt_pk_bf16_f32 v88, v88, v89
    v_cvt_pk_bf16_f32 v89, v90, v91
    v_cvt_pk_bf16_f32 v90, v92, v93
    v_cvt_pk_bf16_f32 v91, v94, v95
    s_nop 2
    v_permlane16_swap_b32 v88, v90
    v_permlane16_swap_b32 v89, v91
    s_nop 2
    buffer_store_dwordx4 v[88:91], v163, s[16:19], s57 offen offset:192
    s_waitcnt vmcnt(0)
    s_add_u32 s56, s56, 1
    s_cmp_lt_u32 s56, 6
    s_cbranch_scc1 L_slow_blk
L_slow_next:
    s_add_u32 s53, s53, 1
    s_cmp_lt_u32 s53, 2
    s_cbranch_scc1 L_slow_head
    s_endpgm

.section .rodata,"a"
.p2align 6
.amdhsa_kernel standalone__gqa_softmax__near_ridge_kernel
  .amdhsa_next_free_vgpr 512
  .amdhsa_next_free_sgpr 102
  .amdhsa_accum_offset 256
  .amdhsa_group_segment_fixed_size 0
  .amdhsa_kernarg_size 48
  .amdhsa_user_sgpr_count 2
  .amdhsa_user_sgpr_kernarg_segment_ptr 1
  .amdhsa_system_sgpr_workgroup_id_x 1
.end_amdhsa_kernel
```
